```python
import torch

def _softmax(x, axis=-1):
    return torch.softmax(x, dim=axis)
def _gelu(x):
    return torch.nn.functional.gelu(x, approximate="tanh")
def _silu(x):
    return torch.nn.functional.silu(x)
def _sigmoid(x):
    return torch.sigmoid(x)
def _layernorm(x, axis=-1, eps=1e-5):
    m = x.mean(dim=axis, keepdim=True)
    v = x.var(dim=axis, keepdim=True, unbiased=False)
    return (x - m) / torch.sqrt(v + eps)
def _scatter_add(tgt, idx, src, axis=0):
    return tgt.clone().index_add_(axis, idx, src)
def _segment_sum(src, seg, n):
    out = torch.zeros((n,) + src.shape[1:], dtype=src.dtype)
    return out.index_add_(0, seg, src)
def _pad(x, pw):
    flat = tuple(v for pair in reversed(pw) for v in pair)
    return torch.nn.functional.pad(x, flat)

kernel_name = 'interleave_layers__linear_attn_block__geglu_ffn__prompt'

def setup_inputs():

    _w = (lambda a: (lambda t: t.to(torch.bfloat16) if t.is_floating_point() else t)(torch.as_tensor(a)))
    def _A_setup():
        B, S, D = 1, 2048, 576
        return {
            "x": _w((lambda *s: torch.randn(*s, dtype=torch.bfloat16) * 0.05)(B, S, D)),
            "wqkv": _w((lambda *s: torch.randn(*s, dtype=torch.bfloat16) * 0.05)(D, 3 * D)),
            "wo": _w((lambda *s: torch.randn(*s, dtype=torch.bfloat16) * 0.05)(D, D)),
        }
    _A_in = _A_setup()

    def _B_setup():
        B, S, D, F = 1, 2048, 576, 4608
        return {
            "x": _w((lambda *s: torch.randn(*s, dtype=torch.bfloat16) * 0.05)(B, S, D)),
            "w_gate": _w((lambda *s: torch.randn(*s, dtype=torch.bfloat16) * 0.05)(D, F)),
            "w_up": _w((lambda *s: torch.randn(*s, dtype=torch.bfloat16) * 0.05)(D, F)),
            "w_down": _w((lambda *s: torch.randn(*s, dtype=torch.bfloat16) * 0.05)(F, D)),
        }
    _B_in = _B_setup()

    return {
        "A_x": _A_in["x"],
        "A_wqkv": _A_in["wqkv"],
        "A_wo": _A_in["wo"],
        "B_x": _B_in["x"],
        "B_w_gate": _B_in["w_gate"],
        "B_w_up": _B_in["w_up"],
        "B_w_down": _B_in["w_down"],
    }

def reference(A_x, A_wqkv, A_wo, B_x, B_w_gate, B_w_up, B_w_down):
    def _A_ref(x, wqkv, wo):
        B, S, D = x.shape
        H = 32; Dh = D // H
        qkv = (lambda x, *d: x.permute(*d))((x @ wqkv).reshape(B, S, 3, H, Dh), 2, 0, 3, 1, 4)
        q, k, v = qkv[0], qkv[1], qkv[2]
        phi = lambda t: torch.where(t > 0, t + 1, torch.exp(t)) + 1e-6
        pq, pk = phi(q), phi(k)
        kv = torch.einsum("bhsd,bhse->bhde", pk, v)
        z = torch.einsum("bhsd->bhd", pk)
        num = torch.einsum("bhqd,bhde->bhqe", pq, kv)
        den = torch.einsum("bhqd,bhd->bhq", pq, z)[..., None] + 1e-6
        o = num / den
        return (lambda x, *d: x.permute(*d))(o, 0, 2, 1, 3).reshape(B, S, D) @ wo

    def _B_ref(x, w_gate, w_up, w_down):
        return (_gelu(x @ w_gate) * (x @ w_up)) @ w_down

    x = A_x
    x = x + _A_ref(_layernorm(x, axis=-1), A_wqkv, A_wo)
    x = x + _B_ref(_layernorm(x, axis=-1), B_w_gate, B_w_up, B_w_down)
    x = x + _A_ref(_layernorm(x, axis=-1), A_wqkv, A_wo)
    x = x + _B_ref(_layernorm(x, axis=-1), B_w_gate, B_w_up, B_w_down)
    return x
```

```asm
; @launch grid=(256,1,1) block=(256,1,1) lds=163840
.amdgcn_target "amdgcn-amd-amdhsa--gfx950"
.text
.globl interleave_layers__linear_attn_block__geglu_ffn__prompt_kernel
.p2align 8
.type interleave_layers__linear_attn_block__geglu_ffn__prompt_kernel,@function
interleave_layers__linear_attn_block__geglu_ffn__prompt_kernel:
mega_kernel:
  s_cmp_ge_u32 s2, 256
  s_cbranch_scc1 M_end
  s_load_dwordx16 s[16:31], s[0:1], 0
  s_load_dwordx4 s[32:35], s[0:1], 64
  v_lshrrev_b32 v1, 6, v0
  v_and_b32 v0, 63, v0
  v_readfirstlane_b32 s3, v1
  s_waitcnt lgkmcnt(0)
  s_mov_b32 s4, s34
  s_and_b32 s5, s35, 0xffff
  s_mov_b32 s6, 268435456
  s_mov_b32 s7, 0x20000
  s_mov_b32 s50, 19136512
  s_mov_b32 s51, 0
  s_mov_b32 s49, 536870912
  s_mov_b32 s100, s2
  s_mov_b32 s101, s2
  s_and_b32 s31, s31, 0xffff
  s_and_b32 s36, s100, 7
  s_lshr_b32 s37, s100, 3
  v_lshlrev_b32 v1, 4, v0
  v_mov_b32 v80, s49
  v_mov_b32 v96, s49
  s_cmp_lg_u32 s3, 3
  s_cbranch_scc1 M_nopf
  s_getpc_b64 s[12:13]
M_pc:
  s_add_u32 s12, s12, mega_kernel-M_pc
  s_addc_u32 s13, s13, -1
  s_mul_i32 s14, s37, 2048
  v_lshl_add_u32 v24, v0, 4, s14
  v_min_u32 v25, M_after-mega_kernel-16, v24
  global_load_dwordx4 v[152:155], v25, s[12:13]
  v_add_u32 v24, 0x400, v24
  v_min_u32 v25, M_after-mega_kernel-16, v24
  global_load_dwordx4 v[156:159], v25, s[12:13]
  v_add_u32 v24, 0x400, v24
M_nopf:
  s_mov_b32 s101, 0
P_s0:
  s_cmp_ge_u32 s100, 225
  s_cbranch_scc1 P0_end
  s_mov_b32 s2, 504
  s_cmp_lt_u32 s100, 144
  s_cselect_b32 s2, 685, s2
  s_cmp_lt_u32 s100, 80
  s_cselect_b32 s2, 685, s2
  s_cmp_lt_u32 s100, 44
  s_cselect_b32 s2, 829, s2
  s_add_u32 s2, s2, s100
  s_mov_b32 s58, 73728
  s_mov_b32 s59, 1
  s_mov_b32 s57, 0
  s_branch P0_job
P_s1:
  s_mov_b32 s2, s100
  s_mov_b32 s58, 0
  s_mov_b32 s59, 1
  s_mov_b32 s57, 0
  s_branch P0_job
P_s2:
  s_waitcnt vmcnt(6)
  s_cmp_ge_u32 s100, 225
  s_cbranch_scc1 P0_end
  s_mov_b32 s2, 504
  s_cmp_lt_u32 s100, 144
  s_cselect_b32 s2, 685, s2
  s_cmp_lt_u32 s100, 80
  s_cselect_b32 s2, 685, s2
  s_cmp_lt_u32 s100, 44
  s_cselect_b32 s2, 829, s2
  s_add_u32 s2, s2, s100
  s_mov_b32 s58, 73728
  s_mov_b32 s59, 2
  s_mov_b32 s57, 18
  s_branch P0_job
P_s3:
  s_waitcnt vmcnt(0)
  s_barrier
  s_mov_b32 s8, s32
  s_and_b32 s9, s33, 0xffff
  s_movk_i32 s10, 256
  s_mov_b32 s11, 0x20000
  s_cmp_eq_u32 s3, 0
  s_cselect_b32 s46, 0, s49
  v_mov_b32 v96, s49
  v_writelane_b32 v96, s46, 0
  v_mov_b32 v97, 1
  buffer_atomic_add v97, v96, s[8:11], 0 offen sc0
  s_mov_b32 s60, 6
  s_mov_b32 s2, 256
  s_mov_b32 s56, s49
  s_sub_u32 s46, s100, 0
  s_add_u32 s47, s46, 256
  s_cmp_lt_u32 s46, 256
  s_cselect_b32 s2, s47, s2
  s_cselect_b32 s56, 0, s56
  s_mov_b32 s58, 24576
  s_mov_b32 s59, 1
  s_mov_b32 s57, 0
  s_branch P0_job
P_s4:
  s_mov_b32 s2, 512
  s_mov_b32 s56, s49
  s_sub_u32 s46, s100, 0
  s_add_u32 s47, s46, 512
  s_cmp_lt_u32 s46, 80
  s_cselect_b32 s2, s47, s2
  s_cselect_b32 s56, 0, s56
  s_sub_u32 s46, s100, 225
  s_add_u32 s47, s46, 592
  s_cmp_lt_u32 s46, 31
  s_cselect_b32 s2, s47, s2
  s_cselect_b32 s56, 0, s56
  s_cmp_lg_u32 s56, 0
  s_cbranch_scc1 P_s6x
  s_add_u32 s60, s60, 6
  s_mov_b32 s58, 139264
  s_mov_b32 s59, 1
  s_mov_b32 s57, 0
  s_branch P0_job
P_s5:
  s_mov_b32 s2, 623
  s_mov_b32 s56, s49
  s_sub_u32 s46, s100, 225
  s_add_u32 s47, s46, 623
  s_cmp_lt_u32 s46, 25
  s_cselect_b32 s2, s47, s2
  s_cselect_b32 s56, 0, s56
  s_cmp_lg_u32 s56, 0
  s_cbranch_scc1 P_s6x
  s_add_u32 s60, s60, 6
  s_mov_b32 s58, 49152
  s_mov_b32 s59, 1
  s_mov_b32 s57, 0
  s_branch P0_job
P_s6x:
  s_mov_b32 s101, 6
P_s6:
  s_waitcnt vmcnt(18)
  s_cmp_eq_u32 s60, 18
  s_cbranch_scc1 P_ret
  s_waitcnt vmcnt(12)
  s_cmp_eq_u32 s60, 12
  s_cbranch_scc1 P_ret
  s_waitcnt vmcnt(6)
P_ret:
  v_readfirstlane_b32 s46, v97
  s_cmp_lg_u32 s3, 0
  s_cbranch_scc1 DL0_nl
  s_cmp_lg_u32 s46, 255
  s_cbranch_scc1 DL0_nl
  s_mov_b32 s8, s32
  s_and_b32 s9, s33, 0xffff
  s_movk_i32 s10, 256
  s_mov_b32 s11, 0x20000
  v_mov_b32 v97, 1
  buffer_store_dword v97, v96, s[8:11], 0 offen offset:128 sc1
DL0_nl:
  s_mov_b32 s2, s100
  s_mov_b32 s58, 0
  s_mov_b32 s59, 2
  s_mov_b32 s57, 18
  s_branch P0_job
P_s7:
  s_mov_b32 s2, 256
  s_mov_b32 s56, s49
  s_sub_u32 s46, s100, 0
  s_add_u32 s47, s46, 256
  s_cmp_lt_u32 s46, 256
  s_cselect_b32 s2, s47, s2
  s_cselect_b32 s56, 0, s56
  s_mov_b32 s58, 24576
  s_mov_b32 s59, 2
  s_mov_b32 s57, s60
  s_branch P0_job
P_s8:
  s_mov_b32 s2, 512
  s_mov_b32 s56, s49
  s_sub_u32 s46, s100, 0
  s_add_u32 s47, s46, 512
  s_cmp_lt_u32 s46, 80
  s_cselect_b32 s2, s47, s2
  s_cselect_b32 s56, 0, s56
  s_sub_u32 s46, s100, 225
  s_add_u32 s47, s46, 592
  s_cmp_lt_u32 s46, 31
  s_cselect_b32 s2, s47, s2
  s_cselect_b32 s56, 0, s56
  s_cmp_lg_u32 s56, 0
  s_cbranch_scc1 P_fin
  s_mov_b32 s58, 139264
  s_mov_b32 s59, 2
  s_mov_b32 s57, s60
  s_branch P0_job
P_s9:
  s_mov_b32 s2, 623
  s_mov_b32 s56, s49
  s_sub_u32 s46, s100, 225
  s_add_u32 s47, s46, 623
  s_cmp_lt_u32 s46, 25
  s_cselect_b32 s2, s47, s2
  s_cselect_b32 s56, 0, s56
  s_cmp_lg_u32 s56, 0
  s_cbranch_scc1 P_fin
  s_mov_b32 s58, 49152
  s_mov_b32 s59, 2
  s_mov_b32 s57, s60
  s_branch P0_job
P0_job:
  v_and_b32 v5, 15, v0
  v_lshrrev_b32 v6, 4, v0
  s_cmp_ge_u32 s2, 432
  s_cbranch_scc1 P0_notA
  s_mov_b32 s38, 29826162
  s_mul_hi_u32 s36, s2, s38
  s_mul_i32 s38, s36, 144
  s_sub_u32 s37, s2, s38
  s_mov_b32 s38, 59652324
  s_mul_hi_u32 s39, s37, s38
  s_mul_i32 s38, s39, 72
  s_sub_u32 s40, s37, s38
  s_cmp_eq_u32 s39, 0
  s_cselect_b32 s8, s24, s26
  s_cselect_b32 s9, s25, s27
  s_and_b32 s9, s9, 0xffff
  s_mov_b32 s10, 5308416
  s_mov_b32 s11, 0x20000
  s_mov_b32 s12, 9216
  s_mul_i32 s15, s36, 24
  s_mul_i32 s38, s3, 6
  s_add_u32 s15, s15, s38
  s_mul_i32 s13, s15, 73728
  s_lshl_b32 s38, s40, 7
  v_lshrrev_b32 v7, 3, v0
  v_mul_u32_u24 v1, 9216, v7
  v_and_b32 v7, 7, v0
  v_lshl_add_u32 v1, v7, 4, v1
  v_add_u32 v1, s38, v1
  s_cmp_eq_u32 s59, 1
  s_cbranch_scc1 P0_tr
  v_and_b32 v7, 1, v0
  v_bfe_u32 v8, v0, 1, 1
  v_lshl_or_b32 v82, v7, 1, v8
  s_lshl_b32 s38, s40, 2
  v_add_u32 v7, s38, v6
  s_mov_b32 s38, 36864
  v_mul_lo_u32 v2, v7, s38
  s_lshl_b32 s41, s39, 8
  s_add_u32 s38, s41, 0
  v_lshl_add_u32 v8, v5, 4, s38
  v_add_u32 v2, v2, v8
  v_mov_b32 v3, 0x800
  s_movk_i32 s14, 0x200
  s_lshr_b32 s38, s36, 1
  s_lshl_b32 s38, s38, 9
  s_add_u32 s38, s38, s41
  s_and_b32 s42, s36, 1
  s_lshl_b32 s42, s42, 3
  s_add_u32 s38, s38, s42
  s_add_u32 s38, s38, 10616832
  v_lshl_add_u32 v8, v5, 4, s38
  v_lshl_add_u32 v80, v7, 10, v8
  s_mov_b32 s43, 1
  s_branch P0_tr
P0_notA:
  s_cmp_ge_u32 s2, 648
  s_cbranch_scc1 P0_notB
  s_sub_u32 s37, s2, 432
  s_mov_b32 s38, 477218589
  s_mul_hi_u32 s39, s37, s38
  s_mul_i32 s38, s39, 9
  s_sub_u32 s40, s37, s38
  s_mov_b32 s8, s28
  s_and_b32 s9, s29, 0xffff
  s_mov_b32 s10, 5308416
  s_mov_b32 s11, 0x20000
  s_movk_i32 s12, 1152
  s_mul_i32 s15, s39, 24
  s_mul_i32 s38, s3, 6
  s_add_u32 s15, s15, s38
  s_mul_i32 s13, s15, 9216
  s_mov_b32 s38, 29826162
  s_mul_hi_u32 s41, s15, s38
  s_mul_i32 s38, s41, 144
  s_sub_u32 s15, s15, s38
  s_lshl_b32 s38, s40, 7
  v_lshrrev_b32 v7, 3, v0
  v_mul_u32_u24 v1, 1152, v7
  v_and_b32 v7, 7, v0
  v_lshl_add_u32 v1, v7, 4, v1
  v_add_u32 v1, s38, v1
  s_cmp_eq_u32 s59, 1
  s_cbranch_scc1 P0_tr
  v_and_b32 v82, 3, v0
  s_lshl_b32 s38, s40, 2
  v_add_u32 v7, s38, v6
  v_mul_u32_u24 v8, 57, v7
  v_lshrrev_b32 v8, 9, v8
  v_mul_u32_u24 v9, 9, v8
  v_sub_u32 v9, v7, v9
  v_lshrrev_b32 v10, 1, v9
  s_add_u32 s38, s41, 1
  v_subrev_u32 v10, s38, v10
  v_and_b32 v10, 3, v10
  v_and_b32 v11, 1, v9
  v_lshl_add_u32 v10, v10, 1, v11
  v_add_u32 v10, 1, v10
  v_cmp_eq_u32 vcc, 8, v9
  s_nop 1
  v_cndmask_b32 v9, v10, 0, vcc
  v_mul_u32_u24 v10, 36, v9
  v_mov_b32 v12, v10
  v_mov_b32 v3, 1
  v_mov_b32 v13, 1
  v_cmp_gt_u32 vcc, 7, v9
  s_nop 1
  v_cndmask_b32 v10, v10, v9, vcc
  v_cndmask_b32 v3, v3, 7, vcc
  v_add_u32 v11, 175, v9
  v_cndmask_b32 v12, v12, v11, vcc
  v_cndmask_b32 v13, v13, 2, vcc
  v_cmp_gt_u32 vcc, 5, v9
  v_add_u32 v11, 40, v9
  s_nop 0
  v_cndmask_b32 v12, v12, v11, vcc
  v_cndmask_b32 v13, v13, 5, vcc
  v_lshlrev_b32 v3, 10, v3
  v_lshlrev_b32 v85, 10, v13
  s_lshl_b32 s38, s41, 2
  v_add_u32 v8, s38, v8
  v_mul_u32_u24 v8, 324, v8
  s_mov_b32 s38, 10911744
  v_lshl_add_u32 v9, v5, 4, s38
  v_add_u32 v10, v8, v10
  v_lshl_add_u32 v2, v10, 10, v9
  v_add_u32 v12, v8, v12
  v_lshl_add_u32 v84, v12, 10, v9
  s_movk_i32 s14, 0x100
  s_mov_b32 s43, 0
P0_tr:
  s_mul_i32 s38, s3, 6144
  s_add_u32 s38, s38, s58
  s_cmp_eq_u32 s59, 2
  s_cbranch_scc1 P0_trfin
  s_mov_b32 m0, s38
  s_lshl_b32 s12, s12, 3
  buffer_load_dwordx4 v1, s[8:11], s13 offen nt lds
  s_add_u32 s13, s13, s12
  s_add_u32 m0, m0, 1024
  s_nop 0
  buffer_load_dwordx4 v1, s[8:11], s13 offen nt lds
  s_add_u32 s13, s13, s12
  s_add_u32 m0, m0, 1024
  s_nop 0
  buffer_load_dwordx4 v1, s[8:11], s13 offen nt lds
  s_add_u32 s13, s13, s12
  s_add_u32 m0, m0, 1024
  s_nop 0
  buffer_load_dwordx4 v1, s[8:11], s13 offen nt lds
  s_add_u32 s13, s13, s12
  s_add_u32 m0, m0, 1024
  s_nop 0
  buffer_load_dwordx4 v1, s[8:11], s13 offen nt lds
  s_add_u32 s13, s13, s12
  s_add_u32 m0, m0, 1024
  s_nop 0
  buffer_load_dwordx4 v1, s[8:11], s13 offen nt lds
  s_branch P0_end
P0_trfin:
  v_bfe_u32 v7, v0, 2, 2
  v_lshlrev_b32 v7, 7, v7
  v_lshl_add_u32 v7, v6, 5, v7
  v_lshl_add_u32 v7, v82, 3, v7
  v_add_u32 v7, s38, v7
  s_waitcnt vmcnt(18)
  s_cmp_eq_u32 s57, 18
  s_cbranch_scc1 P0_landed
  s_waitcnt vmcnt(12)
  s_cmp_eq_u32 s57, 12
  s_cbranch_scc1 P0_landed
  s_waitcnt vmcnt(6)
P0_landed:
  ds_read_b64_tr_b16 v[56:57], v7 offset:0
  ds_read_b64_tr_b16 v[58:59], v7 offset:512
  ds_read_b64_tr_b16 v[60:61], v7 offset:1024
  ds_read_b64_tr_b16 v[62:63], v7 offset:1536
  ds_read_b64_tr_b16 v[64:65], v7 offset:2048
  ds_read_b64_tr_b16 v[66:67], v7 offset:2560
  ds_read_b64_tr_b16 v[68:69], v7 offset:3072
  ds_read_b64_tr_b16 v[70:71], v7 offset:3584
  ds_read_b64_tr_b16 v[72:73], v7 offset:4096
  ds_read_b64_tr_b16 v[74:75], v7 offset:4608
  ds_read_b64_tr_b16 v[76:77], v7 offset:5120
  ds_read_b64_tr_b16 v[78:79], v7 offset:5632
  s_waitcnt lgkmcnt(0)
  s_branch P0_store
P0_notB:
  s_cmp_ge_u32 s2, 729
  s_cbranch_scc1 P0_notC
  s_sub_u32 s37, s2, 648
  s_mov_b32 s38, 159072863
  s_mul_hi_u32 s36, s37, s38
  s_mul_i32 s38, s36, 27
  s_sub_u32 s40, s37, s38
  s_mov_b32 s38, 477218589
  s_mul_hi_u32 s39, s40, s38
  s_mul_i32 s38, s39, 9
  s_sub_u32 s41, s40, s38
  s_mov_b32 s8, s18
  s_and_b32 s9, s19, 0xffff
  s_mov_b32 s10, 1990656
  s_mov_b32 s11, 0x20000
  s_movk_i32 s12, 3456
  s_mul_i32 s15, s36, 24
  s_mul_i32 s38, s3, 6
  s_add_u32 s15, s15, s38
  s_mul_i32 s13, s15, 27648
  s_lshl_b32 s38, s40, 7
  v_lshrrev_b32 v7, 3, v0
  v_mul_u32_u24 v1, 3456, v7
  v_and_b32 v7, 7, v0
  v_lshl_add_u32 v1, v7, 4, v1
  v_add_u32 v1, s38, v1
  s_cmp_eq_u32 s59, 1
  s_cbranch_scc1 P0_tr
  v_and_b32 v82, 3, v0
  s_lshl_b32 s38, s41, 6
  v_add_u32 v7, s38, v0
  v_mul_u32_u24 v8, 1821, v7
  v_lshrrev_b32 v8, 16, v8
  v_mul_u32_u24 v9, 36, v8
  v_sub_u32 v9, v7, v9
  v_lshrrev_b32 v10, 4, v9
  v_add_u32 v10, 5, v10
  v_and_b32 v11, 15, v9
  v_subrev_u32 v12, 20, v9
  v_cmp_lt_u32 vcc, 31, v9
  s_nop 1
  v_cndmask_b32 v10, v10, 4, vcc
  v_cndmask_b32 v11, v11, v12, vcc
  v_cmp_lt_u32 vcc, 17, v9
  s_nop 1
  v_cndmask_b32 v12, 0, 1, vcc
  v_mul_u32_u24 v13, 18, v12
  v_sub_u32 v13, v9, v13
  s_lshl_b32 s38, s39, 1
  s_sub_u32 s42, s38, 2
  v_add_u32 v14, s42, v12
  v_mul_u32_u24 v15, s38, v12
  s_lshl_b32 s42, s42, 1
  s_sub_u32 s42, s42, 16
  v_add3_u32 v15, v15, v13, s42
  v_cmp_lt_u32 vcc, 15, v13
  s_nop 1
  v_cndmask_b32 v14, v14, 4, vcc
  v_cndmask_b32 v15, v13, v15, vcc
  s_cmp_eq_u32 s39, 0
  s_cselect_b64 vcc, -1, 0
  v_cndmask_b32 v10, v14, v10, vcc
  v_cndmask_b32 v11, v15, v11, vcc
  v_add_u32 v12, 90, v10
  v_cmp_gt_u32 vcc, 5, v10
  s_nop 1
  v_cndmask_b32 v10, v12, v10, vcc
  v_mov_b32 v3, 2048
  v_mov_b32 v12, 5120
  v_cndmask_b32 v3, v3, v12, vcc
  v_mul_u32_u24 v8, 133, v8
  v_add_u32 v10, v10, v8
  s_mov_b32 s38, 16220160
  v_lshl_add_u32 v2, v11, 4, s38
  v_lshl_add_u32 v2, v10, 10, v2
  s_movk_i32 s14, 0x100
  s_lshl_b32 s38, s36, 8
  v_mad_u32_u24 v80, v3, 18, v2
  v_add_u32 v80, s38, v80
  s_mov_b32 s43, 2
  s_branch P0_tr
P0_store:
  s_cmp_eq_u32 s43, 0
  s_cbranch_scc0 P0_storeAC
  s_mov_b32 s44, 0xa4398210
  s_mov_b32 s45, 0xb
  s_lshr_b32 s38, s15, 2
  s_mul_i32 s52, s38, 57
  s_lshr_b32 s52, s52, 9
  s_mul_i32 s53, s52, 36
  s_lshl_b32 s38, s38, 2
  s_sub_u32 s53, s38, s53
  s_lshr_b64 s[54:55], s[44:45], s53
  s_and_b32 s54, s54, 15
  s_mul_i32 s53, s52, 5
  s_lshl_b32 s52, s52, 2
  s_add_u32 s52, s52, 12
  s_cmp_ge_u32 s54, 8
  s_cselect_b32 s52, s52, s53
  s_cselect_b64 vcc, -1, 0
  s_add_u32 s38, s52, s54
  v_mad_u32_u24 v86, s38, v85, v84
  v_mad_u32_u24 v4, s38, v3, v2
  s_and_b32 s41, s15, 3
  s_lshl_b32 s41, s41, 8
  v_cndmask_b32 v4, v4, v86, vcc
  s_add_u32 s15, s15, 2
  buffer_store_dwordx4 v[56:59], v4, s[4:7], s41 offen offset:0 sc1
  buffer_store_dwordx4 v[60:63], v4, s[4:7], s41 offen offset:256 sc1
  s_lshr_b32 s38, s15, 2
  s_mul_i32 s52, s38, 57
  s_lshr_b32 s52, s52, 9
  s_mul_i32 s53, s52, 36
  s_lshl_b32 s38, s38, 2
  s_sub_u32 s53, s38, s53
  s_lshr_b64 s[54:55], s[44:45], s53
  s_and_b32 s54, s54, 15
  s_mul_i32 s53, s52, 5
  s_lshl_b32 s52, s52, 2
  s_add_u32 s52, s52, 12
  s_cmp_ge_u32 s54, 8
  s_cselect_b32 s52, s52, s53
  s_cselect_b64 vcc, -1, 0
  s_add_u32 s38, s52, s54
  v_mad_u32_u24 v86, s38, v85, v84
  v_mad_u32_u24 v4, s38, v3, v2
  s_and_b32 s41, s15, 3
  s_lshl_b32 s41, s41, 8
  v_cndmask_b32 v4, v4, v86, vcc
  s_add_u32 s15, s15, 2
  buffer_store_dwordx4 v[64:67], v4, s[4:7], s41 offen offset:0 sc1
  buffer_store_dwordx4 v[68:71], v4, s[4:7], s41 offen offset:256 sc1
  s_lshr_b32 s38, s15, 2
  s_mul_i32 s52, s38, 57
  s_lshr_b32 s52, s52, 9
  s_mul_i32 s53, s52, 36
  s_lshl_b32 s38, s38, 2
  s_sub_u32 s53, s38, s53
  s_lshr_b64 s[54:55], s[44:45], s53
  s_and_b32 s54, s54, 15
  s_mul_i32 s53, s52, 5
  s_lshl_b32 s52, s52, 2
  s_add_u32 s52, s52, 12
  s_cmp_ge_u32 s54, 8
  s_cselect_b32 s52, s52, s53
  s_cselect_b64 vcc, -1, 0
  s_add_u32 s38, s52, s54
  v_mad_u32_u24 v86, s38, v85, v84
  v_mad_u32_u24 v4, s38, v3, v2
  s_and_b32 s41, s15, 3
  s_lshl_b32 s41, s41, 8
  v_cndmask_b32 v4, v4, v86, vcc
  s_add_u32 s15, s15, 2
  buffer_store_dwordx4 v[72:75], v4, s[4:7], s41 offen offset:0 sc1
  buffer_store_dwordx4 v[76:79], v4, s[4:7], s41 offen offset:256 sc1
  s_branch P0_end
P0_storeAC:
  v_mov_b32 v81, 0
  s_mov_b32 s48, 0x3f803f80
  s_lshr_b32 s38, s15, 2
  s_and_b32 s41, s15, 3
  s_mul_i32 s41, s41, s14
  v_mad_u32_u24 v4, s38, v3, v2
  s_add_u32 s15, s15, 1
  buffer_store_dwordx4 v[56:59], v4, s[4:7], s41 offen sc1
  v_dot2_f32_bf16 v81, v56, s48, v81
  v_dot2_f32_bf16 v81, v57, s48, v81
  v_dot2_f32_bf16 v81, v58, s48, v81
  v_dot2_f32_bf16 v81, v59, s48, v81
  s_lshr_b32 s38, s15, 2
  s_and_b32 s41, s15, 3
  s_mul_i32 s41, s41, s14
  v_mad_u32_u24 v4, s38, v3, v2
  s_add_u32 s15, s15, 1
  buffer_store_dwordx4 v[60:63], v4, s[4:7], s41 offen sc1
  v_dot2_f32_bf16 v81, v60, s48, v81
  v_dot2_f32_bf16 v81, v61, s48, v81
  v_dot2_f32_bf16 v81, v62, s48, v81
  v_dot2_f32_bf16 v81, v63, s48, v81
  s_lshr_b32 s38, s15, 2
  s_and_b32 s41, s15, 3
  s_mul_i32 s41, s41, s14
  v_mad_u32_u24 v4, s38, v3, v2
  s_add_u32 s15, s15, 1
  buffer_store_dwordx4 v[64:67], v4, s[4:7], s41 offen sc1
  v_dot2_f32_bf16 v81, v64, s48, v81
  v_dot2_f32_bf16 v81, v65, s48, v81
  v_dot2_f32_bf16 v81, v66, s48, v81
  v_dot2_f32_bf16 v81, v67, s48, v81
  s_lshr_b32 s38, s15, 2
  s_and_b32 s41, s15, 3
  s_mul_i32 s41, s41, s14
  v_mad_u32_u24 v4, s38, v3, v2
  s_add_u32 s15, s15, 1
  buffer_store_dwordx4 v[68:71], v4, s[4:7], s41 offen sc1
  v_dot2_f32_bf16 v81, v68, s48, v81
  v_dot2_f32_bf16 v81, v69, s48, v81
  v_dot2_f32_bf16 v81, v70, s48, v81
  v_dot2_f32_bf16 v81, v71, s48, v81
  s_lshr_b32 s38, s15, 2
  s_and_b32 s41, s15, 3
  s_mul_i32 s41, s41, s14
  v_mad_u32_u24 v4, s38, v3, v2
  s_add_u32 s15, s15, 1
  buffer_store_dwordx4 v[72:75], v4, s[4:7], s41 offen sc1
  v_dot2_f32_bf16 v81, v72, s48, v81
  v_dot2_f32_bf16 v81, v73, s48, v81
  v_dot2_f32_bf16 v81, v74, s48, v81
  v_dot2_f32_bf16 v81, v75, s48, v81
  s_lshr_b32 s38, s15, 2
  s_and_b32 s41, s15, 3
  s_mul_i32 s41, s41, s14
  v_mad_u32_u24 v4, s38, v3, v2
  s_add_u32 s15, s15, 1
  buffer_store_dwordx4 v[76:79], v4, s[4:7], s41 offen sc1
  v_dot2_f32_bf16 v81, v76, s48, v81
  v_dot2_f32_bf16 v81, v77, s48, v81
  v_dot2_f32_bf16 v81, v78, s48, v81
  v_dot2_f32_bf16 v81, v79, s48, v81
  s_mul_i32 s38, s3, 6144
  s_add_u32 s38, s38, s58
  v_lshl_add_u32 v4, v0, 2, s38
  ds_write_b32 v4, v81
  s_waitcnt lgkmcnt(0)
  s_barrier
  s_cmp_lg_u32 s3, 0
  s_cbranch_scc1 P0_end
  ds_read_b32 v8, v4 offset:6144
  ds_read_b32 v9, v4 offset:12288
  ds_read_b32 v10, v4 offset:18432
  s_waitcnt lgkmcnt(0)
  v_add_f32 v81, v81, v8
  v_add_f32 v9, v9, v10
  v_add_f32 v81, v81, v9
  v_cvt_pk_bf16_f32 v8, v81, 0
  v_lshlrev_b32 v9, 16, v8
  v_sub_f32 v81, v81, v9
  v_cvt_pk_bf16_f32 v9, v81, 0
  v_lshl_or_b32 v12, v9, 16, v8
  v_lshlrev_b32 v9, 16, v9
  v_sub_f32 v81, v81, v9
  v_cvt_pk_bf16_f32 v13, v81, 0
  v_mov_b32 v14, 0
  v_mov_b32 v15, 0
  s_cmp_eq_u32 s43, 2
  s_cbranch_scc1 P0_csC
  s_cmp_eq_u32 s36, 2
  s_cbranch_scc1 P0_cs4
  buffer_store_dwordx2 v[12:13], v80, s[4:7], 0 offen sc1
  s_branch P0_end
P0_csC:
  s_cmp_lg_u32 s36, 2
  s_cbranch_scc1 P0_cs4
  v_mov_b32 v16, 0
  v_mov_b32 v17, 0
  v_mov_b32 v18, 0
  v_mov_b32 v19, 0
  buffer_store_dwordx4 v[16:19], v80, s[4:7], 0 offen offset:256 sc1
P0_cs4:
  buffer_store_dwordx4 v[12:15], v80, s[4:7], 0 offen sc1
  s_branch P0_end
P0_notC:
  s_cmp_ge_u32 s2, 765
  s_cbranch_scc1 P0_notD
  s_sub_u32 s37, s2, 729
  s_mov_b32 s38, 477218589
  s_mul_hi_u32 s39, s37, s38
  s_mul_i32 s38, s39, 9
  s_sub_u32 s40, s37, s38
  s_mov_b32 s8, s20
  s_and_b32 s9, s21, 0xffff
  s_mov_b32 s10, 663552
  s_mov_b32 s11, 0x20000
  s_lshl_b32 s38, s40, 6
  v_add_u32 v7, s38, v0
  v_lshlrev_b32 v1, 1, v7
  s_mul_i32 s41, s39, 144
  s_lshl_b32 s38, s3, 2
  s_add_u32 s42, s41, s38
  s_mul_i32 s42, s42, 1152
  s_lshr_b32 s38, s3, 1
  s_mul_i32 s38, s38, 18
  s_add_u32 s41, s41, s38
  s_and_b32 s38, s3, 1
  s_add_u32 s41, s41, s38
  s_add_u32 s41, s41, 16
  s_mul_i32 s41, s41, 1152
  s_cmp_eq_u32 s59, 2
  s_cbranch_scc1 P0_dfin
  s_add_u32 s13, s42, 0
  buffer_load_ushort v100, v1, s[8:11], s13 offen
  s_add_u32 s13, s42, 1152
  buffer_load_ushort v101, v1, s[8:11], s13 offen
  s_add_u32 s13, s42, 2304
  buffer_load_ushort v102, v1, s[8:11], s13 offen
  s_add_u32 s13, s42, 3456
  buffer_load_ushort v103, v1, s[8:11], s13 offen
  s_add_u32 s13, s42, 20736
  buffer_load_ushort v104, v1, s[8:11], s13 offen
  s_add_u32 s13, s42, 21888
  buffer_load_ushort v105, v1, s[8:11], s13 offen
  s_add_u32 s13, s42, 23040
  buffer_load_ushort v106, v1, s[8:11], s13 offen
  s_add_u32 s13, s42, 24192
  buffer_load_ushort v107, v1, s[8:11], s13 offen
  s_add_u32 s13, s42, 41472
  buffer_load_ushort v108, v1, s[8:11], s13 offen
  s_add_u32 s13, s42, 42624
  buffer_load_ushort v109, v1, s[8:11], s13 offen
  s_add_u32 s13, s42, 43776
  buffer_load_ushort v110, v1, s[8:11], s13 offen
  s_add_u32 s13, s42, 44928
  buffer_load_ushort v111, v1, s[8:11], s13 offen
  s_add_u32 s13, s42, 62208
  buffer_load_ushort v112, v1, s[8:11], s13 offen
  s_add_u32 s13, s42, 63360
  buffer_load_ushort v113, v1, s[8:11], s13 offen
  s_add_u32 s13, s42, 64512
  buffer_load_ushort v114, v1, s[8:11], s13 offen
  s_add_u32 s13, s42, 65664
  buffer_load_ushort v115, v1, s[8:11], s13 offen
  s_add_u32 s13, s42, 82944
  buffer_load_ushort v116, v1, s[8:11], s13 offen
  s_add_u32 s13, s42, 84096
  buffer_load_ushort v117, v1, s[8:11], s13 offen
  s_add_u32 s13, s42, 85248
  buffer_load_ushort v118, v1, s[8:11], s13 offen
  s_add_u32 s13, s42, 86400
  buffer_load_ushort v119, v1, s[8:11], s13 offen
  s_add_u32 s13, s42, 103680
  buffer_load_ushort v120, v1, s[8:11], s13 offen
  s_add_u32 s13, s42, 104832
  buffer_load_ushort v121, v1, s[8:11], s13 offen
  s_add_u32 s13, s42, 105984
  buffer_load_ushort v122, v1, s[8:11], s13 offen
  s_add_u32 s13, s42, 107136
  buffer_load_ushort v123, v1, s[8:11], s13 offen
  s_add_u32 s13, s42, 124416
  buffer_load_ushort v124, v1, s[8:11], s13 offen
  s_add_u32 s13, s42, 125568
  buffer_load_ushort v125, v1, s[8:11], s13 offen
  s_add_u32 s13, s42, 126720
  buffer_load_ushort v126, v1, s[8:11], s13 offen
  s_add_u32 s13, s42, 127872
  buffer_load_ushort v127, v1, s[8:11], s13 offen
  s_add_u32 s13, s42, 145152
  buffer_load_ushort v128, v1, s[8:11], s13 offen
  s_add_u32 s13, s42, 146304
  buffer_load_ushort v129, v1, s[8:11], s13 offen
  s_add_u32 s13, s42, 147456
  buffer_load_ushort v130, v1, s[8:11], s13 offen
  s_add_u32 s13, s42, 148608
  buffer_load_ushort v131, v1, s[8:11], s13 offen
  s_add_u32 s13, s41, 0
  buffer_load_ushort v132, v1, s[8:11], s13 offen
  s_add_u32 s13, s41, 41472
  buffer_load_ushort v133, v1, s[8:11], s13 offen
  s_add_u32 s13, s41, 82944
  buffer_load_ushort v134, v1, s[8:11], s13 offen
  s_add_u32 s13, s41, 124416
  buffer_load_ushort v135, v1, s[8:11], s13 offen
  s_branch P0_end
P0_dfin:
  s_lshl_b32 s38, s40, 2
  v_add_u32 v7, s38, v6
  v_mul_u32_u24 v2, 57, v7
  v_lshrrev_b32 v2, 9, v2
  v_mul_u32_u24 v3, 9, v2
  v_sub_u32 v3, v7, v3
  v_lshlrev_b32 v2, 2, v2
  v_add_u32 v2, s39, v2
  v_mad_u32_u24 v2, v2, 45, v3
  s_lshl_b32 s38, s3, 8
  s_add_u32 s38, s38, 18399232
  v_lshl_add_u32 v3, v5, 4, s38
  v_lshl_add_u32 v2, v2, 10, v3
  v_mov_b32 v74, 0
  v_mov_b32 v75, 0
  s_waitcnt vmcnt(34)
  v_lshl_or_b32 v56, v101, 16, v100
  v_lshl_or_b32 v57, v103, 16, v102
  v_lshl_or_b32 v58, v105, 16, v104
  v_lshl_or_b32 v59, v107, 16, v106
  s_mov_b32 s38, 0
  buffer_store_dwordx4 v[56:59], v2, s[4:7], s38 offen sc1
  s_waitcnt vmcnt(27)
  v_lshl_or_b32 v60, v109, 16, v108
  v_lshl_or_b32 v61, v111, 16, v110
  v_lshl_or_b32 v62, v113, 16, v112
  v_lshl_or_b32 v63, v115, 16, v114
  s_mov_b32 s38, 9216
  buffer_store_dwordx4 v[60:63], v2, s[4:7], s38 offen sc1
  s_waitcnt vmcnt(20)
  v_lshl_or_b32 v64, v117, 16, v116
  v_lshl_or_b32 v65, v119, 16, v118
  v_lshl_or_b32 v66, v121, 16, v120
  v_lshl_or_b32 v67, v123, 16, v122
  s_mov_b32 s38, 18432
  buffer_store_dwordx4 v[64:67], v2, s[4:7], s38 offen sc1
  s_waitcnt vmcnt(13)
  v_lshl_or_b32 v68, v125, 16, v124
  v_lshl_or_b32 v69, v127, 16, v126
  v_lshl_or_b32 v70, v129, 16, v128
  v_lshl_or_b32 v71, v131, 16, v130
  s_mov_b32 s38, 27648
  buffer_store_dwordx4 v[68:71], v2, s[4:7], s38 offen sc1
  s_waitcnt vmcnt(10)
  v_lshl_or_b32 v72, v133, 16, v132
  v_lshl_or_b32 v73, v135, 16, v134
  s_mov_b32 s38, 36864
  buffer_store_dwordx4 v[72:75], v2, s[4:7], s38 offen sc1
  s_branch P0_end
P0_notD:
  s_cmp_ge_u32 s2, 829
  s_cbranch_scc1 P0_zero
  s_sub_u32 s37, s2, 765
  s_lshl_b32 s37, s37, 2
  s_add_u32 s37, s37, s3
  s_mov_b32 s8, s16
  s_and_b32 s9, s17, 0xffff
  s_mov_b32 s10, 2359296
  s_mov_b32 s11, 0x20000
  s_lshl_b32 s38, s37, 3
  v_and_b32 v5, 7, v0
  v_lshrrev_b32 v6, 3, v0
  v_add_u32 v7, s38, v5
  s_lshr_b32 s39, s37, 2
  s_and_b32 s40, s39, 3
  s_lshr_b32 s41, s40, 1
  s_cmp_eq_u32 s41, 0
  s_cselect_b32 s42, 10, 8
  v_lshrrev_b32 v2, 1, v6
  v_mul_u32_u24 v2, 18, v2
  v_and_b32 v3, 1, v6
  v_mad_u32_u24 v2, v3, s42, v2
  v_cmp_ne_u32 vcc, s41, v3
  s_mul_i32 s13, s3, 9216
  s_add_u32 s13, s13, s58
  s_cmp_eq_u32 s59, 2
  s_cbranch_scc1 P0_efin
  s_mov_b32 m0, s13
  s_mul_i32 s12, s37, 9216
  v_lshlrev_b32 v1, 4, v0
  buffer_load_dwordx4 v1, s[8:11], s12 offen offset:0 nt lds
  buffer_load_dwordx4 v1, s[8:11], s12 offen offset:1024 nt lds
  buffer_load_dwordx4 v1, s[8:11], s12 offen offset:2048 nt lds
  buffer_load_dwordx4 v1, s[8:11], s12 offen offset:3072 nt lds
  s_add_u32 s12, s12, 4096
  s_add_u32 m0, m0, 4096
  s_nop 0
  buffer_load_dwordx4 v1, s[8:11], s12 offen offset:0 nt lds
  buffer_load_dwordx4 v1, s[8:11], s12 offen offset:1024 nt lds
  buffer_load_dwordx4 v1, s[8:11], s12 offen offset:2048 nt lds
  buffer_load_dwordx4 v1, s[8:11], s12 offen offset:3072 nt lds
  s_add_u32 s12, s12, 4096
  s_add_u32 m0, m0, 4096
  s_nop 0
  buffer_load_dwordx4 v1, s[8:11], s12 offen offset:0 nt lds
  s_branch P0_end
P0_efin:
  v_mul_u32_u24 v1, 1152, v5
  v_lshl_add_u32 v1, v2, 4, v1
  v_add_u32 v1, s13, v1
  ds_read_b128 v[100:103], v1 offset:0
  ds_read_b128 v[104:107], v1 offset:16
  ds_read_b128 v[108:111], v1 offset:32
  ds_read_b128 v[112:115], v1 offset:48
  ds_read_b128 v[116:119], v1 offset:64
  ds_read_b128 v[120:123], v1 offset:80
  ds_read_b128 v[124:127], v1 offset:96
  ds_read_b128 v[128:131], v1 offset:112
  ds_read_b128 v[132:135], v1 offset:128
  ds_read_b128 v[136:139], v1 offset:144
  s_waitcnt lgkmcnt(0)
  v_cndmask_b32 v132, v132, 0, vcc
  v_cndmask_b32 v133, v133, 0, vcc
  v_cndmask_b32 v134, v134, 0, vcc
  v_cndmask_b32 v135, v135, 0, vcc
  v_cndmask_b32 v136, v136, 0, vcc
  v_cndmask_b32 v137, v137, 0, vcc
  v_cndmask_b32 v138, v138, 0, vcc
  v_cndmask_b32 v139, v139, 0, vcc
  s_mul_i32 s39, s39, 36864
  s_add_u32 s39, s39, 19136512
  v_and_b32 v1, 31, v7
  v_lshlrev_b32 v1, 4, v1
  v_lshl_add_u32 v1, v2, 9, v1
  v_mov_b32 v4, 536870912
  v_cndmask_b32 v4, v1, v4, vcc
  s_mov_b32 s48, 0x3f803f80
  v_mov_b32 v81, 0
  v_mov_b32 v82, 0
  v_mov_b32 v83, 0x3caaaaab
  v_mov_b32 v84, 0x3d000000
  v_cndmask_b32 v83, v83, v84, vcc
  buffer_store_dwordx4 v[100:103], v1, s[4:7], s39 offen offset:0 sc1
  v_dot2_f32_bf16 v81, v100, s48, v81
  v_dot2_f32_bf16 v81, v101, s48, v81
  v_dot2_f32_bf16 v81, v102, s48, v81
  v_dot2_f32_bf16 v81, v103, s48, v81
  buffer_store_dwordx4 v[104:107], v1, s[4:7], s39 offen offset:512 sc1
  v_dot2_f32_bf16 v81, v104, s48, v81
  v_dot2_f32_bf16 v81, v105, s48, v81
  v_dot2_f32_bf16 v81, v106, s48, v81
  v_dot2_f32_bf16 v81, v107, s48, v81
  buffer_store_dwordx4 v[108:111], v1, s[4:7], s39 offen offset:1024 sc1
  v_dot2_f32_bf16 v81, v108, s48, v81
  v_dot2_f32_bf16 v81, v109, s48, v81
  v_dot2_f32_bf16 v81, v110, s48, v81
  v_dot2_f32_bf16 v81, v111, s48, v81
  buffer_store_dwordx4 v[112:115], v1, s[4:7], s39 offen offset:1536 sc1
  v_dot2_f32_bf16 v81, v112, s48, v81
  v_dot2_f32_bf16 v81, v113, s48, v81
  v_dot2_f32_bf16 v81, v114, s48, v81
  v_dot2_f32_bf16 v81, v115, s48, v81
  buffer_store_dwordx4 v[116:119], v1, s[4:7], s39 offen offset:2048 sc1
  v_dot2_f32_bf16 v82, v116, s48, v82
  v_dot2_f32_bf16 v82, v117, s48, v82
  v_dot2_f32_bf16 v82, v118, s48, v82
  v_dot2_f32_bf16 v82, v119, s48, v82
  buffer_store_dwordx4 v[120:123], v1, s[4:7], s39 offen offset:2560 sc1
  v_dot2_f32_bf16 v82, v120, s48, v82
  v_dot2_f32_bf16 v82, v121, s48, v82
  v_dot2_f32_bf16 v82, v122, s48, v82
  v_dot2_f32_bf16 v82, v123, s48, v82
  buffer_store_dwordx4 v[124:127], v1, s[4:7], s39 offen offset:3072 sc1
  v_dot2_f32_bf16 v82, v124, s48, v82
  v_dot2_f32_bf16 v82, v125, s48, v82
  v_dot2_f32_bf16 v82, v126, s48, v82
  v_dot2_f32_bf16 v82, v127, s48, v82
  buffer_store_dwordx4 v[128:131], v1, s[4:7], s39 offen offset:3584 sc1
  v_dot2_f32_bf16 v82, v128, s48, v82
  v_dot2_f32_bf16 v82, v129, s48, v82
  v_dot2_f32_bf16 v82, v130, s48, v82
  v_dot2_f32_bf16 v82, v131, s48, v82
  s_add_u32 s39, s39, 4096
  buffer_store_dwordx4 v[132:135], v4, s[4:7], s39 offen offset:0 sc1
  v_dot2_f32_bf16 v81, v132, s48, v81
  v_dot2_f32_bf16 v81, v133, s48, v81
  v_dot2_f32_bf16 v81, v134, s48, v81
  v_dot2_f32_bf16 v81, v135, s48, v81
  buffer_store_dwordx4 v[136:139], v4, s[4:7], s39 offen offset:512 sc1
  v_dot2_f32_bf16 v81, v136, s48, v81
  v_dot2_f32_bf16 v81, v137, s48, v81
  v_dot2_f32_bf16 v81, v138, s48, v81
  v_dot2_f32_bf16 v81, v139, s48, v81
  s_nop 2
  v_mul_f32 v84, v81, v83
  v_mul_f32 v86, 0x3d000000, v82
  v_mov_b32 v85, 0
  v_mov_b32 v87, 0
  v_mov_b32 v81, 0
  v_lshlrev_b32 v82, 16, v100
  v_and_b32 v83, 0xffff0000, v100
  v_sub_f32 v82, v82, v84
  v_sub_f32 v83, v83, v84
  v_fmac_f32 v85, v82, v82
  v_fmac_f32 v85, v83, v83
  v_lshlrev_b32 v82, 16, v101
  v_and_b32 v83, 0xffff0000, v101
  v_sub_f32 v82, v82, v84
  v_sub_f32 v83, v83, v84
  v_fmac_f32 v85, v82, v82
  v_fmac_f32 v85, v83, v83
  v_lshlrev_b32 v82, 16, v102
  v_and_b32 v83, 0xffff0000, v102
  v_sub_f32 v82, v82, v84
  v_sub_f32 v83, v83, v84
  v_fmac_f32 v85, v82, v82
  v_fmac_f32 v85, v83, v83
  v_lshlrev_b32 v82, 16, v103
  v_and_b32 v83, 0xffff0000, v103
  v_sub_f32 v82, v82, v84
  v_sub_f32 v83, v83, v84
  v_fmac_f32 v85, v82, v82
  v_fmac_f32 v85, v83, v83
  v_lshlrev_b32 v82, 16, v104
  v_and_b32 v83, 0xffff0000, v104
  v_sub_f32 v82, v82, v84
  v_sub_f32 v83, v83, v84
  v_fmac_f32 v85, v82, v82
  v_fmac_f32 v85, v83, v83
  v_lshlrev_b32 v82, 16, v105
  v_and_b32 v83, 0xffff0000, v105
  v_sub_f32 v82, v82, v84
  v_sub_f32 v83, v83, v84
  v_fmac_f32 v85, v82, v82
  v_fmac_f32 v85, v83, v83
  v_lshlrev_b32 v82, 16, v106
  v_and_b32 v83, 0xffff0000, v106
  v_sub_f32 v82, v82, v84
  v_sub_f32 v83, v83, v84
  v_fmac_f32 v85, v82, v82
  v_fmac_f32 v85, v83, v83
  v_lshlrev_b32 v82, 16, v107
  v_and_b32 v83, 0xffff0000, v107
  v_sub_f32 v82, v82, v84
  v_sub_f32 v83, v83, v84
  v_fmac_f32 v85, v82, v82
  v_fmac_f32 v85, v83, v83
  v_lshlrev_b32 v82, 16, v108
  v_and_b32 v83, 0xffff0000, v108
  v_sub_f32 v82, v82, v84
  v_sub_f32 v83, v83, v84
  v_fmac_f32 v85, v82, v82
  v_fmac_f32 v85, v83, v83
  v_lshlrev_b32 v82, 16, v109
  v_and_b32 v83, 0xffff0000, v109
  v_sub_f32 v82, v82, v84
  v_sub_f32 v83, v83, v84
  v_fmac_f32 v85, v82, v82
  v_fmac_f32 v85, v83, v83
  v_lshlrev_b32 v82, 16, v110
  v_and_b32 v83, 0xffff0000, v110
  v_sub_f32 v82, v82, v84
  v_sub_f32 v83, v83, v84
  v_fmac_f32 v85, v82, v82
  v_fmac_f32 v85, v83, v83
  v_lshlrev_b32 v82, 16, v111
  v_and_b32 v83, 0xffff0000, v111
  v_sub_f32 v82, v82, v84
  v_sub_f32 v83, v83, v84
  v_fmac_f32 v85, v82, v82
  v_fmac_f32 v85, v83, v83
  v_lshlrev_b32 v82, 16, v112
  v_and_b32 v83, 0xffff0000, v112
  v_sub_f32 v82, v82, v84
  v_sub_f32 v83, v83, v84
  v_fmac_f32 v85, v82, v82
  v_fmac_f32 v85, v83, v83
  v_lshlrev_b32 v82, 16, v113
  v_and_b32 v83, 0xffff0000, v113
  v_sub_f32 v82, v82, v84
  v_sub_f32 v83, v83, v84
  v_fmac_f32 v85, v82, v82
  v_fmac_f32 v85, v83, v83
  v_lshlrev_b32 v82, 16, v114
  v_and_b32 v83, 0xffff0000, v114
  v_sub_f32 v82, v82, v84
  v_sub_f32 v83, v83, v84
  v_fmac_f32 v85, v82, v82
  v_fmac_f32 v85, v83, v83
  v_lshlrev_b32 v82, 16, v115
  v_and_b32 v83, 0xffff0000, v115
  v_sub_f32 v82, v82, v84
  v_sub_f32 v83, v83, v84
  v_fmac_f32 v85, v82, v82
  v_fmac_f32 v85, v83, v83
  v_lshlrev_b32 v82, 16, v116
  v_and_b32 v83, 0xffff0000, v116
  v_sub_f32 v82, v82, v86
  v_sub_f32 v83, v83, v86
  v_fmac_f32 v87, v82, v82
  v_fmac_f32 v87, v83, v83
  v_lshlrev_b32 v82, 16, v117
  v_and_b32 v83, 0xffff0000, v117
  v_sub_f32 v82, v82, v86
  v_sub_f32 v83, v83, v86
  v_fmac_f32 v87, v82, v82
  v_fmac_f32 v87, v83, v83
  v_lshlrev_b32 v82, 16, v118
  v_and_b32 v83, 0xffff0000, v118
  v_sub_f32 v82, v82, v86
  v_sub_f32 v83, v83, v86
  v_fmac_f32 v87, v82, v82
  v_fmac_f32 v87, v83, v83
  v_lshlrev_b32 v82, 16, v119
  v_and_b32 v83, 0xffff0000, v119
  v_sub_f32 v82, v82, v86
  v_sub_f32 v83, v83, v86
  v_fmac_f32 v87, v82, v82
  v_fmac_f32 v87, v83, v83
  v_lshlrev_b32 v82, 16, v120
  v_and_b32 v83, 0xffff0000, v120
  v_sub_f32 v82, v82, v86
  v_sub_f32 v83, v83, v86
  v_fmac_f32 v87, v82, v82
  v_fmac_f32 v87, v83, v83
  v_lshlrev_b32 v82, 16, v121
  v_and_b32 v83, 0xffff0000, v121
  v_sub_f32 v82, v82, v86
  v_sub_f32 v83, v83, v86
  v_fmac_f32 v87, v82, v82
  v_fmac_f32 v87, v83, v83
  v_lshlrev_b32 v82, 16, v122
  v_and_b32 v83, 0xffff0000, v122
  v_sub_f32 v82, v82, v86
  v_sub_f32 v83, v83, v86
  v_fmac_f32 v87, v82, v82
  v_fmac_f32 v87, v83, v83
  v_lshlrev_b32 v82, 16, v123
  v_and_b32 v83, 0xffff0000, v123
  v_sub_f32 v82, v82, v86
  v_sub_f32 v83, v83, v86
  v_fmac_f32 v87, v82, v82
  v_fmac_f32 v87, v83, v83
  v_lshlrev_b32 v82, 16, v124
  v_and_b32 v83, 0xffff0000, v124
  v_sub_f32 v82, v82, v86
  v_sub_f32 v83, v83, v86
  v_fmac_f32 v87, v82, v82
  v_fmac_f32 v87, v83, v83
  v_lshlrev_b32 v82, 16, v125
  v_and_b32 v83, 0xffff0000, v125
  v_sub_f32 v82, v82, v86
  v_sub_f32 v83, v83, v86
  v_fmac_f32 v87, v82, v82
  v_fmac_f32 v87, v83, v83
  v_lshlrev_b32 v82, 16, v126
  v_and_b32 v83, 0xffff0000, v126
  v_sub_f32 v82, v82, v86
  v_sub_f32 v83, v83, v86
  v_fmac_f32 v87, v82, v82
  v_fmac_f32 v87, v83, v83
  v_lshlrev_b32 v82, 16, v127
  v_and_b32 v83, 0xffff0000, v127
  v_sub_f32 v82, v82, v86
  v_sub_f32 v83, v83, v86
  v_fmac_f32 v87, v82, v82
  v_fmac_f32 v87, v83, v83
  v_lshlrev_b32 v82, 16, v128
  v_and_b32 v83, 0xffff0000, v128
  v_sub_f32 v82, v82, v86
  v_sub_f32 v83, v83, v86
  v_fmac_f32 v87, v82, v82
  v_fmac_f32 v87, v83, v83
  v_lshlrev_b32 v82, 16, v129
  v_and_b32 v83, 0xffff0000, v129
  v_sub_f32 v82, v82, v86
  v_sub_f32 v83, v83, v86
  v_fmac_f32 v87, v82, v82
  v_fmac_f32 v87, v83, v83
  v_lshlrev_b32 v82, 16, v130
  v_and_b32 v83, 0xffff0000, v130
  v_sub_f32 v82, v82, v86
  v_sub_f32 v83, v83, v86
  v_fmac_f32 v87, v82, v82
  v_fmac_f32 v87, v83, v83
  v_lshlrev_b32 v82, 16, v131
  v_and_b32 v83, 0xffff0000, v131
  v_sub_f32 v82, v82, v86
  v_sub_f32 v83, v83, v86
  v_fmac_f32 v87, v82, v82
  v_fmac_f32 v87, v83, v83
  v_lshlrev_b32 v82, 16, v132
  v_and_b32 v83, 0xffff0000, v132
  v_sub_f32 v82, v82, v84
  v_sub_f32 v83, v83, v84
  v_fmac_f32 v81, v82, v82
  v_fmac_f32 v81, v83, v83
  v_lshlrev_b32 v82, 16, v133
  v_and_b32 v83, 0xffff0000, v133
  v_sub_f32 v82, v82, v84
  v_sub_f32 v83, v83, v84
  v_fmac_f32 v81, v82, v82
  v_fmac_f32 v81, v83, v83
  v_lshlrev_b32 v82, 16, v134
  v_and_b32 v83, 0xffff0000, v134
  v_sub_f32 v82, v82, v84
  v_sub_f32 v83, v83, v84
  v_fmac_f32 v81, v82, v82
  v_fmac_f32 v81, v83, v83
  v_lshlrev_b32 v82, 16, v135
  v_and_b32 v83, 0xffff0000, v135
  v_sub_f32 v82, v82, v84
  v_sub_f32 v83, v83, v84
  v_fmac_f32 v81, v82, v82
  v_fmac_f32 v81, v83, v83
  v_lshlrev_b32 v82, 16, v136
  v_and_b32 v83, 0xffff0000, v136
  v_sub_f32 v82, v82, v84
  v_sub_f32 v83, v83, v84
  v_fmac_f32 v81, v82, v82
  v_fmac_f32 v81, v83, v83
  v_lshlrev_b32 v82, 16, v137
  v_and_b32 v83, 0xffff0000, v137
  v_sub_f32 v82, v82, v84
  v_sub_f32 v83, v83, v84
  v_fmac_f32 v81, v82, v82
  v_fmac_f32 v81, v83, v83
  v_lshlrev_b32 v82, 16, v138
  v_and_b32 v83, 0xffff0000, v138
  v_sub_f32 v82, v82, v84
  v_sub_f32 v83, v83, v84
  v_fmac_f32 v81, v82, v82
  v_fmac_f32 v81, v83, v83
  v_lshlrev_b32 v82, 16, v139
  v_and_b32 v83, 0xffff0000, v139
  v_sub_f32 v82, v82, v84
  v_sub_f32 v83, v83, v84
  v_fmac_f32 v81, v82, v82
  v_fmac_f32 v81, v83, v83
  v_cndmask_b32 v81, v81, 0, vcc
  v_add_f32 v85, v85, v81
  v_lshrrev_b32 v2, 4, v7
  v_lshlrev_b32 v2, 11, v2
  v_lshl_add_u32 v2, v3, 10, v2
  v_lshrrev_b32 v4, 1, v6
  v_lshl_add_u32 v2, v4, 8, v2
  v_and_b32 v4, 15, v7
  v_lshl_add_u32 v2, v4, 4, v2
  s_bitcmp1_b32 s40, 0
  s_cselect_b64 vcc, -1, 0
  v_cndmask_b32 v88, v84, v86, vcc
  v_cndmask_b32 v89, v85, v87, vcc
  v_cndmask_b32 v90, v86, v84, vcc
  v_cndmask_b32 v91, v87, v85, vcc
  s_mov_b32 s39, 24608768
  buffer_store_dwordx4 v[88:91], v2, s[4:7], s39 offen sc1
  s_branch P0_end
P0_zero:
  s_cmp_eq_u32 s59, 2
  s_cbranch_scc1 P0_end
  s_sub_u32 s37, s2, 829
  s_cmp_ge_u32 s37, 38
  s_cbranch_scc1 P0_end
  s_cmp_ge_u32 s37, 15
  s_cselect_b32 s38, 45350912, 0
  s_lshl_b32 s39, s37, 15
  s_add_u32 s38, s38, s39
  s_lshl_b32 s39, s3, 13
  s_add_u32 s38, s38, s39
  s_add_u32 s38, s38, 24117248
  v_lshlrev_b32 v1, 4, v0
  v_mov_b32 v8, 0
  v_mov_b32 v9, 0
  v_mov_b32 v10, 0
  v_mov_b32 v11, 0
  buffer_store_dwordx4 v[8:11], v1, s[4:7], s38 offen offset:0 sc1
  buffer_store_dwordx4 v[8:11], v1, s[4:7], s38 offen offset:1024 sc1
  buffer_store_dwordx4 v[8:11], v1, s[4:7], s38 offen offset:2048 sc1
  buffer_store_dwordx4 v[8:11], v1, s[4:7], s38 offen offset:3072 sc1
  s_add_u32 s38, s38, 4096
  buffer_store_dwordx4 v[8:11], v1, s[4:7], s38 offen offset:0 sc1
  buffer_store_dwordx4 v[8:11], v1, s[4:7], s38 offen offset:1024 sc1
  buffer_store_dwordx4 v[8:11], v1, s[4:7], s38 offen offset:2048 sc1
  buffer_store_dwordx4 v[8:11], v1, s[4:7], s38 offen offset:3072 sc1
P0_end:
  s_add_u32 s101, s101, 1
  s_cmp_eq_u32 s101, 1
  s_cbranch_scc1 P_s1
  s_cmp_eq_u32 s101, 2
  s_cbranch_scc1 P_s2
  s_cmp_eq_u32 s101, 3
  s_cbranch_scc1 P_s3
  s_cmp_eq_u32 s101, 4
  s_cbranch_scc1 P_s4
  s_cmp_eq_u32 s101, 5
  s_cbranch_scc1 P_s5
  s_cmp_eq_u32 s101, 6
  s_cbranch_scc1 P_s6
  s_cmp_eq_u32 s101, 7
  s_cbranch_scc1 P_s7
  s_cmp_eq_u32 s101, 8
  s_cbranch_scc1 P_s8
  s_cmp_eq_u32 s101, 9
  s_cbranch_scc1 P_s9
P_fin:
  s_cmp_lg_u32 s3, 0
  s_cbranch_scc1 WD0_done
  s_mov_b32 s8, s32
  s_and_b32 s9, s33, 0xffff
  s_movk_i32 s10, 256
  s_mov_b32 s11, 0x20000
  v_mov_b32 v2, 0
  s_mov_b32 s47, 0
WD0_poll:
  buffer_load_dword v3, v2, s[8:11], 0 offen offset:128 sc1
  s_add_u32 s47, s47, 1
  s_waitcnt vmcnt(0)
  v_readfirstlane_b32 s46, v3
  s_cmp_gt_u32 s47, 131072
  s_cbranch_scc1 WD0_done
  s_cmp_eq_u32 s46, 1
  s_cbranch_scc1 WD0_done
  s_sleep 4
  s_branch WD0_poll
WD0_done:
  s_barrier
  s_and_b32 s36, s100, 7
  s_lshr_b32 s37, s100, 3
  v_lshlrev_b32 v1, 4, v0
  s_lshr_b32 s15, s36, 2
  s_lshl_b32 s15, s15, 3
  s_lshr_b32 s13, s37, 2
  s_add_u32 s15, s15, s13
  s_mul_i32 s15, s15, 136192
  s_add_u32 s15, s15, 16220160
  s_mul_i32 s13, s3, 9216
  s_add_u32 s12, s15, s13
  s_add_u32 s12, s12, 0
  s_add_u32 m0, s13, 0
  s_nop 0
  buffer_load_dwordx4 v1, s[4:7], s12 offen offset:0 sc1 lds
  buffer_load_dwordx4 v1, s[4:7], s12 offen offset:1024 sc1 lds
  buffer_load_dwordx4 v1, s[4:7], s12 offen offset:2048 sc1 lds
  buffer_load_dwordx4 v1, s[4:7], s12 offen offset:3072 sc1 lds
  s_add_u32 s12, s12, 4096
  s_add_u32 m0, m0, 4096
  s_nop 0
  buffer_load_dwordx4 v1, s[4:7], s12 offen offset:0 sc1 lds
  buffer_load_dwordx4 v1, s[4:7], s12 offen offset:1024 sc1 lds
  buffer_load_dwordx4 v1, s[4:7], s12 offen offset:2048 sc1 lds
  buffer_load_dwordx4 v1, s[4:7], s12 offen offset:3072 sc1 lds
  s_add_u32 s12, s12, 4096
  s_add_u32 m0, m0, 4096
  s_nop 0
  buffer_load_dwordx4 v1, s[4:7], s12 offen offset:0 sc1 lds
  s_lshr_b32 s15, s36, 2
  s_lshl_b32 s15, s15, 3
  s_lshr_b32 s13, s37, 2
  s_add_u32 s15, s15, s13
  s_mul_i32 s15, s15, 136192
  s_add_u32 s15, s15, 16220160
  s_mul_i32 s13, s3, 9216
  s_add_u32 s12, s15, s13
  s_add_u32 s12, s12, 36864
  s_add_u32 m0, s13, 36864
  s_nop 0
  buffer_load_dwordx4 v1, s[4:7], s12 offen offset:0 sc1 lds
  buffer_load_dwordx4 v1, s[4:7], s12 offen offset:1024 sc1 lds
  buffer_load_dwordx4 v1, s[4:7], s12 offen offset:2048 sc1 lds
  buffer_load_dwordx4 v1, s[4:7], s12 offen offset:3072 sc1 lds
  s_add_u32 s12, s12, 4096
  s_add_u32 m0, m0, 4096
  s_nop 0
  buffer_load_dwordx4 v1, s[4:7], s12 offen offset:0 sc1 lds
  buffer_load_dwordx4 v1, s[4:7], s12 offen offset:1024 sc1 lds
  buffer_load_dwordx4 v1, s[4:7], s12 offen offset:2048 sc1 lds
  buffer_load_dwordx4 v1, s[4:7], s12 offen offset:3072 sc1 lds
  s_add_u32 s12, s12, 4096
  s_add_u32 m0, m0, 4096
  s_nop 0
  buffer_load_dwordx4 v1, s[4:7], s12 offen offset:0 sc1 lds
  s_lshr_b32 s15, s36, 2
  s_lshl_b32 s15, s15, 3
  s_lshr_b32 s13, s37, 2
  s_add_u32 s15, s15, s13
  s_mul_i32 s15, s15, 136192
  s_add_u32 s15, s15, 16220160
  s_mul_i32 s13, s3, 8192
  s_add_u32 s12, s15, s13
  s_add_u32 s12, s12, 73728
  s_add_u32 m0, s13, 73728
  s_nop 0
  buffer_load_dwordx4 v1, s[4:7], s12 offen offset:0 sc1 lds
  buffer_load_dwordx4 v1, s[4:7], s12 offen offset:1024 sc1 lds
  buffer_load_dwordx4 v1, s[4:7], s12 offen offset:2048 sc1 lds
  buffer_load_dwordx4 v1, s[4:7], s12 offen offset:3072 sc1 lds
  s_add_u32 s12, s12, 4096
  s_add_u32 m0, m0, 4096
  s_nop 0
  buffer_load_dwordx4 v1, s[4:7], s12 offen offset:0 sc1 lds
  buffer_load_dwordx4 v1, s[4:7], s12 offen offset:1024 sc1 lds
  buffer_load_dwordx4 v1, s[4:7], s12 offen offset:2048 sc1 lds
  buffer_load_dwordx4 v1, s[4:7], s12 offen offset:3072 sc1 lds
  s_mov_b32 s2, s100
  s_and_b32 s36, s100, 7
  s_lshr_b32 s37, s100, 3
  v_lshlrev_b32 v1, 4, v0
M_layer:
  s_and_b32 s38, s36, 3
  s_lshl_b32 s38, s38, 2
  s_and_b32 s39, s37, 3
  s_add_u32 s38, s38, s39
  s_lshr_b32 s39, s36, 2
  s_lshl_b32 s39, s39, 3
  s_lshr_b32 s40, s37, 2
  s_add_u32 s39, s39, s40
  s_lshl_b32 s41, s38, 2
  s_add_u32 s41, s41, s3
  v_and_b32 v5, 15, v0
  v_lshrrev_b32 v6, 4, v0
  s_mul_i32 s45, s41, 36864
  s_add_u32 s45, s45, 0
  s_add_u32 s45, s45, s50
  v_lshlrev_b32 v9, 4, v5
  v_lshl_add_u32 v9, v6, 9, v9
  s_lshl_b32 s42, s41, 12
  s_add_u32 s42, s42, 5472256
  s_add_u32 s42, s42, s50
  v_lshlrev_b32 v7, 7, v5
  v_lshl_add_u32 v7, v6, 5, v7
  s_mov_b32 s52, 0x42000000
  s_cmp_eq_u32 s3, 0
  s_cselect_b32 s52, 0x42400000, s52
  s_mov_b32 s53, 0x42000000
  s_cmp_eq_u32 s3, 1
  s_cselect_b32 s53, 0x42400000, s53
  s_mov_b32 s54, 0x42000000
  s_cmp_eq_u32 s3, 2
  s_cselect_b32 s54, 0x42400000, s54
  s_mov_b32 s55, 0x42000000
  s_cmp_eq_u32 s3, 3
  s_cselect_b32 s55, 0x42400000, s55
  v_add_u32 v15, 0x10000, v1
  v_add_u32 v4, 0x20000, v1
  s_mul_i32 s46, s39, 3648
  s_add_u32 s46, s46, 4980736
  s_add_u32 s46, s46, s50
  s_add_u32 s8, s34, s46
  s_addc_u32 s9, s35, 0
  s_and_b32 s9, s9, 0xffff
  s_movk_i32 s10, 3648
  s_mov_b32 s11, 0x20000
  v_mul_u32_u24 v8, 384, v6
  v_lshl_add_u32 v8, v5, 2, v8
  v_cmp_eq_u32 s[62:63], 2, v6
  v_add_u32 v14, 139264, v1
  s_lshl_b32 s46, s3, 2
  s_lshr_b32 s47, 0x3232, s46
  s_and_b32 s47, s47, 7
  s_lshl_b32 s47, s47, 12
  v_add_u32 v250, s47, v14
  s_lshr_b32 s47, 0x4410, s46
  s_and_b32 s47, s47, 7
  s_lshl_b32 s47, s47, 12
  v_add_u32 v251, s47, v14
  s_mov_b32 s96, 0xffffffff
  s_mov_b32 s97, 0xffffffff
  s_mov_b32 s60, 0
  s_mov_b32 s47, 0
  s_cmp_eq_u32 s3, 1
  s_cselect_b32 s96, 0xffffffff, s96
  s_cselect_b32 s97, 0xffffffff, s97
  s_cselect_b32 s60, 1832, s60
  s_cmp_eq_u32 s3, 2
  s_cselect_b32 s96, 0x30003, s96
  s_cselect_b32 s97, 0x30003, s97
  s_cselect_b32 s60, 64, s60
  s_cmp_eq_u32 s3, 3
  s_cselect_b32 s96, 0xc000c, s96
  s_cselect_b32 s97, 0xc000c, s97
  s_cselect_b32 s60, 1888, s60
  v_mov_b32 v2, s47
  v_cndmask_b32 v2, 0, v2, s[62:63]
  v_add3_u32 v254, v8, v2, s60
  s_lshl_b32 s46, s3, 2
  s_lshr_b32 s47, 0x4444, s46
  s_and_b32 s47, s47, 7
  s_lshl_b32 s47, s47, 12
  v_add_u32 v252, s47, v14
  s_lshr_b32 s47, 0x4410, s46
  s_and_b32 s47, s47, 7
  s_lshl_b32 s47, s47, 12
  v_add_u32 v253, s47, v14
  s_mov_b32 s98, 0xffff0000
  s_mov_b32 s99, 0x0
  s_mov_b32 s61, 1152
  s_mov_b32 s47, 0
  s_cmp_eq_u32 s3, 1
  s_cselect_b32 s98, 0x0, s98
  s_cselect_b32 s99, 0xffff, s99
  s_cselect_b32 s61, 2600, s61
  s_cmp_eq_u32 s3, 2
  s_cselect_b32 s98, 0x30000, s98
  s_cselect_b32 s99, 0xc, s99
  s_cselect_b32 s61, 1216, s61
  s_cselect_b32 s47, 1440, s47
  s_cmp_eq_u32 s3, 3
  s_cselect_b32 s98, 0x0, s98
  s_cselect_b32 s99, 0x0, s99
  s_cselect_b32 s61, 0, s61
  v_mov_b32 v2, s47
  v_cndmask_b32 v2, 0, v2, s[62:63]
  v_add3_u32 v255, v8, v2, s61
  s_lshl_b32 s46, s3, 6
  v_add_u32 v2, s46, v0
  v_mul_u32_u24 v8, 2731, v2
  v_lshrrev_b32 v8, 16, v8
  v_mul_u32_u24 v8, 24, v8
  v_sub_u32 v8, v2, v8
  v_cmp_le_u32 vcc, 456, v2
  s_nop 1
  v_cndmask_b32 v14, 0, 2, vcc
  v_sub_u32 v8, v8, v14
  v_cmp_gt_u32 s[16:17], 18, v8
  v_add_u32 v2, s46, v0
  v_add_u32 v2, 256, v2
  v_mul_u32_u24 v8, 2731, v2
  v_lshrrev_b32 v8, 16, v8
  v_mul_u32_u24 v8, 24, v8
  v_sub_u32 v8, v2, v8
  v_cmp_le_u32 vcc, 456, v2
  s_nop 1
  v_cndmask_b32 v14, 0, 2, vcc
  v_sub_u32 v8, v8, v14
  v_cmp_gt_u32 s[18:19], 18, v8
  v_add_u32 v2, s46, v0
  v_add_u32 v2, 512, v2
  v_mul_u32_u24 v8, 2731, v2
  v_lshrrev_b32 v8, 16, v8
  v_mul_u32_u24 v8, 24, v8
  v_sub_u32 v8, v2, v8
  v_cmp_le_u32 vcc, 456, v2
  s_nop 1
  v_cndmask_b32 v14, 0, 2, vcc
  v_sub_u32 v8, v8, v14
  v_cmp_gt_u32 s[20:21], 18, v8
  v_add_u32 v2, s46, v0
  v_add_u32 v2, 768, v2
  v_mul_u32_u24 v8, 2731, v2
  v_lshrrev_b32 v8, 16, v8
  v_mul_u32_u24 v8, 24, v8
  v_sub_u32 v8, v2, v8
  v_cmp_le_u32 vcc, 456, v2
  s_nop 1
  v_cndmask_b32 v14, 0, 2, vcc
  v_sub_u32 v8, v8, v14
  v_cmp_gt_u32 s[22:23], 18, v8
  s_cmp_lg_u32 s3, 0
  s_cbranch_scc1 W4_done
  s_cmp_eq_u32 s51, 0
  s_cbranch_scc1 W4_done
  s_lshl_b32 s46, s38, 11
  s_add_u32 s46, s46, 24412160
  v_and_b32 v2, 15, v0
  v_lshlrev_b32 v2, 7, v2
  s_mov_b32 s47, 0
W4_poll:
  buffer_load_dword v3, v2, s[4:7], s46 offen sc1
  s_add_u32 s47, s47, 1
  s_waitcnt vmcnt(0)
  v_cmp_ne_u32 vcc, 1, v3
  s_cmp_gt_u32 s47, 131072
  s_cbranch_scc1 W4_done
  s_cmp_eq_u64 vcc, 0
  s_cbranch_scc0 W4_poll
W4_done:
  s_waitcnt vmcnt(0) lgkmcnt(0)
  s_barrier
  buffer_load_dwordx4 v[16:19], v9, s[4:7], s45 offen offset:0 sc1
  buffer_load_dwordx4 v[20:23], v9, s[4:7], s45 offen offset:256 sc1
  buffer_load_dwordx4 v[24:27], v9, s[4:7], s45 offen offset:2048 sc1
  buffer_load_dwordx4 v[28:31], v9, s[4:7], s45 offen offset:2304 sc1
  s_add_u32 s45, s45, 4096
  buffer_load_dwordx4 v[32:35], v9, s[4:7], s45 offen offset:0 sc1
  buffer_load_dwordx4 v[36:39], v9, s[4:7], s45 offen offset:256 sc1
  buffer_load_dwordx4 v[40:43], v9, s[4:7], s45 offen offset:2048 sc1
  buffer_load_dwordx4 v[44:47], v9, s[4:7], s45 offen offset:2304 sc1
  s_add_u32 s45, s45, 4096
  buffer_load_dwordx4 v[48:51], v9, s[4:7], s45 offen offset:0 sc1
  buffer_load_dwordx4 v[52:55], v9, s[4:7], s45 offen offset:256 sc1
  buffer_load_dwordx4 v[56:59], v9, s[4:7], s45 offen offset:2048 sc1
  buffer_load_dwordx4 v[60:63], v9, s[4:7], s45 offen offset:2304 sc1
  s_add_u32 s45, s45, 4096
  ds_read_b128 a[180:183], v1 offset:0
  ds_read_b128 a[184:187], v1 offset:1024
  ds_read_b128 a[188:191], v1 offset:2048
  ds_read_b128 a[192:195], v1 offset:3072
  ds_read_b128 a[196:199], v1 offset:4096
  ds_read_b128 a[200:203], v1 offset:5120
  ds_read_b128 a[204:207], v1 offset:6144
  ds_read_b128 a[208:211], v1 offset:7168
  ds_read_b128 a[212:215], v1 offset:8192
  ds_read_b128 a[216:219], v1 offset:9216
  s_waitcnt vmcnt(10)
  s_waitcnt lgkmcnt(9)
  v_mfma_f32_16x16x32_bf16 v[168:171], v[16:19], a[180:183], 0
  buffer_load_dwordx4 v[232:235], v1, s[4:7], s42 offen offset:0 sc1
  v_mfma_f32_16x16x32_bf16 v[172:175], v[20:23], a[180:183], 0
  ds_read_b128 a[180:183], v1 offset:10240
  s_waitcnt lgkmcnt(9)
  v_mfma_f32_16x16x32_bf16 v[176:179], v[16:19], a[184:187], 0
  buffer_load_dwordx4 v[236:239], v1, s[4:7], s42 offen offset:1024 sc1
  v_mfma_f32_16x16x32_bf16 v[180:183], v[20:23], a[184:187], 0
  ds_read_b128 a[184:187], v1 offset:11264
  s_waitcnt lgkmcnt(9)
  v_mfma_f32_16x16x32_bf16 v[184:187], v[16:19], a[188:191], 0
  v_mfma_f32_16x16x32_bf16 v[188:191], v[20:23], a[188:191], 0
  buffer_load_dwordx4 v[240:243], v1, s[4:7], s42 offen offset:2048 sc1
  ds_read_b128 a[188:191], v1 offset:12288
  s_waitcnt lgkmcnt(9)
  v_mfma_f32_16x16x32_bf16 v[192:195], v[16:19], a[192:195], 0
  v_mfma_f32_16x16x32_bf16 v[196:199], v[20:23], a[192:195], 0
  buffer_load_dwordx4 v[244:247], v1, s[4:7], s42 offen offset:3072 sc1
  ds_read_b128 a[192:195], v1 offset:13312
  s_waitcnt lgkmcnt(9)
  v_mfma_f32_16x16x32_bf16 v[200:203], v[16:19], a[196:199], 0
  v_mfma_f32_16x16x32_bf16 v[204:207], v[20:23], a[196:199], 0
  ds_read_b128 a[196:199], v1 offset:14336
  s_waitcnt vmcnt(12)
  s_waitcnt lgkmcnt(9)
  v_mfma_f32_16x16x32_bf16 v[168:171], v[24:27], a[200:203], v[168:171]
  buffer_load_dwordx4 v[64:67], v9, s[4:7], s45 offen offset:0 sc1
  v_mfma_f32_16x16x32_bf16 v[172:175], v[28:31], a[200:203], v[172:175]
  ds_read_b128 a[200:203], v1 offset:15360
  s_waitcnt lgkmcnt(9)
  v_mfma_f32_16x16x32_bf16 v[176:179], v[24:27], a[204:207], v[176:179]
  buffer_load_dwordx4 v[68:71], v9, s[4:7], s45 offen offset:256 sc1
  v_mfma_f32_16x16x32_bf16 v[180:183], v[28:31], a[204:207], v[180:183]
  ds_read_b128 a[204:207], v1 offset:16384
  s_waitcnt lgkmcnt(9)
  v_mfma_f32_16x16x32_bf16 v[184:187], v[24:27], a[208:211], v[184:187]
  v_mfma_f32_16x16x32_bf16 v[188:191], v[28:31], a[208:211], v[188:191]
  buffer_load_dwordx4 v[72:75], v9, s[4:7], s45 offen offset:2048 sc1
  ds_read_b128 a[208:211], v1 offset:17408
  s_waitcnt lgkmcnt(9)
  v_mfma_f32_16x16x32_bf16 v[192:195], v[24:27], a[212:215], v[192:195]
  v_mfma_f32_16x16x32_bf16 v[196:199], v[28:31], a[212:215], v[196:199]
  buffer_load_dwordx4 v[76:79], v9, s[4:7], s45 offen offset:2304 sc1
  s_add_u32 s45, s45, 4096
  ds_read_b128 a[212:215], v1 offset:18432
  s_waitcnt lgkmcnt(9)
  v_mfma_f32_16x16x32_bf16 v[200:203], v[24:27], a[216:219], v[200:203]
  v_mfma_f32_16x16x32_bf16 v[204:207], v[28:31], a[216:219], v[204:207]
  ds_read_b128 a[216:219], v1 offset:19456
  s_waitcnt vmcnt(14)
  s_waitcnt lgkmcnt(9)
  v_mfma_f32_16x16x32_bf16 v[168:171], v[32:35], a[180:183], v[168:171]
  buffer_load_dwordx4 v[80:83], v9, s[4:7], s45 offen offset:0 sc1
  v_mfma_f32_16x16x32_bf16 v[172:175], v[36:39], a[180:183], v[172:175]
  ds_read_b128 a[180:183], v1 offset:20480
  s_waitcnt lgkmcnt(9)
  v_mfma_f32_16x16x32_bf16 v[176:179], v[32:35], a[184:187], v[176:179]
  buffer_load_dwordx4 v[84:87], v9, s[4:7], s45 offen offset:256 sc1
  v_mfma_f32_16x16x32_bf16 v[180:183], v[36:39], a[184:187], v[180:183]
  ds_read_b128 a[184:187], v1 offset:21504
  s_waitcnt lgkmcnt(9)
  v_mfma_f32_16x16x32_bf16 v[184:187], v[32:35], a[188:191], v[184:187]
  v_mfma_f32_16x16x32_bf16 v[188:191], v[36:39], a[188:191], v[188:191]
  ds_read_b128 a[188:191], v1 offset:22528
  s_waitcnt lgkmcnt(9)
  v_mfma_f32_16x16x32_bf16 v[192:195], v[32:35], a[192:195], v[192:195]
  v_mfma_f32_16x16x32_bf16 v[196:199], v[36:39], a[192:195], v[196:199]
  ds_read_b128 a[192:195], v1 offset:23552
  s_waitcnt lgkmcnt(9)
  v_mfma_f32_16x16x32_bf16 v[200:203], v[32:35], a[196:199], v[200:203]
  v_mfma_f32_16x16x32_bf16 v[204:207], v[36:39], a[196:199], v[204:207]
  ds_read_b128 a[196:199], v1 offset:24576
  s_waitcnt vmcnt(14)
  s_waitcnt lgkmcnt(9)
  v_mfma_f32_16x16x32_bf16 v[168:171], v[40:43], a[200:203], v[168:171]
  buffer_load_dwordx4 v[88:91], v9, s[4:7], s45 offen offset:2048 sc1
  v_mfma_f32_16x16x32_bf16 v[172:175], v[44:47], a[200:203], v[172:175]
  ds_read_b128 a[200:203], v1 offset:25600
  s_waitcnt lgkmcnt(9)
  v_mfma_f32_16x16x32_bf16 v[176:179], v[40:43], a[204:207], v[176:179]
  buffer_load_dwordx4 v[92:95], v9, s[4:7], s45 offen offset:2304 sc1
  s_add_u32 s45, s45, 4096
  v_mfma_f32_16x16x32_bf16 v[180:183], v[44:47], a[204:207], v[180:183]
  ds_read_b128 a[204:207], v1 offset:26624
  s_waitcnt lgkmcnt(9)
  v_mfma_f32_16x16x32_bf16 v[184:187], v[40:43], a[208:211], v[184:187]
  v_mfma_f32_16x16x32_bf16 v[188:191], v[44:47], a[208:211], v[188:191]
  ds_read_b128 a[208:211], v1 offset:27648
  s_waitcnt lgkmcnt(9)
  v_mfma_f32_16x16x32_bf16 v[192:195], v[40:43], a[212:215], v[192:195]
  v_mfma_f32_16x16x32_bf16 v[196:199], v[44:47], a[212:215], v[196:199]
  ds_read_b128 a[212:215], v1 offset:28672
  s_waitcnt lgkmcnt(9)
  v_mfma_f32_16x16x32_bf16 v[200:203], v[40:43], a[216:219], v[200:203]
  v_mfma_f32_16x16x32_bf16 v[204:207], v[44:47], a[216:219], v[204:207]
  ds_read_b128 a[216:219], v1 offset:29696
  s_waitcnt vmcnt(14)
  s_waitcnt lgkmcnt(9)
  v_mfma_f32_16x16x32_bf16 v[168:171], v[48:51], a[180:183], v[168:171]
  buffer_load_dwordx4 v[96:99], v9, s[4:7], s45 offen offset:0 sc1
  v_mfma_f32_16x16x32_bf16 v[172:175], v[52:55], a[180:183], v[172:175]
  ds_read_b128 a[180:183], v1 offset:30720
  s_waitcnt lgkmcnt(9)
  v_mfma_f32_16x16x32_bf16 v[176:179], v[48:51], a[184:187], v[176:179]
  buffer_load_dwordx4 v[100:103], v9, s[4:7], s45 offen offset:256 sc1
  v_mfma_f32_16x16x32_bf16 v[180:183], v[52:55], a[184:187], v[180:183]
  ds_read_b128 a[184:187], v1 offset:31744
  s_waitcnt lgkmcnt(9)
  v_mfma_f32_16x16x32_bf16 v[184:187], v[48:51], a[188:191], v[184:187]
  v_mfma_f32_16x16x32_bf16 v[188:191], v[52:55], a[188:191], v[188:191]
  ds_read_b128 a[188:191], v1 offset:32768
  s_waitcnt lgkmcnt(9)
  v_mfma_f32_16x16x32_bf16 v[192:195], v[48:51], a[192:195], v[192:195]
  v_mfma_f32_16x16x32_bf16 v[196:199], v[52:55], a[192:195], v[196:199]
  ds_read_b128 a[192:195], v1 offset:33792
  s_waitcnt lgkmcnt(9)
  v_mfma_f32_16x16x32_bf16 v[200:203], v[48:51], a[196:199], v[200:203]
  v_mfma_f32_16x16x32_bf16 v[204:207], v[52:55], a[196:199], v[204:207]
  ds_read_b128 a[196:199], v1 offset:34816
  s_waitcnt vmcnt(14)
  s_waitcnt lgkmcnt(9)
  v_mfma_f32_16x16x32_bf16 v[168:171], v[56:59], a[200:203], v[168:171]
  buffer_load_dwordx4 v[104:107], v9, s[4:7], s45 offen offset:2048 sc1
  v_mfma_f32_16x16x32_bf16 v[172:175], v[60:63], a[200:203], v[172:175]
  ds_read_b128 a[200:203], v1 offset:35840
  s_waitcnt lgkmcnt(9)
  v_mfma_f32_16x16x32_bf16 v[176:179], v[56:59], a[204:207], v[176:179]
  buffer_load_dwordx4 v[108:111], v9, s[4:7], s45 offen offset:2304 sc1
  s_add_u32 s45, s45, 4096
  v_mfma_f32_16x16x32_bf16 v[180:183], v[60:63], a[204:207], v[180:183]
  ds_read_b128 a[204:207], v1 offset:36864
  s_waitcnt lgkmcnt(9)
  v_mfma_f32_16x16x32_bf16 v[184:187], v[56:59], a[208:211], v[184:187]
  v_mfma_f32_16x16x32_bf16 v[188:191], v[60:63], a[208:211], v[188:191]
  ds_read_b128 a[208:211], v1 offset:37888
  s_waitcnt lgkmcnt(9)
  v_mfma_f32_16x16x32_bf16 v[192:195], v[56:59], a[212:215], v[192:195]
  v_mfma_f32_16x16x32_bf16 v[196:199], v[60:63], a[212:215], v[196:199]
  ds_read_b128 a[212:215], v1 offset:38912
  s_waitcnt lgkmcnt(9)
  v_mfma_f32_16x16x32_bf16 v[200:203], v[56:59], a[216:219], v[200:203]
  v_mfma_f32_16x16x32_bf16 v[204:207], v[60:63], a[216:219], v[204:207]
  ds_read_b128 a[216:219], v1 offset:39936
  s_waitcnt vmcnt(10)
  s_waitcnt lgkmcnt(9)
  v_mfma_f32_16x16x32_bf16 v[168:171], v[64:67], a[180:183], v[168:171]
  buffer_load_dwordx4 v[112:115], v9, s[4:7], s45 offen offset:0 sc1
  v_mfma_f32_16x16x32_bf16 v[172:175], v[68:71], a[180:183], v[172:175]
  ds_read_b128 a[180:183], v1 offset:40960
  s_waitcnt lgkmcnt(9)
  v_mfma_f32_16x16x32_bf16 v[176:179], v[64:67], a[184:187], v[176:179]
  buffer_load_dwordx4 v[116:119], v9, s[4:7], s45 offen offset:256 sc1
  v_mfma_f32_16x16x32_bf16 v[180:183], v[68:71], a[184:187], v[180:183]
  v_mul_f32 v10, s52, v232
  ds_read_b128 a[184:187], v1 offset:41984
  s_waitcnt lgkmcnt(9)
  v_mfma_f32_16x16x32_bf16 v[184:187], v[64:67], a[188:191], v[184:187]
  v_fmac_f32 v10, s53, v234
  v_mfma_f32_16x16x32_bf16 v[188:191], v[68:71], a[188:191], v[188:191]
  v_fmac_f32 v10, s54, v236
  ds_read_b128 a[188:191], v1 offset:43008
  s_waitcnt lgkmcnt(9)
  v_mfma_f32_16x16x32_bf16 v[192:195], v[64:67], a[192:195], v[192:195]
  v_fmac_f32 v10, s55, v238
  v_mfma_f32_16x16x32_bf16 v[196:199], v[68:71], a[192:195], v[196:199]
  v_mul_f32 v10, 0x3ae38e39, v10
  ds_read_b128 a[192:195], v1 offset:44032
  s_waitcnt lgkmcnt(9)
  v_mfma_f32_16x16x32_bf16 v[200:203], v[64:67], a[196:199], v[200:203]
  v_mov_b32 v12, v10
  v_mfma_f32_16x16x32_bf16 v[204:207], v[68:71], a[196:199], v[204:207]
  s_nop 0
  v_permlane16_swap_b32 v10, v12
  ds_read_b128 a[196:199], v1 offset:45056
  s_waitcnt vmcnt(10)
  s_waitcnt lgkmcnt(9)
  v_mfma_f32_16x16x32_bf16 v[168:171], v[72:75], a[200:203], v[168:171]
  buffer_load_dwordx4 v[120:123], v9, s[4:7], s45 offen offset:2048 sc1
  v_add_f32 v10, v10, v12
  v_mfma_f32_16x16x32_bf16 v[172:175], v[76:79], a[200:203], v[172:175]
  v_mov_b32 v12, v10
  ds_read_b128 a[200:203], v1 offset:46080
  s_waitcnt lgkmcnt(9)
  v_mfma_f32_16x16x32_bf16 v[176:179], v[72:75], a[204:207], v[176:179]
  buffer_load_dwordx4 v[124:127], v9, s[4:7], s45 offen offset:2304 sc1
  s_add_u32 s45, s45, 4096
  v_permlane32_swap_b32 v10, v12
  v_mfma_f32_16x16x32_bf16 v[180:183], v[76:79], a[204:207], v[180:183]
  v_add_f32 v10, v10, v12
  ds_read_b128 a[204:207], v1 offset:47104
  s_waitcnt lgkmcnt(9)
  v_mfma_f32_16x16x32_bf16 v[184:187], v[72:75], a[208:211], v[184:187]
  v_mov_b32 v11, v233
  v_mfma_f32_16x16x32_bf16 v[188:191], v[76:79], a[208:211], v[188:191]
  v_add_f32 v11, v11, v235
  ds_read_b128 a[208:211], v1 offset:48128
  s_waitcnt lgkmcnt(9)
  v_mfma_f32_16x16x32_bf16 v[192:195], v[72:75], a[212:215], v[192:195]
  v_add_f32 v11, v11, v237
  v_mfma_f32_16x16x32_bf16 v[196:199], v[76:79], a[212:215], v[196:199]
  v_add_f32 v11, v11, v239
  ds_read_b128 a[212:215], v1 offset:49152
  s_waitcnt lgkmcnt(9)
  v_mfma_f32_16x16x32_bf16 v[200:203], v[72:75], a[216:219], v[200:203]
  v_sub_f32 v232, v232, v10
  v_mfma_f32_16x16x32_bf16 v[204:207], v[76:79], a[216:219], v[204:207]
  v_mul_f32 v232, v232, v232
  ds_read_b128 a[216:219], v1 offset:50176
  s_waitcnt vmcnt(10)
  s_waitcnt lgkmcnt(9)
  v_mfma_f32_16x16x32_bf16 v[168:171], v[80:83], a[180:183], v[168:171]
  buffer_load_dwordx4 v[128:131], v9, s[4:7], s45 offen offset:0 sc1
  v_fmac_f32 v11, s52, v232
  v_mfma_f32_16x16x32_bf16 v[172:175], v[84:87], a[180:183], v[172:175]
  v_sub_f32 v234, v234, v10
  ds_read_b128 a[180:183], v1 offset:51200
  s_waitcnt lgkmcnt(9)
  v_mfma_f32_16x16x32_bf16 v[176:179], v[80:83], a[184:187], v[176:179]
  buffer_load_dwordx4 v[132:135], v9, s[4:7], s45 offen offset:256 sc1
  v_mul_f32 v234, v234, v234
  v_mfma_f32_16x16x32_bf16 v[180:183], v[84:87], a[184:187], v[180:183]
  v_fmac_f32 v11, s53, v234
  ds_read_b128 a[184:187], v1 offset:52224
  s_waitcnt lgkmcnt(9)
  v_mfma_f32_16x16x32_bf16 v[184:187], v[80:83], a[188:191], v[184:187]
  v_sub_f32 v236, v236, v10
  v_mfma_f32_16x16x32_bf16 v[188:191], v[84:87], a[188:191], v[188:191]
  v_mul_f32 v236, v236, v236
  ds_read_b128 a[188:191], v1 offset:53248
  s_waitcnt lgkmcnt(9)
  v_mfma_f32_16x16x32_bf16 v[192:195], v[80:83], a[192:195], v[192:195]
  v_fmac_f32 v11, s54, v236
  v_mfma_f32_16x16x32_bf16 v[196:199], v[84:87], a[192:195], v[196:199]
  v_sub_f32 v238, v238, v10
  ds_read_b128 a[192:195], v1 offset:54272
  s_waitcnt lgkmcnt(9)
  v_mfma_f32_16x16x32_bf16 v[200:203], v[80:83], a[196:199], v[200:203]
  v_mul_f32 v238, v238, v238
  v_mfma_f32_16x16x32_bf16 v[204:207], v[84:87], a[196:199], v[204:207]
  v_fmac_f32 v11, s55, v238
  ds_read_b128 a[196:199], v1 offset:55296
  s_waitcnt vmcnt(10)
  s_waitcnt lgkmcnt(9)
  v_mfma_f32_16x16x32_bf16 v[168:171], v[88:91], a[200:203], v[168:171]
  buffer_load_dwordx4 v[136:139], v9, s[4:7], s45 offen offset:2048 sc1
  v_mov_b32 v12, v11
  v_mfma_f32_16x16x32_bf16 v[172:175], v[92:95], a[200:203], v[172:175]
  s_nop 0
  v_permlane16_swap_b32 v11, v12
  ds_read_b128 a[200:203], v1 offset:56320
  s_waitcnt lgkmcnt(9)
  v_mfma_f32_16x16x32_bf16 v[176:179], v[88:91], a[204:207], v[176:179]
  buffer_load_dwordx4 v[140:143], v9, s[4:7], s45 offen offset:2304 sc1
  s_add_u32 s45, s45, 4096
  v_add_f32 v11, v11, v12
  v_mfma_f32_16x16x32_bf16 v[180:183], v[92:95], a[204:207], v[180:183]
  v_mov_b32 v12, v11
  ds_read_b128 a[204:207], v1 offset:57344
  s_waitcnt lgkmcnt(9)
  v_mfma_f32_16x16x32_bf16 v[184:187], v[88:91], a[208:211], v[184:187]
  v_permlane32_swap_b32 v11, v12
  v_mfma_f32_16x16x32_bf16 v[188:191], v[92:95], a[208:211], v[188:191]
  v_add_f32 v11, v11, v12
  ds_read_b128 a[208:211], v1 offset:58368
  s_waitcnt lgkmcnt(9)
  v_mfma_f32_16x16x32_bf16 v[192:195], v[88:91], a[212:215], v[192:195]
  v_mul_f32 v11, 0x3ae38e39, v11
  v_mfma_f32_16x16x32_bf16 v[196:199], v[92:95], a[212:215], v[196:199]
  v_cvt_pk_bf16_f32 v160, -v10, -v10
  ds_read_b128 a[212:215], v1 offset:59392
  s_waitcnt lgkmcnt(9)
  v_mfma_f32_16x16x32_bf16 v[200:203], v[88:91], a[216:219], v[200:203]
  v_mfma_f32_16x16x32_bf16 v[204:207], v[92:95], a[216:219], v[204:207]
  v_cvt_pk_bf16_f32 v11, v11, v11
  ds_read_b128 a[216:219], v1 offset:60416
  s_waitcnt vmcnt(10)
  s_waitcnt lgkmcnt(9)
  v_mfma_f32_16x16x32_bf16 v[168:171], v[96:99], a[180:183], v[168:171]
  buffer_load_dwordx4 v[144:147], v9, s[4:7], s45 offen offset:0 sc1
  v_lshlrev_b32 v11, 16, v11
  v_mfma_f32_16x16x32_bf16 v[172:175], v[100:103], a[180:183], v[172:175]
  v_add_f32 v11, 0x3727c5ac, v11
  ds_read_b128 a[180:183], v1 offset:61440
  s_waitcnt lgkmcnt(9)
  v_mfma_f32_16x16x32_bf16 v[176:179], v[96:99], a[184:187], v[176:179]
  buffer_load_dwordx4 v[148:151], v9, s[4:7], s45 offen offset:256 sc1
  v_cvt_pk_bf16_f32 v11, v11, v11
  v_mfma_f32_16x16x32_bf16 v[180:183], v[100:103], a[184:187], v[180:183]
  v_lshlrev_b32 v11, 16, v11
  ds_read_b128 a[184:187], v1 offset:62464
  s_waitcnt lgkmcnt(9)
  v_mfma_f32_16x16x32_bf16 v[184:187], v[96:99], a[188:191], v[184:187]
  v_sqrt_f32 v11, v11
  v_mfma_f32_16x16x32_bf16 v[188:191], v[100:103], a[188:191], v[188:191]
  v_cvt_pk_bf16_f32 v12, v11, v11
  ds_read_b128 a[188:191], v1 offset:63488
  s_waitcnt lgkmcnt(9)
  v_mfma_f32_16x16x32_bf16 v[192:195], v[96:99], a[192:195], v[192:195]
  v_lshlrev_b32 v12, 16, v12
  v_mfma_f32_16x16x32_bf16 v[196:199], v[100:103], a[192:195], v[196:199]
  v_rcp_f32 v12, v12
  ds_read_b128 a[192:195], v1 offset:64512
  s_waitcnt lgkmcnt(9)
  v_mfma_f32_16x16x32_bf16 v[200:203], v[96:99], a[196:199], v[200:203]
  v_mov_b32 v161, v160
  v_mfma_f32_16x16x32_bf16 v[204:207], v[100:103], a[196:199], v[204:207]
  v_mov_b32 v162, v160
  ds_read_b128 a[196:199], v15 offset:0
  s_waitcnt vmcnt(10)
  s_waitcnt lgkmcnt(9)
  v_mfma_f32_16x16x32_bf16 v[168:171], v[104:107], a[200:203], v[168:171]
  buffer_load_dwordx4 v[152:155], v9, s[4:7], s45 offen offset:2048 sc1
  v_mov_b32 v163, v160
  v_mfma_f32_16x16x32_bf16 v[172:175], v[108:111], a[200:203], v[172:175]
  v_mul_f32 v248, 0x3fb8aa3b, v12
  ds_read_b128 a[200:203], v15 offset:1024
  s_waitcnt lgkmcnt(9)
  v_mfma_f32_16x16x32_bf16 v[176:179], v[104:107], a[204:207], v[176:179]
  buffer_load_dwordx4 v[156:159], v9, s[4:7], s45 offen offset:2304 sc1
  s_add_u32 s45, s45, 4096
  v_mul_f32 v10, s52, v240
  v_mfma_f32_16x16x32_bf16 v[180:183], v[108:111], a[204:207], v[180:183]
  v_fmac_f32 v10, s53, v242
  ds_read_b128 a[204:207], v15 offset:2048
  s_waitcnt lgkmcnt(9)
  v_mfma_f32_16x16x32_bf16 v[184:187], v[104:107], a[208:211], v[184:187]
  v_fmac_f32 v10, s54, v244
  v_mfma_f32_16x16x32_bf16 v[188:191], v[108:111], a[208:211], v[188:191]
  s_lshr_b32 s15, s36, 2
  s_lshl_b32 s15, s15, 3
  s_lshr_b32 s13, s37, 2
  s_add_u32 s15, s15, s13
  s_mul_i32 s15, s15, 136192
  s_add_u32 s15, s15, 16220160
  s_mul_i32 s13, s3, 8192
  s_add_u32 s12, s15, s13
  s_add_u32 s12, s12, 106496
  s_add_u32 m0, s13, 106496
  s_nop 0
  buffer_load_dwordx4 v1, s[4:7], s12 offen offset:0 sc1 lds
  v_fmac_f32 v10, s55, v246
  ds_read_b128 a[208:211], v15 offset:3072
  s_waitcnt lgkmcnt(9)
  v_mfma_f32_16x16x32_bf16 v[192:195], v[104:107], a[212:215], v[192:195]
  v_mul_f32 v10, 0x3ae38e39, v10
  v_mfma_f32_16x16x32_bf16 v[196:199], v[108:111], a[212:215], v[196:199]
  buffer_load_dwordx4 v1, s[4:7], s12 offen offset:1024 sc1 lds
  v_mov_b32 v13, v10
  ds_read_b128 a[212:215], v15 offset:4096
  s_waitcnt lgkmcnt(9)
  v_mfma_f32_16x16x32_bf16 v[200:203], v[104:107], a[216:219], v[200:203]
  v_permlane16_swap_b32 v10, v13
  v_mfma_f32_16x16x32_bf16 v[204:207], v[108:111], a[216:219], v[204:207]
  v_add_f32 v10, v10, v13
  ds_read_b128 a[216:219], v15 offset:5120
  s_waitcnt vmcnt(12)
  s_waitcnt lgkmcnt(9)
  v_mfma_f32_16x16x32_bf16 v[168:171], v[112:115], a[180:183], v[168:171]
  buffer_load_dwordx4 v1, s[4:7], s12 offen offset:2048 sc1 lds
  v_mov_b32 v13, v10
  v_mfma_f32_16x16x32_bf16 v[172:175], v[116:119], a[180:183], v[172:175]
  s_nop 0
  v_permlane32_swap_b32 v10, v13
  ds_read_b128 a[180:183], v15 offset:6144
  s_waitcnt lgkmcnt(9)
  v_mfma_f32_16x16x32_bf16 v[176:179], v[112:115], a[184:187], v[176:179]
  buffer_load_dwordx4 v1, s[4:7], s12 offen offset:3072 sc1 lds
  s_add_u32 s12, s12, 4096
  s_add_u32 m0, m0, 4096
  v_add_f32 v10, v10, v13
  v_mfma_f32_16x16x32_bf16 v[180:183], v[116:119], a[184:187], v[180:183]
  v_mov_b32 v11, v241
  ds_read_b128 a[184:187], v15 offset:7168
  s_waitcnt lgkmcnt(9)
  v_mfma_f32_16x16x32_bf16 v[184:187], v[112:115], a[188:191], v[184:187]
  v_add_f32 v11, v11, v243
  v_mfma_f32_16x16x32_bf16 v[188:191], v[116:119], a[188:191], v[188:191]
  buffer_load_dwordx4 v1, s[4:7], s12 offen offset:0 sc1 lds
  v_add_f32 v11, v11, v245
  ds_read_b128 a[188:191], v15 offset:8192
  s_waitcnt lgkmcnt(9)
  v_mfma_f32_16x16x32_bf16 v[192:195], v[112:115], a[192:195], v[192:195]
  v_add_f32 v11, v11, v247
  v_mfma_f32_16x16x32_bf16 v[196:199], v[116:119], a[192:195], v[196:199]
  buffer_load_dwordx4 v1, s[4:7], s12 offen offset:1024 sc1 lds
  v_sub_f32 v240, v240, v10
  ds_read_b128 a[192:195], v15 offset:9216
  s_waitcnt lgkmcnt(9)
  v_mfma_f32_16x16x32_bf16 v[200:203], v[112:115], a[196:199], v[200:203]
  v_mul_f32 v240, v240, v240
  v_mfma_f32_16x16x32_bf16 v[204:207], v[116:119], a[196:199], v[204:207]
  v_fmac_f32 v11, s52, v240
  ds_read_b128 a[196:199], v15 offset:10240
  s_waitcnt vmcnt(14)
  s_waitcnt lgkmcnt(9)
  v_mfma_f32_16x16x32_bf16 v[168:171], v[120:123], a[200:203], v[168:171]
  buffer_load_dwordx4 v1, s[4:7], s12 offen offset:2048 sc1 lds
  v_sub_f32 v242, v242, v10
  v_mfma_f32_16x16x32_bf16 v[172:175], v[124:127], a[200:203], v[172:175]
  v_mul_f32 v242, v242, v242
  ds_read_b128 a[200:203], v15 offset:11264
  s_waitcnt lgkmcnt(9)
  v_mfma_f32_16x16x32_bf16 v[176:179], v[120:123], a[204:207], v[176:179]
  buffer_load_dwordx4 v1, s[4:7], s12 offen offset:3072 sc1 lds
  v_fmac_f32 v11, s53, v242
  v_mfma_f32_16x16x32_bf16 v[180:183], v[124:127], a[204:207], v[180:183]
  v_sub_f32 v244, v244, v10
  ds_read_b128 a[204:207], v15 offset:12288
  s_waitcnt lgkmcnt(9)
  v_mfma_f32_16x16x32_bf16 v[184:187], v[120:123], a[208:211], v[184:187]
  v_mfma_f32_16x16x32_bf16 v[188:191], v[124:127], a[208:211], v[188:191]
  s_and_b32 s14, s37, 3
  s_lshl_b32 s14, s14, 2
  s_add_u32 s14, s14, s3
  s_mul_i32 s14, s14, 46080
  s_add_u32 s14, s14, 18399232
  buffer_load_dwordx4 a[0:3], v1, s[4:7], s14 offen offset:0 sc1
  v_mul_f32 v244, v244, v244
  ds_read_b128 a[208:211], v15 offset:13312
  s_waitcnt lgkmcnt(9)
  v_mfma_f32_16x16x32_bf16 v[192:195], v[120:123], a[212:215], v[192:195]
  v_fmac_f32 v11, s54, v244
  v_mfma_f32_16x16x32_bf16 v[196:199], v[124:127], a[212:215], v[196:199]
  buffer_load_dwordx4 a[4:7], v1, s[4:7], s14 offen offset:1024 sc1
  v_sub_f32 v246, v246, v10
  ds_read_b128 a[212:215], v15 offset:14336
  s_waitcnt lgkmcnt(9)
  v_mfma_f32_16x16x32_bf16 v[200:203], v[120:123], a[216:219], v[200:203]
  v_mul_f32 v246, v246, v246
  v_mfma_f32_16x16x32_bf16 v[204:207], v[124:127], a[216:219], v[204:207]
  v_fmac_f32 v11, s55, v246
  ds_read_b128 a[216:219], v15 offset:15360
  s_waitcnt vmcnt(16)
  s_waitcnt lgkmcnt(9)
  v_mfma_f32_16x16x32_bf16 v[168:171], v[128:131], a[180:183], v[168:171]
  buffer_load_dwordx4 a[8:11], v1, s[4:7], s14 offen offset:2048 sc1
  v_mov_b32 v13, v11
  v_mfma_f32_16x16x32_bf16 v[172:175], v[132:135], a[180:183], v[172:175]
  s_nop 0
  v_permlane16_swap_b32 v11, v13
  ds_read_b128 a[180:183], v15 offset:16384
  s_waitcnt lgkmcnt(9)
  v_mfma_f32_16x16x32_bf16 v[176:179], v[128:131], a[184:187], v[176:179]
  buffer_load_dwordx4 a[12:15], v1, s[4:7], s14 offen offset:3072 sc1
  s_add_u32 s14, s14, 4096
  v_add_f32 v11, v11, v13
  v_mfma_f32_16x16x32_bf16 v[180:183], v[132:135], a[184:187], v[180:183]
  v_mov_b32 v13, v11
  ds_read_b128 a[184:187], v15 offset:17408
  s_waitcnt lgkmcnt(9)
  v_mfma_f32_16x16x32_bf16 v[184:187], v[128:131], a[188:191], v[184:187]
  v_permlane32_swap_b32 v11, v13
  v_mfma_f32_16x16x32_bf16 v[188:191], v[132:135], a[188:191], v[188:191]
  buffer_load_dwordx4 a[16:19], v1, s[4:7], s14 offen offset:0 sc1
  v_add_f32 v11, v11, v13
  ds_read_b128 a[188:191], v15 offset:18432
  s_waitcnt lgkmcnt(9)
  v_mfma_f32_16x16x32_bf16 v[192:195], v[128:131], a[192:195], v[192:195]
  v_mul_f32 v11, 0x3ae38e39, v11
  v_mfma_f32_16x16x32_bf16 v[196:199], v[132:135], a[192:195], v[196:199]
  buffer_load_dwordx4 a[20:23], v1, s[4:7], s14 offen offset:1024 sc1
  v_cvt_pk_bf16_f32 v164, -v10, -v10
  ds_read_b128 a[192:195], v15 offset:19456
  s_waitcnt lgkmcnt(9)
  v_mfma_f32_16x16x32_bf16 v[200:203], v[128:131], a[196:199], v[200:203]
  v_cvt_pk_bf16_f32 v11, v11, v11
  v_mfma_f32_16x16x32_bf16 v[204:207], v[132:135], a[196:199], v[204:207]
  v_lshlrev_b32 v11, 16, v11
  ds_read_b128 a[196:199], v15 offset:20480
  s_waitcnt vmcnt(18)
  s_waitcnt lgkmcnt(9)
  v_mfma_f32_16x16x32_bf16 v[168:171], v[136:139], a[200:203], v[168:171]
  buffer_load_dwordx4 a[24:27], v1, s[4:7], s14 offen offset:2048 sc1
  v_add_f32 v11, 0x3727c5ac, v11
  v_mfma_f32_16x16x32_bf16 v[172:175], v[140:143], a[200:203], v[172:175]
  v_cvt_pk_bf16_f32 v11, v11, v11
  ds_read_b128 a[200:203], v15 offset:21504
  s_waitcnt lgkmcnt(9)
  v_mfma_f32_16x16x32_bf16 v[176:179], v[136:139], a[204:207], v[176:179]
  buffer_load_dwordx4 a[28:31], v1, s[4:7], s14 offen offset:3072 sc1
  s_add_u32 s14, s14, 4096
  v_lshlrev_b32 v11, 16, v11
  v_mfma_f32_16x16x32_bf16 v[180:183], v[140:143], a[204:207], v[180:183]
  v_sqrt_f32 v11, v11
  ds_read_b128 a[204:207], v15 offset:22528
  s_waitcnt lgkmcnt(9)
  v_mfma_f32_16x16x32_bf16 v[184:187], v[136:139], a[208:211], v[184:187]
  v_cvt_pk_bf16_f32 v13, v11, v11
  v_mfma_f32_16x16x32_bf16 v[188:191], v[140:143], a[208:211], v[188:191]
  buffer_load_dwordx4 a[32:35], v1, s[4:7], s14 offen offset:0 sc1
  v_lshlrev_b32 v13, 16, v13
  ds_read_b128 a[208:211], v15 offset:23552
  s_waitcnt lgkmcnt(9)
  v_mfma_f32_16x16x32_bf16 v[192:195], v[136:139], a[212:215], v[192:195]
  v_rcp_f32 v13, v13
  v_mfma_f32_16x16x32_bf16 v[196:199], v[140:143], a[212:215], v[196:199]
  buffer_load_dwordx4 a[36:39], v1, s[4:7], s14 offen offset:1024 sc1
  v_mov_b32 v165, v164
  ds_read_b128 a[212:215], v15 offset:24576
  s_waitcnt lgkmcnt(9)
  v_mfma_f32_16x16x32_bf16 v[200:203], v[136:139], a[216:219], v[200:203]
  v_mov_b32 v166, v164
  v_mfma_f32_16x16x32_bf16 v[204:207], v[140:143], a[216:219], v[204:207]
  v_mov_b32 v167, v164
  ds_read_b128 a[216:219], v15 offset:25600
  s_waitcnt vmcnt(20)
  s_waitcnt lgkmcnt(9)
  v_mfma_f32_16x16x32_bf16 v[168:171], v[144:147], a[180:183], v[168:171]
  buffer_load_dwordx4 a[40:43], v1, s[4:7], s14 offen offset:2048 sc1
  v_mul_f32 v249, 0x3fb8aa3b, v13
  v_mfma_f32_16x16x32_bf16 v[172:175], v[148:151], a[180:183], v[172:175]
  s_lshl_b32 s46, s3, 8
  ds_read_b128 a[180:183], v15 offset:26624
  s_waitcnt lgkmcnt(9)
  v_mfma_f32_16x16x32_bf16 v[176:179], v[144:147], a[184:187], v[176:179]
  buffer_load_dwordx4 a[44:47], v1, s[4:7], s14 offen offset:3072 sc1
  s_add_u32 s14, s14, 4096
  s_add_u32 s46, s46, 159744
  v_mfma_f32_16x16x32_bf16 v[180:183], v[148:151], a[184:187], v[180:183]
  v_lshl_add_u32 v10, v5, 2, s46
  ds_read_b128 a[184:187], v15 offset:27648
  s_waitcnt lgkmcnt(9)
  v_mfma_f32_16x16x32_bf16 v[184:187], v[144:147], a[188:191], v[184:187]
  ds_write_b32 v10, v12 offset:0
  v_mfma_f32_16x16x32_bf16 v[188:191], v[148:151], a[188:191], v[188:191]
  buffer_load_dwordx4 a[48:51], v1, s[4:7], s14 offen offset:0 sc1
  ds_write_b32 v10, v13 offset:64
  ds_read_b128 a[188:191], v15 offset:28672
  s_waitcnt lgkmcnt(11)
  v_mfma_f32_16x16x32_bf16 v[192:195], v[144:147], a[192:195], v[192:195]
  ds_write_b32 v10, v248 offset:128
  v_mfma_f32_16x16x32_bf16 v[196:199], v[148:151], a[192:195], v[196:199]
  buffer_load_dwordx4 a[52:55], v1, s[4:7], s14 offen offset:1024 sc1
  ds_write_b32 v10, v249 offset:192
  ds_read_b128 a[192:195], v15 offset:29696
  s_waitcnt lgkmcnt(13)
  v_mfma_f32_16x16x32_bf16 v[200:203], v[144:147], a[196:199], v[200:203]
  v_lshl_add_u32 v10, v6, 4, s46
  v_mfma_f32_16x16x32_bf16 v[204:207], v[148:151], a[196:199], v[204:207]
  ds_read_b128 a[196:199], v15 offset:30720
  s_waitcnt vmcnt(22)
  s_waitcnt lgkmcnt(13)
  v_mfma_f32_16x16x32_bf16 v[168:171], v[152:155], a[200:203], v[168:171]
  buffer_load_dwordx4 a[56:59], v1, s[4:7], s14 offen offset:2048 sc1
  v_mfma_f32_16x16x32_bf16 v[172:175], v[156:159], a[200:203], v[172:175]
  s_waitcnt lgkmcnt(12)
  v_mfma_f32_16x16x32_bf16 v[176:179], v[152:155], a[204:207], v[176:179]
  buffer_load_dwordx4 a[60:63], v1, s[4:7], s14 offen offset:3072 sc1
  s_add_u32 s14, s14, 4096
  v_mfma_f32_16x16x32_bf16 v[180:183], v[156:159], a[204:207], v[180:183]
  s_waitcnt lgkmcnt(11)
  v_mfma_f32_16x16x32_bf16 v[184:187], v[152:155], a[208:211], v[184:187]
  v_mfma_f32_16x16x32_bf16 v[188:191], v[156:159], a[208:211], v[188:191]
  buffer_load_dwordx4 a[64:67], v1, s[4:7], s14 offen offset:0 sc1
  s_waitcnt lgkmcnt(10)
  v_mfma_f32_16x16x32_bf16 v[192:195], v[152:155], a[212:215], v[192:195]
  s_waitcnt lgkmcnt(2)
  ds_read_b128 v[232:235], v10 offset:0
  ds_read_b128 v[236:239], v10 offset:64
  ds_read_b128 v[240:243], v10 offset:128
  ds_read_b128 v[244:247], v10 offset:192
  v_mfma_f32_16x16x32_bf16 v[196:199], v[156:159], a[212:215], v[196:199]
  buffer_load_dwordx4 a[68:71], v1, s[4:7], s14 offen offset:1024 sc1
  v_mfma_f32_16x16x32_bf16 v[200:203], v[152:155], a[216:219], v[200:203]
  v_mfma_f32_16x16x32_bf16 v[204:207], v[156:159], a[216:219], v[204:207]
  v_mfma_f32_16x16x32_bf16 v[168:171], v[160:163], a[180:183], v[168:171]
  buffer_load_dwordx4 a[72:75], v1, s[4:7], s14 offen offset:2048 sc1
  v_mfma_f32_16x16x32_bf16 v[172:175], v[164:167], a[180:183], v[172:175]
  v_mfma_f32_16x16x32_bf16 v[176:179], v[160:163], a[184:187], v[176:179]
  buffer_load_dwordx4 a[76:79], v1, s[4:7], s14 offen offset:3072 sc1
  s_add_u32 s14, s14, 4096
  v_mfma_f32_16x16x32_bf16 v[180:183], v[164:167], a[184:187], v[180:183]
  v_mfma_f32_16x16x32_bf16 v[184:187], v[160:163], a[188:191], v[184:187]
  v_mfma_f32_16x16x32_bf16 v[188:191], v[164:167], a[188:191], v[188:191]
  buffer_load_dwordx4 a[80:83], v1, s[4:7], s14 offen offset:0 sc1
  s_waitcnt lgkmcnt(5)
  v_mfma_f32_16x16x32_bf16 v[192:195], v[160:163], a[192:195], v[192:195]
  v_mfma_f32_16x16x32_bf16 v[196:199], v[164:167], a[192:195], v[196:199]
  buffer_load_dwordx4 a[84:87], v1, s[4:7], s14 offen offset:1024 sc1
  s_waitcnt lgkmcnt(4)
  v_mfma_f32_16x16x32_bf16 v[200:203], v[160:163], a[196:199], v[200:203]
  v_mfma_f32_16x16x32_bf16 v[204:207], v[164:167], a[196:199], v[204:207]
  s_waitcnt lgkmcnt(0)
  v_mov_b32 v208, 1.0
  v_mov_b32 v209, 0x358637bd
  s_mov_b32 s56, 0xf000f
  s_mov_b32 s57, 0xf000f
  s_mov_b32 s58, 0xcc00cc0
  s_mov_b32 s59, 0xcc00cc0
  v_mov_b32 v14, 0x3f803f80
  v_and_b32 v10, 1, v0
  v_cmp_eq_u32 vcc, 1, v10
  s_nop 1
  v_cndmask_b32 v14, v14, 0, vcc
  s_lshl_b32 s46, s3, 10
  s_add_u32 s46, s46, 139264
  v_add_u32 v8, s46, v1
  v_pk_mul_f32 v[10:11], v[168:169], v[240:241] op_sel:[0,0] op_sel_hi:[1,1]
  v_exp_f32 v10, v10
  v_exp_f32 v11, v11
  v_cmp_lt_f32 vcc, 0, v168
  v_cmp_lt_f32 s[52:53], 0, v169
  v_pk_fma_f32 v[168:169], v[168:169], v[232:233], v[208:209] op_sel:[0,0,0] op_sel_hi:[1,1,0]
  v_cndmask_b32 v168, v10, v168, vcc
  v_cndmask_b32 v169, v11, v169, s[52:53]
  v_pk_add_f32 v[168:169], v[168:169], v[208:209] op_sel:[0,1] op_sel_hi:[1,1]
  v_cvt_pk_bf16_f32 v168, v168, v169
  v_pk_mul_f32 v[10:11], v[170:171], v[242:243] op_sel:[0,0] op_sel_hi:[1,1]
  v_exp_f32 v10, v10
  v_exp_f32 v11, v11
  v_cmp_lt_f32 vcc, 0, v170
  v_cmp_lt_f32 s[52:53], 0, v171
  v_pk_fma_f32 v[170:171], v[170:171], v[234:235], v[208:209] op_sel:[0,0,0] op_sel_hi:[1,1,0]
  v_cndmask_b32 v170, v10, v170, vcc
  v_cndmask_b32 v171, v11, v171, s[52:53]
  v_pk_add_f32 v[170:171], v[170:171], v[208:209] op_sel:[0,1] op_sel_hi:[1,1]
  v_cvt_pk_bf16_f32 v169, v170, v171
  v_pk_mul_f32 v[10:11], v[172:173], v[244:245] op_sel:[0,0] op_sel_hi:[1,1]
  v_exp_f32 v10, v10
  v_exp_f32 v11, v11
  v_cmp_lt_f32 vcc, 0, v172
  v_cmp_lt_f32 s[52:53], 0, v173
  v_pk_fma_f32 v[172:173], v[172:173], v[236:237], v[208:209] op_sel:[0,0,0] op_sel_hi:[1,1,0]
  v_cndmask_b32 v172, v10, v172, vcc
  v_cndmask_b32 v173, v11, v173, s[52:53]
  v_pk_add_f32 v[172:173], v[172:173], v[208:209] op_sel:[0,1] op_sel_hi:[1,1]
  v_cvt_pk_bf16_f32 v170, v172, v173
  v_pk_mul_f32 v[10:11], v[174:175], v[246:247] op_sel:[0,0] op_sel_hi:[1,1]
  v_exp_f32 v10, v10
  v_exp_f32 v11, v11
  v_cmp_lt_f32 vcc, 0, v174
  v_cmp_lt_f32 s[52:53], 0, v175
  v_pk_fma_f32 v[174:175], v[174:175], v[238:239], v[208:209] op_sel:[0,0,0] op_sel_hi:[1,1,0]
  v_cndmask_b32 v174, v10, v174, vcc
  v_cndmask_b32 v175, v11, v175, s[52:53]
  v_pk_add_f32 v[174:175], v[174:175], v[208:209] op_sel:[0,1] op_sel_hi:[1,1]
  v_cvt_pk_bf16_f32 v171, v174, v175
  ds_write_b128 v8, v[168:171] offset:0
  buffer_load_dwordx4 a[88:91], v1, s[4:7], s14 offen offset:2048 sc1
  buffer_load_dwordx4 a[92:95], v1, s[4:7], s14 offen offset:3072 sc1
  s_add_u32 s14, s14, 4096
  buffer_load_dwordx4 a[96:99], v1, s[4:7], s14 offen offset:0 sc1
  buffer_load_dwordx4 a[100:103], v1, s[4:7], s14 offen offset:1024 sc1
  v_pk_mul_f32 v[10:11], v[176:177], v[240:241] op_sel:[0,0] op_sel_hi:[1,1]
  v_exp_f32 v10, v10
  v_exp_f32 v11, v11
  v_cmp_lt_f32 vcc, 0, v176
  v_cmp_lt_f32 s[52:53], 0, v177
  v_pk_fma_f32 v[176:177], v[176:177], v[232:233], v[208:209] op_sel:[0,0,0] op_sel_hi:[1,1,0]
  v_cndmask_b32 v176, v10, v176, vcc
  v_cndmask_b32 v177, v11, v177, s[52:53]
  v_pk_add_f32 v[176:177], v[176:177], v[208:209] op_sel:[0,1] op_sel_hi:[1,1]
  v_cvt_pk_bf16_f32 v176, v176, v177
  v_pk_mul_f32 v[10:11], v[178:179], v[242:243] op_sel:[0,0] op_sel_hi:[1,1]
  v_exp_f32 v10, v10
  v_exp_f32 v11, v11
  v_cmp_lt_f32 vcc, 0, v178
  v_cmp_lt_f32 s[52:53], 0, v179
  v_pk_fma_f32 v[178:179], v[178:179], v[234:235], v[208:209] op_sel:[0,0,0] op_sel_hi:[1,1,0]
  v_cndmask_b32 v178, v10, v178, vcc
  v_cndmask_b32 v179, v11, v179, s[52:53]
  v_pk_add_f32 v[178:179], v[178:179], v[208:209] op_sel:[0,1] op_sel_hi:[1,1]
  v_cvt_pk_bf16_f32 v177, v178, v179
  v_pk_mul_f32 v[10:11], v[180:181], v[244:245] op_sel:[0,0] op_sel_hi:[1,1]
  v_exp_f32 v10, v10
  v_exp_f32 v11, v11
  v_cmp_lt_f32 vcc, 0, v180
  v_cmp_lt_f32 s[52:53], 0, v181
  v_pk_fma_f32 v[180:181], v[180:181], v[236:237], v[208:209] op_sel:[0,0,0] op_sel_hi:[1,1,0]
  v_cndmask_b32 v180, v10, v180, vcc
  v_cndmask_b32 v181, v11, v181, s[52:53]
  v_pk_add_f32 v[180:181], v[180:181], v[208:209] op_sel:[0,1] op_sel_hi:[1,1]
  v_cvt_pk_bf16_f32 v178, v180, v181
  v_pk_mul_f32 v[10:11], v[182:183], v[246:247] op_sel:[0,0] op_sel_hi:[1,1]
  v_exp_f32 v10, v10
  v_exp_f32 v11, v11
  v_cmp_lt_f32 vcc, 0, v182
  v_cmp_lt_f32 s[52:53], 0, v183
  v_pk_fma_f32 v[182:183], v[182:183], v[238:239], v[208:209] op_sel:[0,0,0] op_sel_hi:[1,1,0]
  v_cndmask_b32 v182, v10, v182, vcc
  v_cndmask_b32 v183, v11, v183, s[52:53]
  v_pk_add_f32 v[182:183], v[182:183], v[208:209] op_sel:[0,1] op_sel_hi:[1,1]
  v_cvt_pk_bf16_f32 v179, v182, v183
  ds_write_b128 v8, v[176:179] offset:4096
  buffer_load_dwordx4 a[104:107], v1, s[4:7], s14 offen offset:2048 sc1
  buffer_load_dwordx4 a[108:111], v1, s[4:7], s14 offen offset:3072 sc1
  s_add_u32 s14, s14, 4096
  buffer_load_dwordx4 a[112:115], v1, s[4:7], s14 offen offset:0 sc1
  buffer_load_dwordx4 a[116:119], v1, s[4:7], s14 offen offset:1024 sc1
  v_pk_mul_f32 v[10:11], v[200:201], v[232:233] op_sel:[0,0] op_sel_hi:[1,1]
  v_cvt_pk_bf16_f32 v3, v10, v11
  v_pk_mul_f32 v[10:11], v[200:201], v[240:241] op_sel:[0,0] op_sel_hi:[1,1]
  v_exp_f32 v10, v10
  v_exp_f32 v11, v11
  v_cmp_lt_f32 vcc, 0, v200
  v_cmp_lt_f32 s[52:53], 0, v201
  v_pk_fma_f32 v[200:201], v[200:201], v[232:233], v[208:209] op_sel:[0,0,0] op_sel_hi:[1,1,0]
  v_cndmask_b32 v200, v10, v200, vcc
  v_cndmask_b32 v201, v11, v201, s[52:53]
  v_pk_add_f32 v[200:201], v[200:201], v[208:209] op_sel:[0,1] op_sel_hi:[1,1]
  v_cvt_pk_bf16_f32 v200, v200, v201
  v_cndmask_b32 v200, v3, v200, s[56:57]
  v_cndmask_b32 v200, v200, v14, s[58:59]
  v_pk_mul_f32 v[10:11], v[202:203], v[234:235] op_sel:[0,0] op_sel_hi:[1,1]
  v_cvt_pk_bf16_f32 v3, v10, v11
  v_pk_mul_f32 v[10:11], v[202:203], v[242:243] op_sel:[0,0] op_sel_hi:[1,1]
  v_exp_f32 v10, v10
  v_exp_f32 v11, v11
  v_cmp_lt_f32 vcc, 0, v202
  v_cmp_lt_f32 s[52:53], 0, v203
  v_pk_fma_f32 v[202:203], v[202:203], v[234:235], v[208:209] op_sel:[0,0,0] op_sel_hi:[1,1,0]
  v_cndmask_b32 v202, v10, v202, vcc
  v_cndmask_b32 v203, v11, v203, s[52:53]
  v_pk_add_f32 v[202:203], v[202:203], v[208:209] op_sel:[0,1] op_sel_hi:[1,1]
  v_cvt_pk_bf16_f32 v201, v202, v203
  v_cndmask_b32 v201, v3, v201, s[56:57]
  v_cndmask_b32 v201, v201, v14, s[58:59]
  v_pk_mul_f32 v[10:11], v[204:205], v[236:237] op_sel:[0,0] op_sel_hi:[1,1]
  v_cvt_pk_bf16_f32 v3, v10, v11
  v_pk_mul_f32 v[10:11], v[204:205], v[244:245] op_sel:[0,0] op_sel_hi:[1,1]
  v_exp_f32 v10, v10
  v_exp_f32 v11, v11
  v_cmp_lt_f32 vcc, 0, v204
  v_cmp_lt_f32 s[52:53], 0, v205
  v_pk_fma_f32 v[204:205], v[204:205], v[236:237], v[208:209] op_sel:[0,0,0] op_sel_hi:[1,1,0]
  v_cndmask_b32 v204, v10, v204, vcc
  v_cndmask_b32 v205, v11, v205, s[52:53]
  v_pk_add_f32 v[204:205], v[204:205], v[208:209] op_sel:[0,1] op_sel_hi:[1,1]
  v_cvt_pk_bf16_f32 v202, v204, v205
  v_cndmask_b32 v202, v3, v202, s[56:57]
  v_cndmask_b32 v202, v202, v14, s[58:59]
  v_pk_mul_f32 v[10:11], v[206:207], v[238:239] op_sel:[0,0] op_sel_hi:[1,1]
  v_cvt_pk_bf16_f32 v3, v10, v11
  v_pk_mul_f32 v[10:11], v[206:207], v[246:247] op_sel:[0,0] op_sel_hi:[1,1]
  v_exp_f32 v10, v10
  v_exp_f32 v11, v11
  v_cmp_lt_f32 vcc, 0, v206
  v_cmp_lt_f32 s[52:53], 0, v207
  v_pk_fma_f32 v[206:207], v[206:207], v[238:239], v[208:209] op_sel:[0,0,0] op_sel_hi:[1,1,0]
  v_cndmask_b32 v206, v10, v206, vcc
  v_cndmask_b32 v207, v11, v207, s[52:53]
  v_pk_add_f32 v[206:207], v[206:207], v[208:209] op_sel:[0,1] op_sel_hi:[1,1]
  v_cvt_pk_bf16_f32 v203, v206, v207
  v_cndmask_b32 v203, v3, v203, s[56:57]
  v_cndmask_b32 v203, v203, v14, s[58:59]
  ds_write_b128 v8, v[200:203] offset:16384
  buffer_load_dwordx4 a[120:123], v1, s[4:7], s14 offen offset:2048 sc1
  buffer_load_dwordx4 a[124:127], v1, s[4:7], s14 offen offset:3072 sc1
  s_add_u32 s14, s14, 4096
  buffer_load_dwordx4 a[128:131], v1, s[4:7], s14 offen offset:0 sc1
  buffer_load_dwordx4 a[132:135], v1, s[4:7], s14 offen offset:1024 sc1
  v_pk_mul_f32 v[10:11], v[184:185], v[232:233] op_sel:[0,0] op_sel_hi:[1,1]
  v_cvt_pk_bf16_f32 v184, v10, v11
  v_pk_mul_f32 v[10:11], v[186:187], v[234:235] op_sel:[0,0] op_sel_hi:[1,1]
  v_cvt_pk_bf16_f32 v185, v10, v11
  v_pk_mul_f32 v[10:11], v[188:189], v[236:237] op_sel:[0,0] op_sel_hi:[1,1]
  v_cvt_pk_bf16_f32 v186, v10, v11
  v_pk_mul_f32 v[10:11], v[190:191], v[238:239] op_sel:[0,0] op_sel_hi:[1,1]
  v_cvt_pk_bf16_f32 v187, v10, v11
  ds_write_b128 v8, v[184:187] offset:8192
  buffer_load_dwordx4 a[136:139], v1, s[4:7], s14 offen offset:2048 sc1
  buffer_load_dwordx4 a[140:143], v1, s[4:7], s14 offen offset:3072 sc1
  s_add_u32 s14, s14, 4096
  buffer_load_dwordx4 a[144:147], v1, s[4:7], s14 offen offset:0 sc1
  buffer_load_dwordx4 a[148:151], v1, s[4:7], s14 offen offset:1024 sc1
  v_pk_mul_f32 v[10:11], v[192:193], v[232:233] op_sel:[0,0] op_sel_hi:[1,1]
  v_cvt_pk_bf16_f32 v192, v10, v11
  v_pk_mul_f32 v[10:11], v[194:195], v[234:235] op_sel:[0,0] op_sel_hi:[1,1]
  v_cvt_pk_bf16_f32 v193, v10, v11
  v_pk_mul_f32 v[10:11], v[196:197], v[236:237] op_sel:[0,0] op_sel_hi:[1,1]
  v_cvt_pk_bf16_f32 v194, v10, v11
  v_pk_mul_f32 v[10:11], v[198:199], v[238:239] op_sel:[0,0] op_sel_hi:[1,1]
  v_cvt_pk_bf16_f32 v195, v10, v11
  ds_write_b128 v8, v[192:195] offset:12288
  buffer_load_dwordx4 a[152:155], v1, s[4:7], s14 offen offset:2048 sc1
  buffer_load_dwordx4 a[156:159], v1, s[4:7], s14 offen offset:3072 sc1
  s_add_u32 s14, s14, 4096
  buffer_load_dwordx4 a[160:163], v1, s[4:7], s14 offen offset:0 sc1
  buffer_load_dwordx4 a[164:167], v1, s[4:7], s14 offen offset:1024 sc1
  s_waitcnt lgkmcnt(0)
  s_barrier
  ds_read_b128 a[180:183], v250 offset:0
  ds_read_b128 a[184:187], v251 offset:0
  ds_read_b128 a[188:191], v250 offset:1024
  ds_read_b128 a[192:195], v251 offset:1024
  ds_read_b128 a[196:199], v250 offset:2048
  ds_read_b128 a[200:203], v251 offset:2048
  ds_read_b128 a[204:207], v250 offset:3072
  ds_read_b128 a[208:211], v251 offset:3072
  s_waitcnt lgkmcnt(6)
  v_mfma_f32_16x16x32_bf16 v[168:171], a[180:183], a[184:187], 0
  s_waitcnt lgkmcnt(4)
  v_mfma_f32_16x16x32_bf16 v[168:171], a[188:191], a[192:195], v[168:171]
  s_waitcnt lgkmcnt(2)
  v_mfma_f32_16x16x32_bf16 v[168:171], a[196:199], a[200:203], v[168:171]
  s_waitcnt lgkmcnt(0)
  v_mfma_f32_16x16x32_bf16 v[168:171], a[204:207], a[208:211], v[168:171]
  ds_read_b128 a[180:183], v252 offset:0
  ds_read_b128 a[184:187], v253 offset:0
  ds_read_b128 a[188:191], v252 offset:1024
  ds_read_b128 a[192:195], v253 offset:1024
  ds_read_b128 a[196:199], v252 offset:2048
  ds_read_b128 a[200:203], v253 offset:2048
  ds_read_b128 a[204:207], v252 offset:3072
  ds_read_b128 a[208:211], v253 offset:3072
  s_waitcnt lgkmcnt(6)
  v_mfma_f32_16x16x32_bf16 v[172:175], a[180:183], a[184:187], 0
  s_waitcnt lgkmcnt(4)
  v_mfma_f32_16x16x32_bf16 v[172:175], a[188:191], a[192:195], v[172:175]
  s_waitcnt lgkmcnt(2)
  v_mfma_f32_16x16x32_bf16 v[172:175], a[196:199], a[200:203], v[172:175]
  s_waitcnt lgkmcnt(0)
  v_mfma_f32_16x16x32_bf16 v[172:175], a[204:207], a[208:211], v[172:175]
  s_mov_b64 exec, s[96:97]
  ds_write_b32 v254, v168 offset:0
  ds_write_b32 v254, v169 offset:96
  ds_write_b32 v254, v170 offset:192
  ds_write_b32 v254, v171 offset:288
  s_mov_b64 exec, s[98:99]
  s_nop 1
  ds_write_b32 v255, v172 offset:0
  ds_write_b32 v255, v173 offset:96
  ds_write_b32 v255, v174 offset:192
  s_mov_b64 exec, -1
  s_lshl_b32 s46, s3, 8
  v_lshl_add_u32 v8, v0, 2, s46
  s_waitcnt lgkmcnt(0)
  s_barrier
  ds_read_b32 v176, v8 offset:0
  ds_read_b32 v177, v8 offset:1024
  ds_read_b32 v178, v8 offset:2048
  ds_read_b32 v179, v8 offset:3072
  ds_read_b128 a[200:203], v1 offset:4096
  ds_read_b128 a[204:207], v15 offset:31744
  ds_read_b128 a[208:211], v15 offset:32768
  ds_read_b128 a[212:215], v1 offset:9216
  ds_read_b128 a[216:219], v15 offset:33792
  ds_read_b128 a[180:183], v15 offset:34816
  ds_read_b128 a[184:187], v1 offset:14336
  ds_read_b128 a[188:191], v15 offset:35840
  ds_read_b128 a[192:195], v15 offset:36864
  s_waitcnt lgkmcnt(12)
  s_mov_b64 exec, s[16:17]
  buffer_atomic_add_f32 v176, v8, s[8:11], 0 offen offset:0
  s_waitcnt lgkmcnt(11)
  s_mov_b64 exec, s[18:19]
  buffer_atomic_add_f32 v177, v8, s[8:11], 0 offen offset:1024
  s_waitcnt lgkmcnt(10)
  s_mov_b64 exec, s[20:21]
  buffer_atomic_add_f32 v178, v8, s[8:11], 0 offen offset:2048
  s_waitcnt lgkmcnt(9)
  s_mov_b64 exec, s[22:23]
  buffer_atomic_add_f32 v179, v8, s[8:11], 0 offen offset:3072
  s_mov_b64 exec, -1
  ds_read_b128 a[196:199], v1 offset:19456
  s_waitcnt lgkmcnt(9)
  v_mfma_f32_16x16x32_bf16 v[208:211], a[200:203], v[16:19], 0
  buffer_load_dwordx4 a[168:171], v1, s[4:7], s14 offen offset:2048 sc1
  v_mfma_f32_16x16x32_bf16 v[212:215], a[200:203], v[20:23], 0
  s_lshl_b32 s44, s41, 4
  ds_read_b128 a[200:203], v15 offset:37888
  s_waitcnt lgkmcnt(9)
  v_mfma_f32_16x16x32_bf16 v[216:219], a[204:207], v[16:19], 0
  v_mfma_f32_16x16x32_bf16 v[220:223], a[204:207], v[20:23], 0
  s_add_u32 s44, s44, s39
  ds_read_b128 a[204:207], v15 offset:38912
  s_waitcnt lgkmcnt(9)
  v_mfma_f32_16x16x32_bf16 v[224:227], a[208:211], v[16:19], 0
  buffer_load_dwordx4 a[172:175], v1, s[4:7], s14 offen offset:3072 sc1
  s_add_u32 s14, s14, 4096
  v_mfma_f32_16x16x32_bf16 v[228:231], a[208:211], v[20:23], 0
  s_mul_i32 s44, s44, 2560
  ds_read_b128 a[208:211], v1 offset:24576
  s_waitcnt lgkmcnt(9)
  v_mfma_f32_16x16x32_bf16 v[208:211], a[212:215], v[24:27], v[208:211]
  v_mfma_f32_16x16x32_bf16 v[212:215], a[212:215], v[28:31], v[212:215]
  ds_read_b128 a[212:215], v15 offset:39936
  s_waitcnt lgkmcnt(9)
  v_mfma_f32_16x16x32_bf16 v[216:219], a[216:219], v[24:27], v[216:219]
  buffer_load_dwordx4 a[176:179], v1, s[4:7], s14 offen offset:0 sc1
  s_add_u32 s44, s44, 2359296
  v_mfma_f32_16x16x32_bf16 v[220:223], a[216:219], v[28:31], v[220:223]
  s_waitcnt vmcnt(49)
  s_barrier
  ds_read_b128 a[216:219], v15 offset:40960
  s_waitcnt lgkmcnt(9)
  v_mfma_f32_16x16x32_bf16 v[224:227], a[180:183], v[24:27], v[224:227]
  s_add_u32 s44, s44, s50
  v_mfma_f32_16x16x32_bf16 v[228:231], a[180:183], v[28:31], v[228:231]
  ds_read_b128 a[180:183], v1 offset:29696
  s_waitcnt lgkmcnt(9)
  v_mfma_f32_16x16x32_bf16 v[208:211], a[184:187], v[32:35], v[208:211]
  v_lshrrev_b32 v7, 1, v6
  v_mfma_f32_16x16x32_bf16 v[212:215], a[184:187], v[36:39], v[212:215]
  ds_read_b128 a[184:187], v15 offset:41984
  s_waitcnt lgkmcnt(9)
  v_mfma_f32_16x16x32_bf16 v[216:219], a[188:191], v[32:35], v[216:219]
  v_mfma_f32_16x16x32_bf16 v[220:223], a[188:191], v[36:39], v[220:223]
  v_lshlrev_b32 v7, 9, v7
  ds_read_b128 a[188:191], v15 offset:43008
  s_waitcnt lgkmcnt(9)
  v_mfma_f32_16x16x32_bf16 v[224:227], a[192:195], v[32:35], v[224:227]
  v_mfma_f32_16x16x32_bf16 v[228:231], a[192:195], v[36:39], v[228:231]
  v_lshl_add_u32 v7, v5, 4, v7
  ds_read_b128 a[192:195], v1 offset:34816
  s_waitcnt lgkmcnt(9)
  v_mfma_f32_16x16x32_bf16 v[208:211], a[196:199], v[40:43], v[208:211]
  v_mfma_f32_16x16x32_bf16 v[212:215], a[196:199], v[44:47], v[212:215]
  v_and_b32 v14, 1, v6
  ds_read_b128 a[196:199], v15 offset:44032
  s_waitcnt lgkmcnt(9)
  v_mfma_f32_16x16x32_bf16 v[216:219], a[200:203], v[40:43], v[216:219]
  v_mfma_f32_16x16x32_bf16 v[220:223], a[200:203], v[44:47], v[220:223]
  ds_read_b128 a[200:203], v15 offset:45056
  s_waitcnt lgkmcnt(9)
  v_mfma_f32_16x16x32_bf16 v[224:227], a[204:207], v[40:43], v[224:227]
  v_lshl_add_u32 v7, v14, 8, v7
  v_mfma_f32_16x16x32_bf16 v[228:231], a[204:207], v[44:47], v[228:231]
  ds_read_b128 a[204:207], v1 offset:39936
  s_waitcnt lgkmcnt(9)
  v_mfma_f32_16x16x32_bf16 v[208:211], a[208:211], v[48:51], v[208:211]
  v_mov_b32 v9, s49
  v_mfma_f32_16x16x32_bf16 v[212:215], a[208:211], v[52:55], v[212:215]
  ds_read_b128 a[208:211], v15 offset:46080
  s_waitcnt lgkmcnt(9)
  v_mfma_f32_16x16x32_bf16 v[216:219], a[212:215], v[48:51], v[216:219]
  v_cmp_gt_u32 vcc, 2, v6
  v_mfma_f32_16x16x32_bf16 v[220:223], a[212:215], v[52:55], v[220:223]
  ds_read_b128 a[212:215], v15 offset:47104
  s_waitcnt lgkmcnt(9)
  v_mfma_f32_16x16x32_bf16 v[224:227], a[216:219], v[48:51], v[224:227]
  v_mfma_f32_16x16x32_bf16 v[228:231], a[216:219], v[52:55], v[228:231]
  v_cndmask_b32 v14, v7, v9, vcc
  ds_read_b128 a[216:219], v1 offset:45056
  s_waitcnt lgkmcnt(9)
  v_mfma_f32_16x16x32_bf16 v[208:211], a[180:183], v[56:59], v[208:211]
  v_mfma_f32_16x16x32_bf16 v[212:215], a[180:183], v[60:63], v[212:215]
  v_mov_b32 v206, 1.0
  ds_read_b128 a[180:183], v15 offset:48128
  s_waitcnt lgkmcnt(9)
  v_mfma_f32_16x16x32_bf16 v[216:219], a[184:187], v[56:59], v[216:219]
  v_mfma_f32_16x16x32_bf16 v[220:223], a[184:187], v[60:63], v[220:223]
  v_mov_b32 v207, 0x358637bd
  ds_read_b128 a[184:187], v15 offset:49152
  s_waitcnt lgkmcnt(9)
  v_mfma_f32_16x16x32_bf16 v[224:227], a[188:191], v[56:59], v[224:227]
  v_mfma_f32_16x16x32_bf16 v[228:231], a[188:191], v[60:63], v[228:231]
  ds_read_b128 a[188:191], v1 offset:50176
  s_waitcnt lgkmcnt(9)
  v_mfma_f32_16x16x32_bf16 v[208:211], a[192:195], v[64:67], v[208:211]
  v_mfma_f32_16x16x32_bf16 v[212:215], a[192:195], v[68:71], v[212:215]
  ds_read_b128 a[192:195], v15 offset:50176
  s_waitcnt lgkmcnt(9)
  v_mfma_f32_16x16x32_bf16 v[216:219], a[196:199], v[64:67], v[216:219]
  v_mfma_f32_16x16x32_bf16 v[220:223], a[196:199], v[68:71], v[220:223]
  ds_read_b128 a[196:199], v15 offset:51200
  s_waitcnt lgkmcnt(9)
  v_mfma_f32_16x16x32_bf16 v[224:227], a[200:203], v[64:67], v[224:227]
  v_mfma_f32_16x16x32_bf16 v[228:231], a[200:203], v[68:71], v[228:231]
  ds_read_b128 a[200:203], v1 offset:55296
  s_waitcnt lgkmcnt(9)
  v_mfma_f32_16x16x32_bf16 v[208:211], a[204:207], v[72:75], v[208:211]
  v_mfma_f32_16x16x32_bf16 v[212:215], a[204:207], v[76:79], v[212:215]
  ds_read_b128 a[204:207], v15 offset:52224
  s_waitcnt lgkmcnt(9)
  v_mfma_f32_16x16x32_bf16 v[216:219], a[208:211], v[72:75], v[216:219]
  v_mfma_f32_16x16x32_bf16 v[220:223], a[208:211], v[76:79], v[220:223]
  ds_read_b128 a[208:211], v15 offset:53248
  s_waitcnt lgkmcnt(9)
  v_mfma_f32_16x16x32_bf16 v[224:227], a[212:215], v[72:75], v[224:227]
  v_mfma_f32_16x16x32_bf16 v[228:231], a[212:215], v[76:79], v[228:231]
  ds_read_b128 a[212:215], v1 offset:60416
  s_waitcnt lgkmcnt(9)
  v_mfma_f32_16x16x32_bf16 v[208:211], a[216:219], v[80:83], v[208:211]
  v_mfma_f32_16x16x32_bf16 v[212:215], a[216:219], v[84:87], v[212:215]
  ds_read_b128 a[216:219], v15 offset:54272
  s_waitcnt lgkmcnt(9)
  v_mfma_f32_16x16x32_bf16 v[216:219], a[180:183], v[80:83], v[216:219]
  v_mfma_f32_16x16x32_bf16 v[220:223], a[180:183], v[84:87], v[220:223]
  ds_read_b128 a[180:183], v15 offset:55296
  s_waitcnt lgkmcnt(9)
  v_mfma_f32_16x16x32_bf16 v[224:227], a[184:187], v[80:83], v[224:227]
  v_mfma_f32_16x16x32_bf16 v[228:231], a[184:187], v[84:87], v[228:231]
  ds_read_b128 a[184:187], v15 offset:0
  s_waitcnt lgkmcnt(9)
  v_mfma_f32_16x16x32_bf16 v[208:211], a[188:191], v[88:91], v[208:211]
  v_mfma_f32_16x16x32_bf16 v[212:215], a[188:191], v[92:95], v[212:215]
  ds_read_b128 a[188:191], v15 offset:56320
  s_waitcnt lgkmcnt(9)
  v_mfma_f32_16x16x32_bf16 v[216:219], a[192:195], v[88:91], v[216:219]
  v_mfma_f32_16x16x32_bf16 v[220:223], a[192:195], v[92:95], v[220:223]
  ds_read_b128 a[192:195], v15 offset:57344
  s_waitcnt lgkmcnt(9)
  v_mfma_f32_16x16x32_bf16 v[224:227], a[196:199], v[88:91], v[224:227]
  v_mfma_f32_16x16x32_bf16 v[228:231], a[196:199], v[92:95], v[228:231]
  ds_read_b128 a[196:199], v15 offset:5120
  s_waitcnt lgkmcnt(9)
  v_mfma_f32_16x16x32_bf16 v[208:211], a[200:203], v[96:99], v[208:211]
  v_mfma_f32_16x16x32_bf16 v[212:215], a[200:203], v[100:103], v[212:215]
  ds_read_b128 a[200:203], v15 offset:58368
  s_waitcnt lgkmcnt(9)
  v_mfma_f32_16x16x32_bf16 v[216:219], a[204:207], v[96:99], v[216:219]
  v_mfma_f32_16x16x32_bf16 v[220:223], a[204:207], v[100:103], v[220:223]
  ds_read_b128 a[204:207], v15 offset:59392
  s_waitcnt lgkmcnt(9)
  v_mfma_f32_16x16x32_bf16 v[224:227], a[208:211], v[96:99], v[224:227]
  v_mfma_f32_16x16x32_bf16 v[228:231], a[208:211], v[100:103], v[228:231]
  ds_read_b128 a[208:211], v15 offset:10240
  s_waitcnt lgkmcnt(9)
  v_mfma_f32_16x16x32_bf16 v[208:211], a[212:215], v[104:107], v[208:211]
  v_mfma_f32_16x16x32_bf16 v[212:215], a[212:215], v[108:111], v[212:215]
  ds_read_b128 a[212:215], v15 offset:60416
  s_waitcnt lgkmcnt(9)
  v_mfma_f32_16x16x32_bf16 v[216:219], a[216:219], v[104:107], v[216:219]
  v_mfma_f32_16x16x32_bf16 v[220:223], a[216:219], v[108:111], v[220:223]
  ds_read_b128 a[216:219], v15 offset:61440
  s_waitcnt lgkmcnt(9)
  v_mfma_f32_16x16x32_bf16 v[224:227], a[180:183], v[104:107], v[224:227]
  s_and_b32 s46, s2, 15
  s_lshl_b32 s46, s46, 7
  s_add_u32 s46, s46, 5177344
  s_add_u32 s46, s46, s50
  s_cmp_eq_u32 s3, 0
  s_cselect_b32 s46, s46, s49
  v_mov_b32 v204, s49
  v_writelane_b32 v204, s46, 0
  v_mov_b32 v205, 1
  s_waitcnt vmcnt(3)
  s_barrier
  buffer_atomic_add v205, v204, s[4:7], 0 offen sc0
  v_mfma_f32_16x16x32_bf16 v[228:231], a[180:183], v[108:111], v[228:231]
  ds_read_b128 a[180:183], v15 offset:15360
  s_waitcnt lgkmcnt(9)
  v_mfma_f32_16x16x32_bf16 v[208:211], a[184:187], v[112:115], v[208:211]
  v_mfma_f32_16x16x32_bf16 v[212:215], a[184:187], v[116:119], v[212:215]
  ds_read_b128 a[184:187], v15 offset:62464
  s_waitcnt lgkmcnt(9)
  v_mfma_f32_16x16x32_bf16 v[216:219], a[188:191], v[112:115], v[216:219]
  v_mfma_f32_16x16x32_bf16 v[220:223], a[188:191], v[116:119], v[220:223]
  ds_read_b128 a[188:191], v15 offset:63488
  s_waitcnt lgkmcnt(9)
  v_mfma_f32_16x16x32_bf16 v[224:227], a[192:195], v[112:115], v[224:227]
  v_mfma_f32_16x16x32_bf16 v[228:231], a[192:195], v[116:119], v[228:231]
  ds_read_b128 a[192:195], v15 offset:20480
  s_waitcnt lgkmcnt(9)
  v_mfma_f32_16x16x32_bf16 v[208:211], a[196:199], v[120:123], v[208:211]
  v_mfma_f32_16x16x32_bf16 v[212:215], a[196:199], v[124:127], v[212:215]
  ds_read_b128 a[196:199], v15 offset:64512
  s_waitcnt lgkmcnt(9)
  v_mfma_f32_16x16x32_bf16 v[216:219], a[200:203], v[120:123], v[216:219]
  v_mfma_f32_16x16x32_bf16 v[220:223], a[200:203], v[124:127], v[220:223]
  ds_read_b128 a[200:203], v4 offset:0
  s_waitcnt lgkmcnt(9)
  v_mfma_f32_16x16x32_bf16 v[224:227], a[204:207], v[120:123], v[224:227]
  v_mfma_f32_16x16x32_bf16 v[228:231], a[204:207], v[124:127], v[228:231]
  ds_read_b128 a[204:207], v15 offset:25600
  s_waitcnt lgkmcnt(9)
  v_mfma_f32_16x16x32_bf16 v[208:211], a[208:211], v[128:131], v[208:211]
  v_mfma_f32_16x16x32_bf16 v[212:215], a[208:211], v[132:135], v[212:215]
  ds_read_b128 a[208:211], v4 offset:1024
  s_waitcnt lgkmcnt(9)
  v_mfma_f32_16x16x32_bf16 v[216:219], a[212:215], v[128:131], v[216:219]
  v_mfma_f32_16x16x32_bf16 v[220:223], a[212:215], v[132:135], v[220:223]
  ds_read_b128 a[212:215], v4 offset:2048
  s_waitcnt lgkmcnt(9)
  v_mfma_f32_16x16x32_bf16 v[224:227], a[216:219], v[128:131], v[224:227]
  v_mfma_f32_16x16x32_bf16 v[228:231], a[216:219], v[132:135], v[228:231]
  ds_read_b128 a[216:219], v15 offset:30720
  s_waitcnt lgkmcnt(9)
  v_mfma_f32_16x16x32_bf16 v[208:211], a[180:183], v[136:139], v[208:211]
  v_mfma_f32_16x16x32_bf16 v[212:215], a[180:183], v[140:143], v[212:215]
  ds_read_b128 a[180:183], v4 offset:3072
  s_waitcnt lgkmcnt(9)
  v_mfma_f32_16x16x32_bf16 v[216:219], a[184:187], v[136:139], v[216:219]
  v_mfma_f32_16x16x32_bf16 v[220:223], a[184:187], v[140:143], v[220:223]
  ds_read_b128 a[184:187], v4 offset:4096
  s_waitcnt lgkmcnt(9)
  v_mfma_f32_16x16x32_bf16 v[224:227], a[188:191], v[136:139], v[224:227]
  v_mfma_f32_16x16x32_bf16 v[228:231], a[188:191], v[140:143], v[228:231]
  s_waitcnt lgkmcnt(8)
  v_mfma_f32_16x16x32_bf16 v[208:211], a[192:195], v[144:147], v[208:211]
  v_mfma_f32_16x16x32_bf16 v[212:215], a[192:195], v[148:151], v[212:215]
  s_waitcnt lgkmcnt(7)
  v_mfma_f32_16x16x32_bf16 v[216:219], a[196:199], v[144:147], v[216:219]
  v_mfma_f32_16x16x32_bf16 v[220:223], a[196:199], v[148:151], v[220:223]
  s_waitcnt lgkmcnt(6)
  v_mfma_f32_16x16x32_bf16 v[224:227], a[200:203], v[144:147], v[224:227]
  v_mfma_f32_16x16x32_bf16 v[228:231], a[200:203], v[148:151], v[228:231]
  s_waitcnt lgkmcnt(5)
  v_mfma_f32_16x16x32_bf16 v[208:211], a[204:207], v[152:155], v[208:211]
  v_mfma_f32_16x16x32_bf16 v[212:215], a[204:207], v[156:159], v[212:215]
  s_waitcnt lgkmcnt(4)
  v_mfma_f32_16x16x32_bf16 v[216:219], a[208:211], v[152:155], v[216:219]
  v_mfma_f32_16x16x32_bf16 v[220:223], a[208:211], v[156:159], v[220:223]
  s_waitcnt lgkmcnt(3)
  v_mfma_f32_16x16x32_bf16 v[224:227], a[212:215], v[152:155], v[224:227]
  v_mfma_f32_16x16x32_bf16 v[228:231], a[212:215], v[156:159], v[228:231]
  s_waitcnt lgkmcnt(2)
  v_mfma_f32_16x16x32_bf16 v[208:211], a[216:219], v[160:163], v[208:211]
  v_mfma_f32_16x16x32_bf16 v[212:215], a[216:219], v[164:167], v[212:215]
  s_waitcnt lgkmcnt(1)
  v_mfma_f32_16x16x32_bf16 v[216:219], a[180:183], v[160:163], v[216:219]
  v_mfma_f32_16x16x32_bf16 v[220:223], a[180:183], v[164:167], v[220:223]
  s_waitcnt lgkmcnt(0)
  v_mfma_f32_16x16x32_bf16 v[224:227], a[184:187], v[160:163], v[224:227]
  v_mfma_f32_16x16x32_bf16 v[228:231], a[184:187], v[164:167], v[228:231]
  s_nop 3
  v_pk_mul_f32 v[10:11], v[216:217], v[248:249] op_sel:[0,0] op_sel_hi:[1,0]
  v_exp_f32 v10, v10
  v_exp_f32 v11, v11
  v_cmp_lt_f32 vcc, 0, v216
  v_cmp_lt_f32 s[52:53], 0, v217
  v_pk_fma_f32 v[216:217], v[216:217], v[12:13], v[206:207] op_sel:[0,0,0] op_sel_hi:[1,0,0]
  v_cndmask_b32 v216, v10, v216, vcc
  v_cndmask_b32 v217, v11, v217, s[52:53]
  v_pk_add_f32 v[216:217], v[216:217], v[206:207] op_sel:[0,1] op_sel_hi:[1,1]
  v_cvt_pk_bf16_f32 v188, v216, v217
  v_pk_mul_f32 v[10:11], v[218:219], v[248:249] op_sel:[0,0] op_sel_hi:[1,0]
  v_exp_f32 v10, v10
  v_exp_f32 v11, v11
  v_cmp_lt_f32 vcc, 0, v218
  v_cmp_lt_f32 s[52:53], 0, v219
  v_pk_fma_f32 v[218:219], v[218:219], v[12:13], v[206:207] op_sel:[0,0,0] op_sel_hi:[1,0,0]
  v_cndmask_b32 v218, v10, v218, vcc
  v_cndmask_b32 v219, v11, v219, s[52:53]
  v_pk_add_f32 v[218:219], v[218:219], v[206:207] op_sel:[0,1] op_sel_hi:[1,1]
  v_cvt_pk_bf16_f32 v189, v218, v219
  v_pk_mul_f32 v[10:11], v[220:221], v[248:249] op_sel:[0,1] op_sel_hi:[1,1]
  v_exp_f32 v10, v10
  v_exp_f32 v11, v11
  v_cmp_lt_f32 vcc, 0, v220
  v_cmp_lt_f32 s[52:53], 0, v221
  v_pk_fma_f32 v[220:221], v[220:221], v[12:13], v[206:207] op_sel:[0,1,0] op_sel_hi:[1,1,0]
  v_cndmask_b32 v220, v10, v220, vcc
  v_cndmask_b32 v221, v11, v221, s[52:53]
  v_pk_add_f32 v[220:221], v[220:221], v[206:207] op_sel:[0,1] op_sel_hi:[1,1]
  v_cvt_pk_bf16_f32 v190, v220, v221
  v_pk_mul_f32 v[10:11], v[222:223], v[248:249] op_sel:[0,1] op_sel_hi:[1,1]
  v_exp_f32 v10, v10
  v_exp_f32 v11, v11
  v_cmp_lt_f32 vcc, 0, v222
  v_cmp_lt_f32 s[52:53], 0, v223
  v_pk_fma_f32 v[222:223], v[222:223], v[12:13], v[206:207] op_sel:[0,1,0] op_sel_hi:[1,1,0]
  v_cndmask_b32 v222, v10, v222, vcc
  v_cndmask_b32 v223, v11, v223, s[52:53]
  v_pk_add_f32 v[222:223], v[222:223], v[206:207] op_sel:[0,1] op_sel_hi:[1,1]
  v_cvt_pk_bf16_f32 v191, v222, v223
  v_permlane16_swap_b32 v188, v190
  s_nop 0
  v_permlane16_swap_b32 v189, v191
  buffer_store_dwordx4 v[188:191], v7, s[4:7], s44 offen offset:0 sc1
  s_waitcnt vmcnt(1)
  v_readfirstlane_b32 s46, v205
  s_cmp_lg_u32 s3, 0
  s_cbranch_scc1 KVL_no
  s_cmp_lg_u32 s46, 15
  s_cbranch_scc1 KVL_no
  v_mov_b32 v205, 1
  buffer_store_dword v205, v204, s[4:7], 0 offen offset:2048 sc1
KVL_no:
  v_pk_mul_f32 v[10:11], v[224:225], v[248:249] op_sel:[0,0] op_sel_hi:[1,0]
  v_exp_f32 v10, v10
  v_exp_f32 v11, v11
  v_cmp_lt_f32 vcc, 0, v224
  v_cmp_lt_f32 s[52:53], 0, v225
  v_pk_fma_f32 v[224:225], v[224:225], v[12:13], v[206:207] op_sel:[0,0,0] op_sel_hi:[1,0,0]
  v_cndmask_b32 v224, v10, v224, vcc
  v_cndmask_b32 v225, v11, v225, s[52:53]
  v_pk_add_f32 v[224:225], v[224:225], v[206:207] op_sel:[0,1] op_sel_hi:[1,1]
  v_cvt_pk_bf16_f32 v192, v224, v225
  v_pk_mul_f32 v[10:11], v[226:227], v[248:249] op_sel:[0,0] op_sel_hi:[1,0]
  v_exp_f32 v10, v10
  v_exp_f32 v11, v11
  v_cmp_lt_f32 vcc, 0, v226
  v_cmp_lt_f32 s[52:53], 0, v227
  v_pk_fma_f32 v[226:227], v[226:227], v[12:13], v[206:207] op_sel:[0,0,0] op_sel_hi:[1,0,0]
  v_cndmask_b32 v226, v10, v226, vcc
  v_cndmask_b32 v227, v11, v227, s[52:53]
  v_pk_add_f32 v[226:227], v[226:227], v[206:207] op_sel:[0,1] op_sel_hi:[1,1]
  v_cvt_pk_bf16_f32 v193, v226, v227
  v_pk_mul_f32 v[10:11], v[228:229], v[248:249] op_sel:[0,1] op_sel_hi:[1,1]
  v_exp_f32 v10, v10
  v_exp_f32 v11, v11
  v_cmp_lt_f32 vcc, 0, v228
  v_cmp_lt_f32 s[52:53], 0, v229
  v_pk_fma_f32 v[228:229], v[228:229], v[12:13], v[206:207] op_sel:[0,1,0] op_sel_hi:[1,1,0]
  v_cndmask_b32 v228, v10, v228, vcc
  v_cndmask_b32 v229, v11, v229, s[52:53]
  v_pk_add_f32 v[228:229], v[228:229], v[206:207] op_sel:[0,1] op_sel_hi:[1,1]
  v_cvt_pk_bf16_f32 v194, v228, v229
  v_pk_mul_f32 v[10:11], v[230:231], v[248:249] op_sel:[0,1] op_sel_hi:[1,1]
  v_exp_f32 v10, v10
  v_exp_f32 v11, v11
  v_cmp_lt_f32 vcc, 0, v230
  v_cmp_lt_f32 s[52:53], 0, v231
  v_pk_fma_f32 v[230:231], v[230:231], v[12:13], v[206:207] op_sel:[0,1,0] op_sel_hi:[1,1,0]
  v_cndmask_b32 v230, v10, v230, vcc
  v_cndmask_b32 v231, v11, v231, s[52:53]
  v_pk_add_f32 v[230:231], v[230:231], v[206:207] op_sel:[0,1] op_sel_hi:[1,1]
  v_cvt_pk_bf16_f32 v195, v230, v231
  v_permlane16_swap_b32 v192, v194
  s_nop 0
  v_permlane16_swap_b32 v193, v195
  buffer_store_dwordx4 v[192:195], v7, s[4:7], s44 offen offset:1024 sc1
  v_pk_mul_f32 v[10:11], v[208:209], v[248:249] op_sel:[0,0] op_sel_hi:[1,0]
  v_exp_f32 v10, v10
  v_exp_f32 v11, v11
  v_cmp_lt_f32 vcc, 0, v208
  v_cmp_lt_f32 s[52:53], 0, v209
  v_pk_fma_f32 v[208:209], v[208:209], v[12:13], v[206:207] op_sel:[0,0,0] op_sel_hi:[1,0,0]
  v_cndmask_b32 v208, v10, v208, vcc
  v_cndmask_b32 v209, v11, v209, s[52:53]
  v_pk_add_f32 v[208:209], v[208:209], v[206:207] op_sel:[0,1] op_sel_hi:[1,1]
  v_cvt_pk_bf16_f32 v186, v208, v209
  v_pk_mul_f32 v[10:11], v[210:211], v[248:249] op_sel:[0,0] op_sel_hi:[1,0]
  v_exp_f32 v10, v10
  v_exp_f32 v11, v11
  v_cmp_lt_f32 vcc, 0, v210
  v_cmp_lt_f32 s[52:53], 0, v211
  v_pk_fma_f32 v[210:211], v[210:211], v[12:13], v[206:207] op_sel:[0,0,0] op_sel_hi:[1,0,0]
  v_cndmask_b32 v210, v10, v210, vcc
  v_cndmask_b32 v211, v11, v211, s[52:53]
  v_pk_add_f32 v[210:211], v[210:211], v[206:207] op_sel:[0,1] op_sel_hi:[1,1]
  v_cvt_pk_bf16_f32 v187, v210, v211
  v_pk_mul_f32 v[10:11], v[212:213], v[248:249] op_sel:[0,1] op_sel_hi:[1,1]
  v_exp_f32 v10, v10
  v_exp_f32 v11, v11
  v_cmp_lt_f32 vcc, 0, v212
  v_cmp_lt_f32 s[52:53], 0, v213
  v_pk_fma_f32 v[212:213], v[212:213], v[12:13], v[206:207] op_sel:[0,1,0] op_sel_hi:[1,1,0]
  v_cndmask_b32 v212, v10, v212, vcc
  v_cndmask_b32 v213, v11, v213, s[52:53]
  v_pk_add_f32 v[212:213], v[212:213], v[206:207] op_sel:[0,1] op_sel_hi:[1,1]
  v_cvt_pk_bf16_f32 v184, v212, v213
  v_pk_mul_f32 v[10:11], v[214:215], v[248:249] op_sel:[0,1] op_sel_hi:[1,1]
  v_exp_f32 v10, v10
  v_exp_f32 v11, v11
  v_cmp_lt_f32 vcc, 0, v214
  v_cmp_lt_f32 s[52:53], 0, v215
  v_pk_fma_f32 v[214:215], v[214:215], v[12:13], v[206:207] op_sel:[0,1,0] op_sel_hi:[1,1,0]
  v_cndmask_b32 v214, v10, v214, vcc
  v_cndmask_b32 v215, v11, v215, s[52:53]
  v_pk_add_f32 v[214:215], v[214:215], v[206:207] op_sel:[0,1] op_sel_hi:[1,1]
  v_cvt_pk_bf16_f32 v185, v214, v215
  v_permlane16_swap_b32 v186, v184
  s_nop 0
  v_permlane16_swap_b32 v187, v185
  v_mov_b32 v186, 0
  v_mov_b32 v187, 0
  buffer_store_dwordx4 v[184:187], v14, s[4:7], s44 offen offset:1536 sc1
  s_lshl_b32 s46, s38, 4
  s_add_u32 s46, s46, s39
  s_lshl_b32 s46, s46, 7
  s_add_u32 s46, s46, 5308416
  s_add_u32 s46, s46, s50
  s_cmp_eq_u32 s3, 0
  s_cselect_b32 s46, s46, s49
  v_mov_b32 v2, s49
  v_writelane_b32 v2, s46, 0
  v_mov_b32 v3, 1
  s_waitcnt vmcnt(0)
  s_barrier
  buffer_store_dword v3, v2, s[4:7], 0 offen sc1
  v_and_b32 v5, 15, v0
  v_lshrrev_b32 v6, 4, v0
  s_lshl_b32 s38, s36, 3
  s_lshr_b32 s39, s37, 2
  s_add_u32 s38, s38, s39
  s_and_b32 s39, s37, 3
  s_mul_i32 s40, s3, 14592
  s_add_u32 s40, s40, 4980736
  s_add_u32 s40, s40, s50
  s_mul_i32 s42, s3, 18432
  s_add_u32 s43, s42, 15360
  v_mov_b32 v12, s43
  v_lshl_add_u32 v7, v6, 5, s42
  v_mad_u32_u24 v8, v5, 48, v7
  v_mad_u32_u24 v8, v5, 48, v8
  v_cmp_eq_u32 vcc, 3, v6
  s_nop 1
  v_cndmask_b32 v8, v8, v12, vcc
  v_mov_b32 v13, 1824
  v_cndmask_b32 v13, v13, 0, vcc
  v_mov_b32 v9, v12
  v_mov_b32 v4, 0
  s_mov_b32 exec_lo, 0x11111111
  s_mov_b32 exec_hi, 0x1111
  v_add_u32 v9, 1728, v7
  v_mov_b32 v4, 3648
  s_mov_b32 exec_lo, 0x20002
  s_mov_b32 exec_hi, 0x2
  v_add_u32 v9, 1536, v7
  v_mov_b32 v4, 3648
  s_mov_b32 exec_lo, 0x200020
  s_mov_b32 exec_hi, 0x20
  v_add_u32 v9, 1632, v7
  v_mov_b32 v4, 3648
  s_mov_b64 exec, -1
  v_mov_b32 v10, v12
  v_mov_b32 v2, 0
  s_mov_b32 exec_lo, 0x11111111
  s_mov_b32 exec_hi, 0x1111
  v_add_u32 v10, 3552, v7
  v_mov_b32 v2, 3648
  s_mov_b32 exec_lo, 0x2000200
  s_mov_b32 exec_hi, 0x200
  v_add_u32 v10, 3360, v7
  v_mov_b32 v2, 3648
  s_mov_b32 exec_lo, 0x20002000
  s_mov_b32 exec_hi, 0x2000
  v_add_u32 v10, 3456, v7
  v_mov_b32 v2, 3648
  s_mov_b64 exec, -1
  v_mov_b32 v247, v2
  s_lshl_b32 s41, s38, 4
  s_lshl_b32 s44, s3, 2
  s_add_u32 s41, s41, s44
  s_mul_i32 s41, s41, 2560
  s_add_u32 s41, s41, 2359296
  s_add_u32 s41, s41, s50
  v_lshlrev_b32 v11, 9, v6
  v_lshl_add_u32 v11, v5, 4, v11
  v_mov_b32 v3, s49
  v_cmp_eq_u32 vcc, 3, v6
  s_nop 1
  v_cndmask_b32 v11, v11, v3, vcc
  v_mov_b32 v248, 0
  v_mov_b32 v249, 0
  v_mov_b32 v250, 0
  v_mov_b32 v251, 0
  ds_write_b128 v12, v[248:251]
  ds_write_b128 v12, v[248:251] offset:16
  s_cmp_lg_u32 s3, 0
  s_cbranch_scc1 W1_done
  s_add_u32 s46, s50, 5179392
  v_and_b32 v2, 15, v0
  v_lshlrev_b32 v2, 7, v2
  s_lshr_b32 s47, s38, 2
  s_lshl_b32 s47, s47, 11
  s_add_u32 s47, s47, 129024
  v_add_u32 v3, s47, v2
  v_cmp_lt_u32 vcc, 31, v0
  s_nop 1
  v_cndmask_b32 v2, v2, v3, vcc
  v_cndmask_b32 v246, 1, 1, vcc
  s_mov_b32 s47, 0
W1_poll:
  buffer_load_dword v3, v2, s[4:7], s46 offen sc1
  s_add_u32 s47, s47, 1
  s_waitcnt vmcnt(0)
  v_cmp_ne_u32 vcc, v246, v3
  s_cmp_gt_u32 s47, 131072
  s_cbranch_scc1 W1_done
  s_cmp_eq_u64 vcc, 0
  s_cbranch_scc0 W1_poll
W1_done:
  s_waitcnt vmcnt(0) lgkmcnt(0)
  s_barrier
  s_mov_b32 m0, s42
  s_nop 0
  buffer_load_dwordx4 v1, s[4:7], s40 offen offset:0 sc1 lds
  buffer_load_dwordx4 v1, s[4:7], s40 offen offset:1024 sc1 lds
  buffer_load_dwordx4 v[16:19], v11, s[4:7], s41 offen offset:0 sc1
  buffer_load_dwordx4 v[20:23], v11, s[4:7], s41 offen offset:256 sc1
  buffer_load_dwordx4 v1, s[4:7], s40 offen offset:2048 sc1 lds
  buffer_load_dwordx4 v1, s[4:7], s40 offen offset:3072 sc1 lds
  s_add_u32 s40, s40, 4096
  s_add_u32 m0, m0, 4096
  buffer_load_dwordx4 v[24:27], v11, s[4:7], s41 offen offset:1024 sc1
  buffer_load_dwordx4 v[28:31], v11, s[4:7], s41 offen offset:1280 sc1
  s_add_u32 s41, s41, 2560
  buffer_load_dwordx4 v1, s[4:7], s40 offen offset:0 sc1 lds
  buffer_load_dwordx4 v1, s[4:7], s40 offen offset:1024 sc1 lds
  buffer_load_dwordx4 v[32:35], v11, s[4:7], s41 offen offset:0 sc1
  buffer_load_dwordx4 v[36:39], v11, s[4:7], s41 offen offset:256 sc1
  buffer_load_dwordx4 v1, s[4:7], s40 offen offset:2048 sc1 lds
  buffer_load_dwordx4 v1, s[4:7], s40 offen offset:3072 sc1 lds
  s_add_u32 s40, s40, 4096
  s_add_u32 m0, m0, 4096
  buffer_load_dwordx4 v[40:43], v11, s[4:7], s41 offen offset:1024 sc1
  buffer_load_dwordx4 v[44:47], v11, s[4:7], s41 offen offset:1280 sc1
  s_add_u32 s41, s41, 2560
  v_mov_b32 v178, 0
  v_mov_b32 v179, 0
  v_mov_b32 v182, 0
  v_mov_b32 v183, 0
  s_waitcnt vmcnt(14)
  ds_read_b128 v[80:83], v8 offset:0
  ds_read_b128 v[84:87], v8 offset:16
  ds_read_b128 v[88:91], v9 offset:0
  ds_read_b128 v[92:95], v9 offset:16
  v_add_u32 v8, v8, v13
  s_waitcnt vmcnt(10)
  ds_read_b128 v[96:99], v8 offset:0
  ds_read_b128 v[100:103], v8 offset:16
  ds_read_b128 v[104:107], v10 offset:0
  ds_read_b128 v[108:111], v10 offset:16
  v_add_u32 v8, v8, v13
  v_add_u32 v9, v9, v4
  v_add_u32 v10, v10, v247
  s_waitcnt vmcnt(6)
  ds_read_b128 v[112:115], v8 offset:0
  ds_read_b128 v[116:119], v8 offset:16
  ds_read_b128 v[120:123], v9 offset:0
  ds_read_b128 v[124:127], v9 offset:16
  v_add_u32 v8, v8, v13
  s_waitcnt lgkmcnt(8)
  v_cvt_pk_bf16_f32 v80, v80, v81
  v_cvt_pk_bf16_f32 v81, v82, v83
  v_cvt_pk_bf16_f32 v82, v84, v85
  v_cvt_pk_bf16_f32 v83, v86, v87
  v_cvt_pk_bf16_f32 v88, v88, v89
  v_cvt_pk_bf16_f32 v89, v90, v91
  v_cvt_pk_bf16_f32 v90, v92, v93
  v_cvt_pk_bf16_f32 v91, v94, v95
  v_mfma_f32_16x16x32_bf16 v[84:87], v[80:83], v[16:19], 0
  s_nop 0
  v_mfma_f32_16x16x32_bf16 v[92:95], v[88:91], v[16:19], 0
  v_mfma_f32_16x16x32_bf16 v[248:251], v[80:83], v[20:23], 0
  v_mfma_f32_16x16x32_bf16 v[252:255], v[88:91], v[20:23], 0
  s_waitcnt lgkmcnt(4)
  buffer_load_dwordx4 v1, s[4:7], s40 offen offset:0 sc1 lds
  buffer_load_dwordx4 v1, s[4:7], s40 offen offset:1024 sc1 lds
  buffer_load_dwordx4 v[48:51], v11, s[4:7], s41 offen offset:0 sc1
  buffer_load_dwordx4 v[52:55], v11, s[4:7], s41 offen offset:256 sc1
  v_cvt_pk_bf16_f32 v96, v96, v97
  v_cvt_pk_bf16_f32 v97, v98, v99
  v_cvt_pk_bf16_f32 v98, v100, v101
  v_cvt_pk_bf16_f32 v99, v102, v103
  v_cvt_pk_bf16_f32 v104, v104, v105
  v_cvt_pk_bf16_f32 v105, v106, v107
  v_cvt_pk_bf16_f32 v106, v108, v109
  v_cvt_pk_bf16_f32 v107, v110, v111
  v_add_f32 v92, 0x358637bd, v92
  v_add_f32 v252, 0x358637bd, v252
  v_mfma_f32_16x16x32_bf16 v[100:103], v[96:99], v[24:27], 0
  v_rcp_f32 v92, v92
  v_rcp_f32 v252, v252
  v_mfma_f32_16x16x32_bf16 v[108:111], v[104:107], v[24:27], 0
  v_mul_f32 v84, v84, v92
  v_mul_f32 v248, v248, v252
  v_mfma_f32_16x16x32_bf16 v[224:227], v[96:99], v[28:31], 0
  v_mul_f32 v85, v85, v92
  v_mul_f32 v249, v249, v252
  v_mfma_f32_16x16x32_bf16 v[228:231], v[104:107], v[28:31], 0
  v_mul_f32 v86, v86, v92
  v_mul_f32 v250, v250, v252
  v_mul_f32 v87, v87, v92
  v_mul_f32 v251, v251, v252
  v_cvt_pk_bf16_f32 v144, v84, v85
  v_cvt_pk_bf16_f32 v148, v248, v249
  v_cvt_pk_bf16_f32 v145, v86, v87
  v_cvt_pk_bf16_f32 v149, v250, v251
  v_mul_f32 v2, v93, v92
  v_mul_f32 v3, v253, v252
  s_waitcnt vmcnt(6)
  ds_read_b128 v[128:131], v8 offset:0
  ds_read_b128 v[132:135], v8 offset:16
  ds_read_b128 v[136:139], v10 offset:0
  ds_read_b128 v[140:143], v10 offset:16
  v_add_u32 v8, v8, v13
  v_add_u32 v9, v9, v4
  v_add_u32 v10, v10, v247
  s_waitcnt lgkmcnt(4)
  buffer_load_dwordx4 v1, s[4:7], s40 offen offset:2048 sc1 lds
  buffer_load_dwordx4 v1, s[4:7], s40 offen offset:3072 sc1 lds
  s_add_u32 s40, s40, 4096
  s_add_u32 m0, m0, 4096
  buffer_load_dwordx4 v[56:59], v11, s[4:7], s41 offen offset:1024 sc1
  buffer_load_dwordx4 v[60:63], v11, s[4:7], s41 offen offset:1280 sc1
  s_add_u32 s41, s41, 2560
  v_cvt_pk_bf16_f32 v112, v112, v113
  v_cvt_pk_bf16_f32 v113, v114, v115
  v_cvt_pk_bf16_f32 v114, v116, v117
  v_cvt_pk_bf16_f32 v115, v118, v119
  v_cvt_pk_bf16_f32 v120, v120, v121
  v_cvt_pk_bf16_f32 v121, v122, v123
  v_cvt_pk_bf16_f32 v122, v124, v125
  v_cvt_pk_bf16_f32 v123, v126, v127
  v_add_f32 v108, 0x358637bd, v108
  v_add_f32 v228, 0x358637bd, v228
  v_mfma_f32_16x16x32_bf16 v[116:119], v[112:115], v[32:35], 0
  v_rcp_f32 v108, v108
  v_rcp_f32 v228, v228
  v_mfma_f32_16x16x32_bf16 v[124:127], v[120:123], v[32:35], 0
  v_mul_f32 v100, v100, v108
  v_mul_f32 v224, v224, v228
  v_mfma_f32_16x16x32_bf16 v[248:251], v[112:115], v[36:39], 0
  v_mul_f32 v101, v101, v108
  v_mul_f32 v225, v225, v228
  v_mfma_f32_16x16x32_bf16 v[252:255], v[120:123], v[36:39], 0
  v_mul_f32 v102, v102, v108
  v_mul_f32 v226, v226, v228
  v_mul_f32 v103, v103, v108
  v_mul_f32 v227, v227, v228
  v_cvt_pk_bf16_f32 v146, v100, v101
  v_cvt_pk_bf16_f32 v150, v224, v225
  v_cvt_pk_bf16_f32 v147, v102, v103
  v_cvt_pk_bf16_f32 v151, v226, v227
  v_fma_f32 v14, v109, v108, v2
  v_fma_f32 v15, v229, v228, v3
  s_waitcnt vmcnt(7)
  ds_read_b128 v[80:83], v8 offset:0
  ds_read_b128 v[84:87], v8 offset:16
  ds_read_b128 v[88:91], v9 offset:0
  ds_read_b128 v[92:95], v9 offset:16
  v_add_u32 v8, v8, v13
  s_waitcnt lgkmcnt(4)
  buffer_load_dwordx4 v1, s[4:7], s40 offen offset:0 sc1 lds
  buffer_load_dwordx4 v1, s[4:7], s40 offen offset:1024 sc1 lds
  buffer_load_dwordx4 v[64:67], v11, s[4:7], s41 offen offset:0 sc1
  buffer_load_dwordx4 v[68:71], v11, s[4:7], s41 offen offset:256 sc1
  v_cvt_pk_bf16_f32 v128, v128, v129
  v_cvt_pk_bf16_f32 v129, v130, v131
  v_cvt_pk_bf16_f32 v130, v132, v133
  v_mfma_f32_16x16x32_bf16 a[180:183], a[0:3], v[144:147], 0
  v_cvt_pk_bf16_f32 v131, v134, v135
  v_cvt_pk_bf16_f32 v136, v136, v137
  v_cvt_pk_bf16_f32 v137, v138, v139
  v_mfma_f32_16x16x32_bf16 a[184:187], a[0:3], v[148:151], 0
  v_cvt_pk_bf16_f32 v138, v140, v141
  v_cvt_pk_bf16_f32 v139, v142, v143
  v_add_f32 v124, 0x358637bd, v124
  v_add_f32 v252, 0x358637bd, v252
  v_mfma_f32_16x16x32_bf16 v[132:135], v[128:131], v[40:43], 0
  v_rcp_f32 v124, v124
  v_rcp_f32 v252, v252
  v_mfma_f32_16x16x32_bf16 v[140:143], v[136:139], v[40:43], 0
  v_mul_f32 v116, v116, v124
  v_mul_f32 v248, v248, v252
  v_mfma_f32_16x16x32_bf16 v[224:227], v[128:131], v[44:47], 0
  v_mul_f32 v117, v117, v124
  v_mul_f32 v249, v249, v252
  v_mfma_f32_16x16x32_bf16 v[228:231], v[136:139], v[44:47], 0
  v_mul_f32 v118, v118, v124
  v_mul_f32 v250, v250, v252
  v_mfma_f32_16x16x32_bf16 a[188:191], a[4:7], v[144:147], 0
  v_mul_f32 v119, v119, v124
  v_mul_f32 v251, v251, v252
  v_mfma_f32_16x16x32_bf16 a[192:195], a[4:7], v[148:151], 0
  v_cvt_pk_bf16_f32 v152, v116, v117
  v_cvt_pk_bf16_f32 v156, v248, v249
  v_mfma_f32_16x16x32_bf16 a[196:199], a[8:11], v[144:147], 0
  v_cvt_pk_bf16_f32 v153, v118, v119
  v_cvt_pk_bf16_f32 v157, v250, v251
  v_mfma_f32_16x16x32_bf16 a[200:203], a[8:11], v[148:151], 0
  v_mul_f32 v2, v125, v124
  v_mul_f32 v3, v253, v252
  v_mfma_f32_16x16x32_bf16 a[204:207], a[12:15], v[144:147], 0
  s_waitcnt vmcnt(7)
  ds_read_b128 v[96:99], v8 offset:0
  ds_read_b128 v[100:103], v8 offset:16
  ds_read_b128 v[104:107], v10 offset:0
  ds_read_b128 v[108:111], v10 offset:16
  v_add_u32 v8, v8, v13
  v_add_u32 v9, v9, v4
  v_add_u32 v10, v10, v247
  s_waitcnt lgkmcnt(4)
  buffer_load_dwordx4 v1, s[4:7], s40 offen offset:2048 sc1 lds
  buffer_load_dwordx4 v[72:75], v11, s[4:7], s41 offen offset:1024 sc1
  buffer_load_dwordx4 v[76:79], v11, s[4:7], s41 offen offset:1280 sc1
  s_add_u32 s41, s41, 2560
  v_cvt_pk_bf16_f32 v80, v80, v81
  v_cvt_pk_bf16_f32 v81, v82, v83
  v_cvt_pk_bf16_f32 v82, v84, v85
  v_mfma_f32_16x16x32_bf16 a[208:211], a[12:15], v[148:151], 0
  v_cvt_pk_bf16_f32 v83, v86, v87
  v_cvt_pk_bf16_f32 v88, v88, v89
  v_cvt_pk_bf16_f32 v89, v90, v91
  v_mfma_f32_16x16x32_bf16 a[212:215], a[16:19], v[144:147], 0
  v_cvt_pk_bf16_f32 v90, v92, v93
  v_cvt_pk_bf16_f32 v91, v94, v95
  v_add_f32 v140, 0x358637bd, v140
  v_add_f32 v228, 0x358637bd, v228
  v_mfma_f32_16x16x32_bf16 v[84:87], v[80:83], v[48:51], 0
  v_rcp_f32 v140, v140
  v_rcp_f32 v228, v228
  v_mfma_f32_16x16x32_bf16 v[92:95], v[88:91], v[48:51], 0
  v_mul_f32 v132, v132, v140
  v_mul_f32 v224, v224, v228
  v_mfma_f32_16x16x32_bf16 v[248:251], v[80:83], v[52:55], 0
  v_mul_f32 v133, v133, v140
  v_mul_f32 v225, v225, v228
  v_mfma_f32_16x16x32_bf16 v[252:255], v[88:91], v[52:55], 0
  v_mul_f32 v134, v134, v140
  v_mul_f32 v226, v226, v228
  v_mfma_f32_16x16x32_bf16 a[216:219], a[16:19], v[148:151], 0
  v_mul_f32 v135, v135, v140
  v_mul_f32 v227, v227, v228
  v_mfma_f32_16x16x32_bf16 a[220:223], a[20:23], v[144:147], 0
  v_cvt_pk_bf16_f32 v154, v132, v133
  v_cvt_pk_bf16_f32 v158, v224, v225
  v_mfma_f32_16x16x32_bf16 a[224:227], a[20:23], v[148:151], 0
  v_cvt_pk_bf16_f32 v155, v134, v135
  v_cvt_pk_bf16_f32 v159, v226, v227
  v_mfma_f32_16x16x32_bf16 a[228:231], a[24:27], v[144:147], 0
  v_fmac_f32 v2, v141, v140
  v_fmac_f32 v3, v229, v228
  v_mfma_f32_16x16x32_bf16 a[232:235], a[24:27], v[148:151], 0
  v_cvt_pk_bf16_f32 v176, v14, v2
  v_cvt_pk_bf16_f32 v180, v15, v3
  v_mfma_f32_16x16x32_bf16 a[236:239], a[28:31], v[144:147], 0
  s_waitcnt vmcnt(6)
  ds_read_b128 v[112:115], v8 offset:0
  ds_read_b128 v[116:119], v8 offset:16
  ds_read_b128 v[120:123], v9 offset:0
  ds_read_b128 v[124:127], v9 offset:16
  v_add_u32 v8, v8, v13
  s_waitcnt lgkmcnt(4)
  v_cvt_pk_bf16_f32 v96, v96, v97
  v_cvt_pk_bf16_f32 v97, v98, v99
  v_cvt_pk_bf16_f32 v98, v100, v101
  v_mfma_f32_16x16x32_bf16 a[240:243], a[28:31], v[148:151], 0
  v_cvt_pk_bf16_f32 v99, v102, v103
  v_cvt_pk_bf16_f32 v104, v104, v105
  v_cvt_pk_bf16_f32 v105, v106, v107
  v_mfma_f32_16x16x32_bf16 a[244:247], a[32:35], v[144:147], 0
  v_cvt_pk_bf16_f32 v106, v108, v109
  v_cvt_pk_bf16_f32 v107, v110, v111
  v_add_f32 v92, 0x358637bd, v92
  v_add_f32 v252, 0x358637bd, v252
  v_mfma_f32_16x16x32_bf16 v[100:103], v[96:99], v[56:59], 0
  v_rcp_f32 v92, v92
  v_rcp_f32 v252, v252
  v_mfma_f32_16x16x32_bf16 v[108:111], v[104:107], v[56:59], 0
  v_mul_f32 v84, v84, v92
  v_mul_f32 v248, v248, v252
  v_mfma_f32_16x16x32_bf16 v[224:227], v[96:99], v[60:63], 0
  v_mul_f32 v85, v85, v92
  v_mul_f32 v249, v249, v252
  v_mfma_f32_16x16x32_bf16 v[228:231], v[104:107], v[60:63], 0
  v_mul_f32 v86, v86, v92
  v_mul_f32 v250, v250, v252
  v_mfma_f32_16x16x32_bf16 a[248:251], a[32:35], v[148:151], 0
  v_mul_f32 v87, v87, v92
  v_mul_f32 v251, v251, v252
  v_mfma_f32_16x16x32_bf16 a[180:183], a[36:39], v[152:155], a[180:183]
  v_cvt_pk_bf16_f32 v160, v84, v85
  v_cvt_pk_bf16_f32 v164, v248, v249
  v_mfma_f32_16x16x32_bf16 a[184:187], a[36:39], v[156:159], a[184:187]
  v_cvt_pk_bf16_f32 v161, v86, v87
  v_cvt_pk_bf16_f32 v165, v250, v251
  v_mfma_f32_16x16x32_bf16 a[188:191], a[40:43], v[152:155], a[188:191]
  v_mul_f32 v2, v93, v92
  v_mul_f32 v3, v253, v252
  v_mfma_f32_16x16x32_bf16 a[192:195], a[40:43], v[156:159], a[192:195]
  s_waitcnt vmcnt(2)
  ds_read_b128 v[128:131], v8 offset:0
  ds_read_b128 v[132:135], v8 offset:16
  ds_read_b128 v[136:139], v10 offset:0
  ds_read_b128 v[140:143], v10 offset:16
  v_add_u32 v8, v8, v13
  v_add_u32 v9, v9, v4
  v_add_u32 v10, v10, v247
  s_and_b32 s43, s3, 1
  s_lshr_b32 s44, s3, 1
  s_mul_i32 s53, s38, 36864
  s_mul_i32 s46, s39, 9216
  s_add_u32 s53, s53, s46
  s_mul_i32 s46, s44, 5120
  s_add_u32 s53, s53, s46
  s_lshl_b32 s46, s43, 8
  s_add_u32 s53, s53, s46
  v_bfe_u32 v244, v0, 5, 1
  v_lshlrev_b32 v244, 9, v244
  v_and_b32 v245, 15, v0
  v_lshl_add_u32 v244, v245, 4, v244
  v_bfe_u32 v232, v0, 4, 1
  v_cmp_eq_u32 vcc, 1, v232
  v_mov_b32 v245, s49
  s_nop 0
  v_cndmask_b32 v245, v244, v245, vcc
  v_lshl_add_u32 v244, v232, 10, v244
  s_add_u32 s46, s53, 0
  s_add_u32 s46, s46, s50
  buffer_load_dwordx4 v[232:235], v244, s[4:7], s46 offen offset:0 sc1
  buffer_load_dwordx4 v[236:239], v244, s[4:7], s46 offen offset:2048 sc1
  s_add_u32 s46, s46, 4096
  buffer_load_dwordx4 v[240:243], v245, s[4:7], s46 offen offset:0 sc1
  s_add_u32 s54, s53, 5734400
  s_add_u32 s54, s54, s50
  s_waitcnt lgkmcnt(4)
  v_cvt_pk_bf16_f32 v112, v112, v113
  v_cvt_pk_bf16_f32 v113, v114, v115
  v_cvt_pk_bf16_f32 v114, v116, v117
  v_mfma_f32_16x16x32_bf16 a[196:199], a[44:47], v[152:155], a[196:199]
  v_cvt_pk_bf16_f32 v115, v118, v119
  v_cvt_pk_bf16_f32 v120, v120, v121
  v_cvt_pk_bf16_f32 v121, v122, v123
  v_mfma_f32_16x16x32_bf16 a[200:203], a[44:47], v[156:159], a[200:203]
  v_cvt_pk_bf16_f32 v122, v124, v125
  v_cvt_pk_bf16_f32 v123, v126, v127
  v_add_f32 v108, 0x358637bd, v108
  v_add_f32 v228, 0x358637bd, v228
  v_mfma_f32_16x16x32_bf16 v[116:119], v[112:115], v[64:67], 0
  v_rcp_f32 v108, v108
  v_rcp_f32 v228, v228
  v_mfma_f32_16x16x32_bf16 v[124:127], v[120:123], v[64:67], 0
  v_mul_f32 v100, v100, v108
  v_mul_f32 v224, v224, v228
  v_mfma_f32_16x16x32_bf16 v[248:251], v[112:115], v[68:71], 0
  v_mul_f32 v101, v101, v108
  v_mul_f32 v225, v225, v228
  v_mfma_f32_16x16x32_bf16 v[252:255], v[120:123], v[68:71], 0
  v_mul_f32 v102, v102, v108
  v_mul_f32 v226, v226, v228
  v_mfma_f32_16x16x32_bf16 a[204:207], a[48:51], v[152:155], a[204:207]
  v_mul_f32 v103, v103, v108
  v_mul_f32 v227, v227, v228
  v_mfma_f32_16x16x32_bf16 a[208:211], a[48:51], v[156:159], a[208:211]
  v_cvt_pk_bf16_f32 v162, v100, v101
  v_cvt_pk_bf16_f32 v166, v224, v225
  v_mfma_f32_16x16x32_bf16 a[212:215], a[52:55], v[152:155], a[212:215]
  v_cvt_pk_bf16_f32 v163, v102, v103
  v_cvt_pk_bf16_f32 v167, v226, v227
  v_mfma_f32_16x16x32_bf16 a[216:219], a[52:55], v[156:159], a[216:219]
  v_fma_f32 v14, v109, v108, v2
  v_fma_f32 v15, v229, v228, v3
  v_mfma_f32_16x16x32_bf16 a[220:223], a[56:59], v[152:155], a[220:223]
  s_lshr_b32 s15, s36, 1
  s_lshl_b32 s15, s15, 3
  s_lshr_b32 s13, s37, 2
  s_add_u32 s14, s15, s13
  s_mul_i32 s15, s14, 331776
  s_add_u32 s15, s15, 0
  s_mul_i32 s13, s3, 6144
  s_add_u32 s12, s15, s13
  s_add_u32 s12, s12, 0
  s_add_u32 m0, s13, 73728
  s_nop 0
  buffer_load_dwordx4 v1, s[4:7], s12 offen offset:0 sc1 lds
  buffer_load_dwordx4 v1, s[4:7], s12 offen offset:1024 sc1 lds
  s_waitcnt lgkmcnt(0)
  s_waitcnt vmcnt(5)
  v_cvt_pk_bf16_f32 v128, v128, v129
  v_cvt_pk_bf16_f32 v129, v130, v131
  v_cvt_pk_bf16_f32 v130, v132, v133
  v_mfma_f32_16x16x32_bf16 a[224:227], a[56:59], v[156:159], a[224:227]
  v_cvt_pk_bf16_f32 v131, v134, v135
  v_cvt_pk_bf16_f32 v136, v136, v137
  v_cvt_pk_bf16_f32 v137, v138, v139
  v_mfma_f32_16x16x32_bf16 a[228:231], a[60:63], v[152:155], a[228:231]
  v_cvt_pk_bf16_f32 v138, v140, v141
  v_cvt_pk_bf16_f32 v139, v142, v143
  v_add_f32 v124, 0x358637bd, v124
  v_add_f32 v252, 0x358637bd, v252
  v_mfma_f32_16x16x32_bf16 v[132:135], v[128:131], v[72:75], 0
  v_rcp_f32 v124, v124
  v_rcp_f32 v252, v252
  v_mfma_f32_16x16x32_bf16 v[140:143], v[136:139], v[72:75], 0
  v_mul_f32 v116, v116, v124
  v_mul_f32 v248, v248, v252
  v_mfma_f32_16x16x32_bf16 v[224:227], v[128:131], v[76:79], 0
  v_mul_f32 v117, v117, v124
  v_mul_f32 v249, v249, v252
  v_mfma_f32_16x16x32_bf16 v[228:231], v[136:139], v[76:79], 0
  v_mul_f32 v118, v118, v124
  v_mul_f32 v250, v250, v252
  v_mfma_f32_16x16x32_bf16 a[232:235], a[60:63], v[156:159], a[232:235]
  v_mul_f32 v119, v119, v124
  v_mul_f32 v251, v251, v252
  v_mfma_f32_16x16x32_bf16 a[236:239], a[64:67], v[152:155], a[236:239]
  v_cvt_pk_bf16_f32 v168, v116, v117
  v_cvt_pk_bf16_f32 v172, v248, v249
  v_mfma_f32_16x16x32_bf16 a[240:243], a[64:67], v[156:159], a[240:243]
  v_cvt_pk_bf16_f32 v169, v118, v119
  v_cvt_pk_bf16_f32 v173, v250, v251
  v_mfma_f32_16x16x32_bf16 a[244:247], a[68:71], v[152:155], a[244:247]
  v_mul_f32 v2, v125, v124
  v_mul_f32 v3, v253, v252
  v_mfma_f32_16x16x32_bf16 a[248:251], a[68:71], v[156:159], a[248:251]
  buffer_load_dwordx4 v1, s[4:7], s12 offen offset:2048 sc1 lds
  buffer_load_dwordx4 v1, s[4:7], s12 offen offset:3072 sc1 lds
  s_add_u32 s12, s12, 4096
  s_add_u32 m0, m0, 4096
  v_add_f32 v140, 0x358637bd, v140
  v_add_f32 v228, 0x358637bd, v228
  v_mfma_f32_16x16x32_bf16 a[180:183], a[72:75], v[160:163], a[180:183]
  v_rcp_f32 v140, v140
  v_rcp_f32 v228, v228
  v_mfma_f32_16x16x32_bf16 a[184:187], a[72:75], v[164:167], a[184:187]
  v_mul_f32 v132, v132, v140
  v_mul_f32 v224, v224, v228
  v_mfma_f32_16x16x32_bf16 a[188:191], a[76:79], v[160:163], a[188:191]
  v_mul_f32 v133, v133, v140
  v_mul_f32 v225, v225, v228
  v_mfma_f32_16x16x32_bf16 a[192:195], a[76:79], v[164:167], a[192:195]
  v_mul_f32 v134, v134, v140
  v_mul_f32 v226, v226, v228
  v_mfma_f32_16x16x32_bf16 a[196:199], a[80:83], v[160:163], a[196:199]
  v_mul_f32 v135, v135, v140
  v_mul_f32 v227, v227, v228
  v_mfma_f32_16x16x32_bf16 a[200:203], a[80:83], v[164:167], a[200:203]
  v_cvt_pk_bf16_f32 v170, v132, v133
  v_cvt_pk_bf16_f32 v174, v224, v225
  v_mfma_f32_16x16x32_bf16 a[204:207], a[84:87], v[160:163], a[204:207]
  v_cvt_pk_bf16_f32 v171, v134, v135
  v_cvt_pk_bf16_f32 v175, v226, v227
  v_mfma_f32_16x16x32_bf16 a[208:211], a[84:87], v[164:167], a[208:211]
  v_fmac_f32 v2, v141, v140
  v_fmac_f32 v3, v229, v228
  v_mfma_f32_16x16x32_bf16 a[212:215], a[88:91], v[160:163], a[212:215]
  v_cvt_pk_bf16_f32 v177, v14, v2
  v_cvt_pk_bf16_f32 v181, v15, v3
  v_mfma_f32_16x16x32_bf16 a[216:219], a[88:91], v[164:167], a[216:219]
  buffer_load_dwordx4 v1, s[4:7], s12 offen offset:0 sc1 lds
  buffer_load_dwordx4 v1, s[4:7], s12 offen offset:1024 sc1 lds
  v_mfma_f32_16x16x32_bf16 a[220:223], a[92:95], v[160:163], a[220:223]
  v_mfma_f32_16x16x32_bf16 a[224:227], a[92:95], v[164:167], a[224:227]
  v_mfma_f32_16x16x32_bf16 a[228:231], a[96:99], v[160:163], a[228:231]
  v_mfma_f32_16x16x32_bf16 a[232:235], a[96:99], v[164:167], a[232:235]
  v_mfma_f32_16x16x32_bf16 a[236:239], a[100:103], v[160:163], a[236:239]
  v_mfma_f32_16x16x32_bf16 a[240:243], a[100:103], v[164:167], a[240:243]
  v_mfma_f32_16x16x32_bf16 a[244:247], a[104:107], v[160:163], a[244:247]
  v_mfma_f32_16x16x32_bf16 a[248:251], a[104:107], v[164:167], a[248:251]
  s_mul_i32 s47, s3, 18432
  s_add_u32 s47, s47, 0
  v_add_u32 v8, s47, v1
  v_mfma_f32_16x16x32_bf16 a[180:183], a[108:111], v[168:171], a[180:183]
  v_mfma_f32_16x16x32_bf16 a[184:187], a[108:111], v[172:175], a[184:187]
  v_mfma_f32_16x16x32_bf16 a[180:183], a[144:147], v[176:179], a[180:183]
  v_mfma_f32_16x16x32_bf16 a[184:187], a[144:147], v[180:183], a[184:187]
  v_mfma_f32_16x16x32_bf16 a[188:191], a[112:115], v[168:171], a[188:191]
  v_mfma_f32_16x16x32_bf16 a[192:195], a[112:115], v[172:175], a[192:195]
  v_mfma_f32_16x16x32_bf16 a[188:191], a[148:151], v[176:179], a[188:191]
  v_mfma_f32_16x16x32_bf16 a[192:195], a[148:151], v[180:183], a[192:195]
  v_mfma_f32_16x16x32_bf16 a[196:199], a[116:119], v[168:171], a[196:199]
  v_mfma_f32_16x16x32_bf16 a[200:203], a[116:119], v[172:175], a[200:203]
  s_nop 0
  ds_write_b128 v8, a[180:183] offset:0
  v_mfma_f32_16x16x32_bf16 a[196:199], a[152:155], v[176:179], a[196:199]
  v_mfma_f32_16x16x32_bf16 a[200:203], a[152:155], v[180:183], a[200:203]
  ds_write_b128 v8, a[184:187] offset:1024
  v_mfma_f32_16x16x32_bf16 a[204:207], a[120:123], v[168:171], a[204:207]
  v_mfma_f32_16x16x32_bf16 a[208:211], a[120:123], v[172:175], a[208:211]
  ds_write_b128 v8, a[188:191] offset:2048
  v_mfma_f32_16x16x32_bf16 a[204:207], a[156:159], v[176:179], a[204:207]
  v_mfma_f32_16x16x32_bf16 a[208:211], a[156:159], v[180:183], a[208:211]
  ds_write_b128 v8, a[192:195] offset:3072
  v_mfma_f32_16x16x32_bf16 a[212:215], a[124:127], v[168:171], a[212:215]
  v_mfma_f32_16x16x32_bf16 a[216:219], a[124:127], v[172:175], a[216:219]
  ds_write_b128 v8, a[196:199] offset:4096
  v_mfma_f32_16x16x32_bf16 a[212:215], a[160:163], v[176:179], a[212:215]
  v_mfma_f32_16x16x32_bf16 a[216:219], a[160:163], v[180:183], a[216:219]
  ds_write_b128 v8, a[200:203] offset:5120
  v_mfma_f32_16x16x32_bf16 a[220:223], a[128:131], v[168:171], a[220:223]
  v_mfma_f32_16x16x32_bf16 a[224:227], a[128:131], v[172:175], a[224:227]
  ds_write_b128 v8, a[204:207] offset:6144
  v_mfma_f32_16x16x32_bf16 a[220:223], a[164:167], v[176:179], a[220:223]
  v_mfma_f32_16x16x32_bf16 a[224:227], a[164:167], v[180:183], a[224:227]
  ds_write_b128 v8, a[208:211] offset:7168
  v_mfma_f32_16x16x32_bf16 a[228:231], a[132:135], v[168:171], a[228:231]
  v_mfma_f32_16x16x32_bf16 a[232:235], a[132:135], v[172:175], a[232:235]
  ds_write_b128 v8, a[212:215] offset:8192
  v_mfma_f32_16x16x32_bf16 a[228:231], a[168:171], v[176:179], a[228:231]
  v_mfma_f32_16x16x32_bf16 a[232:235], a[168:171], v[180:183], a[232:235]
  ds_write_b128 v8, a[216:219] offset:9216
  v_mfma_f32_16x16x32_bf16 a[236:239], a[136:139], v[168:171], a[236:239]
  v_mfma_f32_16x16x32_bf16 a[240:243], a[136:139], v[172:175], a[240:243]
  ds_write_b128 v8, a[220:223] offset:10240
  v_mfma_f32_16x16x32_bf16 a[236:239], a[172:175], v[176:179], a[236:239]
  v_mfma_f32_16x16x32_bf16 a[240:243], a[172:175], v[180:183], a[240:243]
  ds_write_b128 v8, a[224:227] offset:11264
  v_mfma_f32_16x16x32_bf16 a[244:247], a[140:143], v[168:171], a[244:247]
  v_mfma_f32_16x16x32_bf16 a[248:251], a[140:143], v[172:175], a[248:251]
  ds_write_b128 v8, a[228:231] offset:12288
  v_mfma_f32_16x16x32_bf16 a[244:247], a[176:179], v[176:179], a[244:247]
  v_mfma_f32_16x16x32_bf16 a[248:251], a[176:179], v[180:183], a[248:251]
  ds_write_b128 v8, a[232:235] offset:13312
  ds_write_b128 v8, a[236:239] offset:14336
  ds_write_b128 v8, a[240:243] offset:15360
  s_nop 3
  ds_write_b128 v8, a[244:247] offset:16384
  ds_write_b128 v8, a[248:251] offset:17408
  s_mul_i32 s13, s3, 6144
  s_add_u32 s12, s15, s13
  s_add_u32 s12, s12, 36864
  s_add_u32 m0, s13, 98304
  s_nop 0
  buffer_load_dwordx4 v1, s[4:7], s12 offen offset:0 sc1 lds
  buffer_load_dwordx4 v1, s[4:7], s12 offen offset:1024 sc1 lds
  buffer_load_dwordx4 v1, s[4:7], s12 offen offset:2048 sc1 lds
  buffer_load_dwordx4 v1, s[4:7], s12 offen offset:3072 sc1 lds
  s_add_u32 s12, s12, 4096
  s_add_u32 m0, m0, 4096
  s_nop 0
  buffer_load_dwordx4 v1, s[4:7], s12 offen offset:0 sc1 lds
  buffer_load_dwordx4 v1, s[4:7], s12 offen offset:1024 sc1 lds
  s_mul_i32 s47, s44, 10240
  s_lshl_b32 s48, s43, 10
  s_add_u32 s47, s47, s48
  s_add_u32 s47, s47, 0
  v_add_u32 v9, s47, v1
  s_waitcnt lgkmcnt(0)
  s_barrier
  v_mov_b32 v32, 0
  v_mov_b32 v33, 0
  v_mov_b32 v34, 0
  v_mov_b32 v35, 0
  ds_read_b128 v[40:43], v9 offset:0
  ds_read_b128 v[44:47], v9 offset:18432
  ds_read_b128 v[48:51], v9 offset:36864
  ds_read_b128 v[52:55], v9 offset:55296
  s_mul_i32 s13, s3, 6144
  s_add_u32 s12, s15, s13
  s_add_u32 s12, s12, 73728
  s_add_u32 m0, s13, 122880
  s_nop 0
  buffer_load_dwordx4 v1, s[4:7], s12 offen offset:0 sc1 lds
  ds_read_b128 v[56:59], v9 offset:2048
  ds_read_b128 v[60:63], v9 offset:20480
  ds_read_b128 v[64:67], v9 offset:38912
  ds_read_b128 v[68:71], v9 offset:57344
  buffer_load_dwordx4 v1, s[4:7], s12 offen offset:1024 sc1 lds
  ds_read_b128 v[72:75], v9 offset:4096
  ds_read_b128 v[76:79], v9 offset:22528
  ds_read_b128 v[80:83], v9 offset:40960
  ds_read_b128 v[84:87], v9 offset:59392
  buffer_load_dwordx4 v1, s[4:7], s12 offen offset:2048 sc1 lds
  ds_read_b128 v[88:91], v9 offset:6144
  ds_read_b128 v[92:95], v9 offset:24576
  ds_read_b128 v[96:99], v9 offset:43008
  ds_read_b128 v[100:103], v9 offset:61440
  buffer_load_dwordx4 v1, s[4:7], s12 offen offset:3072 sc1 lds
  s_add_u32 s12, s12, 4096
  s_add_u32 m0, m0, 4096
  s_cmp_lg_u32 s44, 0
  s_cbranch_scc1 K2_skip4
  ds_read_b128 v[104:107], v9 offset:8192
  ds_read_b128 v[108:111], v9 offset:26624
  ds_read_b128 v[112:115], v9 offset:45056
  ds_read_b128 v[116:119], v9 offset:63488
K2_skip4:
  s_waitcnt vmcnt(16)
  v_permlane16_swap_b32 v232, v234
  v_permlane16_swap_b32 v233, v235
  v_permlane16_swap_b32 v236, v238
  v_permlane16_swap_b32 v237, v239
  v_permlane16_swap_b32 v240, v242
  v_permlane16_swap_b32 v241, v243
  s_waitcnt lgkmcnt(12)
  v_pk_add_f32 v[40:41], v[40:41], v[44:45]
  v_pk_add_f32 v[48:49], v[48:49], v[52:53]
  v_pk_add_f32 v[42:43], v[42:43], v[46:47]
  v_pk_add_f32 v[50:51], v[50:51], v[54:55]
  v_lshlrev_b32 v44, 16, v232
  v_and_b32 v45, 0xffff0000, v232
  v_lshlrev_b32 v46, 16, v233
  v_and_b32 v47, 0xffff0000, v233
  v_pk_add_f32 v[40:41], v[40:41], v[48:49]
  v_pk_add_f32 v[42:43], v[42:43], v[50:51]
  v_pk_add_f32 v[40:41], v[40:41], v[44:45]
  v_pk_add_f32 v[42:43], v[42:43], v[46:47]
  v_cvt_pk_bf16_f32 v232, v40, v41
  v_cvt_pk_bf16_f32 v233, v42, v43
  v_lshlrev_b32 v16, 16, v232
  v_and_b32 v17, 0xffff0000, v232
  v_lshlrev_b32 v18, 16, v233
  v_and_b32 v19, 0xffff0000, v233
  s_waitcnt lgkmcnt(8)
  v_pk_add_f32 v[56:57], v[56:57], v[60:61]
  v_pk_add_f32 v[64:65], v[64:65], v[68:69]
  v_pk_add_f32 v[58:59], v[58:59], v[62:63]
  v_pk_add_f32 v[66:67], v[66:67], v[70:71]
  v_lshlrev_b32 v60, 16, v234
  v_and_b32 v61, 0xffff0000, v234
  v_lshlrev_b32 v62, 16, v235
  v_and_b32 v63, 0xffff0000, v235
  v_pk_add_f32 v[56:57], v[56:57], v[64:65]
  v_pk_add_f32 v[58:59], v[58:59], v[66:67]
  v_pk_add_f32 v[56:57], v[56:57], v[60:61]
  v_pk_add_f32 v[58:59], v[58:59], v[62:63]
  v_cvt_pk_bf16_f32 v234, v56, v57
  v_cvt_pk_bf16_f32 v235, v58, v59
  v_lshlrev_b32 v20, 16, v234
  v_and_b32 v21, 0xffff0000, v234
  v_lshlrev_b32 v22, 16, v235
  v_and_b32 v23, 0xffff0000, v235
  v_permlane16_swap_b32 v232, v234
  v_permlane16_swap_b32 v233, v235
  buffer_store_dwordx4 v[232:235], v244, s[4:7], s54 offen offset:0 sc1
  s_waitcnt lgkmcnt(4)
  v_pk_add_f32 v[72:73], v[72:73], v[76:77]
  v_pk_add_f32 v[80:81], v[80:81], v[84:85]
  v_pk_add_f32 v[74:75], v[74:75], v[78:79]
  v_pk_add_f32 v[82:83], v[82:83], v[86:87]
  v_lshlrev_b32 v76, 16, v236
  v_and_b32 v77, 0xffff0000, v236
  v_lshlrev_b32 v78, 16, v237
  v_and_b32 v79, 0xffff0000, v237
  v_pk_add_f32 v[72:73], v[72:73], v[80:81]
  v_pk_add_f32 v[74:75], v[74:75], v[82:83]
  v_pk_add_f32 v[72:73], v[72:73], v[76:77]
  v_pk_add_f32 v[74:75], v[74:75], v[78:79]
  v_cvt_pk_bf16_f32 v236, v72, v73
  v_cvt_pk_bf16_f32 v237, v74, v75
  v_lshlrev_b32 v24, 16, v236
  v_and_b32 v25, 0xffff0000, v236
  v_lshlrev_b32 v26, 16, v237
  v_and_b32 v27, 0xffff0000, v237
  s_waitcnt lgkmcnt(0)
  v_pk_add_f32 v[88:89], v[88:89], v[92:93]
  v_pk_add_f32 v[96:97], v[96:97], v[100:101]
  v_pk_add_f32 v[90:91], v[90:91], v[94:95]
  v_pk_add_f32 v[98:99], v[98:99], v[102:103]
  v_lshlrev_b32 v92, 16, v238
  v_and_b32 v93, 0xffff0000, v238
  v_lshlrev_b32 v94, 16, v239
  v_and_b32 v95, 0xffff0000, v239
  v_pk_add_f32 v[88:89], v[88:89], v[96:97]
  v_pk_add_f32 v[90:91], v[90:91], v[98:99]
  v_pk_add_f32 v[88:89], v[88:89], v[92:93]
  v_pk_add_f32 v[90:91], v[90:91], v[94:95]
  v_cvt_pk_bf16_f32 v238, v88, v89
  v_cvt_pk_bf16_f32 v239, v90, v91
  v_lshlrev_b32 v28, 16, v238
  v_and_b32 v29, 0xffff0000, v238
  v_lshlrev_b32 v30, 16, v239
  v_and_b32 v31, 0xffff0000, v239
  v_permlane16_swap_b32 v236, v238
  v_permlane16_swap_b32 v237, v239
  buffer_store_dwordx4 v[236:239], v244, s[4:7], s54 offen offset:2048 sc1
  s_cmp_lg_u32 s44, 0
  s_cbranch_scc1 K2_skip5
  s_waitcnt lgkmcnt(0)
  v_pk_add_f32 v[104:105], v[104:105], v[108:109]
  v_pk_add_f32 v[112:113], v[112:113], v[116:117]
  v_pk_add_f32 v[106:107], v[106:107], v[110:111]
  v_pk_add_f32 v[114:115], v[114:115], v[118:119]
  v_lshlrev_b32 v108, 16, v240
  v_and_b32 v109, 0xffff0000, v240
  v_lshlrev_b32 v110, 16, v241
  v_and_b32 v111, 0xffff0000, v241
  v_pk_add_f32 v[104:105], v[104:105], v[112:113]
  v_pk_add_f32 v[106:107], v[106:107], v[114:115]
  v_pk_add_f32 v[104:105], v[104:105], v[108:109]
  v_pk_add_f32 v[106:107], v[106:107], v[110:111]
  v_cvt_pk_bf16_f32 v240, v104, v105
  v_cvt_pk_bf16_f32 v241, v106, v107
  v_lshlrev_b32 v32, 16, v240
  v_and_b32 v33, 0xffff0000, v240
  v_lshlrev_b32 v34, 16, v241
  v_and_b32 v35, 0xffff0000, v241
  v_permlane16_swap_b32 v240, v242
  v_permlane16_swap_b32 v241, v243
  s_add_u32 s54, s54, 4096
  buffer_store_dwordx4 v[240:243], v245, s[4:7], s54 offen offset:0 sc1
K2_skip5:
  s_barrier
  s_mov_b32 s47, 0x3d800000
  s_mov_b32 s48, 0x41000000
  s_mov_b32 s45, 0x41800000
  s_cmp_eq_u32 s44, 0
  s_cselect_b32 s47, 0x3d4ccccd, s47
  s_cselect_b32 s48, 0x41200000, s48
  s_cselect_b32 s45, 0x41a00000, s45
  v_pk_add_f32 v[10:11], v[16:17], v[18:19]
  v_pk_add_f32 v[12:13], v[20:21], v[22:23]
  v_pk_add_f32 v[10:11], v[10:11], v[24:25]
  v_pk_add_f32 v[12:13], v[12:13], v[26:27]
  v_pk_add_f32 v[10:11], v[10:11], v[28:29]
  v_pk_add_f32 v[12:13], v[12:13], v[30:31]
  v_pk_add_f32 v[10:11], v[10:11], v[32:33]
  v_pk_add_f32 v[12:13], v[12:13], v[34:35]
  v_pk_add_f32 v[10:11], v[10:11], v[12:13]
  v_add_f32 v10, v10, v11
  v_mul_f32 v14, s47, v10
  v_mov_b32 v15, v14
  v_mov_b32 v12, 0
  v_mov_b32 v13, 0
  v_pk_add_f32 v[16:17], v[16:17], v[14:15] neg_lo:[0,1] neg_hi:[0,1]
  v_pk_add_f32 v[18:19], v[18:19], v[14:15] neg_lo:[0,1] neg_hi:[0,1]
  v_pk_add_f32 v[20:21], v[20:21], v[14:15] neg_lo:[0,1] neg_hi:[0,1]
  v_pk_add_f32 v[22:23], v[22:23], v[14:15] neg_lo:[0,1] neg_hi:[0,1]
  v_pk_add_f32 v[24:25], v[24:25], v[14:15] neg_lo:[0,1] neg_hi:[0,1]
  v_pk_add_f32 v[26:27], v[26:27], v[14:15] neg_lo:[0,1] neg_hi:[0,1]
  v_pk_add_f32 v[28:29], v[28:29], v[14:15] neg_lo:[0,1] neg_hi:[0,1]
  v_pk_add_f32 v[30:31], v[30:31], v[14:15] neg_lo:[0,1] neg_hi:[0,1]
  v_pk_fma_f32 v[12:13], v[16:17], v[16:17], v[12:13]
  v_pk_fma_f32 v[12:13], v[18:19], v[18:19], v[12:13]
  v_pk_fma_f32 v[12:13], v[20:21], v[20:21], v[12:13]
  v_pk_fma_f32 v[12:13], v[22:23], v[22:23], v[12:13]
  v_pk_fma_f32 v[12:13], v[24:25], v[24:25], v[12:13]
  v_pk_fma_f32 v[12:13], v[26:27], v[26:27], v[12:13]
  v_pk_fma_f32 v[12:13], v[28:29], v[28:29], v[12:13]
  v_pk_fma_f32 v[12:13], v[30:31], v[30:31], v[12:13]
  s_cbranch_scc0 K2_skip6
  v_pk_add_f32 v[32:33], v[32:33], v[14:15] neg_lo:[0,1] neg_hi:[0,1]
  v_pk_add_f32 v[34:35], v[34:35], v[14:15] neg_lo:[0,1] neg_hi:[0,1]
  v_pk_fma_f32 v[12:13], v[32:33], v[32:33], v[12:13]
  v_pk_fma_f32 v[12:13], v[34:35], v[34:35], v[12:13]
K2_skip6:
  v_add_f32 v11, v12, v13
  v_mov_b32 v10, v14
  v_mov_b32 v2, v10
  v_mov_b32 v3, v11
  s_nop 0
  v_permlane16_swap_b32 v10, v2
  v_permlane16_swap_b32 v11, v3
  v_add_f32 v11, v11, v3
  v_sub_f32 v3, v10, v2
  v_add_f32 v10, v10, v2
  v_mul_f32 v10, 0.5, v10
  v_mul_f32 v3, v3, v3
  v_fma_f32 v11, v3, s48, v11
  v_mov_b32 v2, v10
  v_mov_b32 v3, v11
  s_nop 0
  v_permlane32_swap_b32 v10, v2
  v_permlane32_swap_b32 v11, v3
  v_add_f32 v11, v11, v3
  v_sub_f32 v3, v10, v2
  v_add_f32 v10, v10, v2
  v_mul_f32 v10, 0.5, v10
  v_mul_f32 v3, v3, v3
  v_fma_f32 v11, v3, s45, v11
  s_lshl_b32 s46, s38, 11
  s_lshl_b32 s47, s43, 8
  s_add_u32 s46, s46, s47
  s_and_b32 s47, s39, 1
  s_lshl_b32 s47, s47, 10
  s_add_u32 s46, s46, s47
  s_lshr_b32 s47, s39, 1
  s_lshl_b32 s47, s47, 9
  s_add_u32 s46, s46, s47
  s_lshl_b32 s47, s44, 3
  s_add_u32 s46, s46, s47
  s_add_u32 s46, s46, 5341184
  s_add_u32 s46, s46, s50
  v_lshlrev_b32 v8, 4, v0
  s_mov_b32 exec_lo, 0xffff
  s_mov_b32 exec_hi, 0x0
  buffer_store_dwordx2 v[10:11], v8, s[4:7], s46 offen sc1
  s_mov_b64 exec, -1
  s_lshl_b32 s46, s38, 2
  s_add_u32 s46, s46, s39
  s_lshl_b32 s46, s46, 7
  s_add_u32 s46, s46, 5242880
  s_add_u32 s46, s46, s50
  s_cmp_eq_u32 s3, 0
  s_cselect_b32 s46, s46, s49
  v_mov_b32 v2, s49
  v_writelane_b32 v2, s46, 0
  v_mov_b32 v3, 1
  s_and_b32 s38, s36, 1
  s_lshl_b32 s38, s38, 2
  s_and_b32 s39, s37, 3
  s_add_u32 s38, s38, s39
  s_lshr_b32 s46, s37, 2
  s_lshr_b32 s39, s36, 1
  s_lshl_b32 s39, s39, 3
  s_add_u32 s39, s39, s46
  s_lshl_b32 s52, s38, 3
  s_lshl_b32 s53, s3, 1
  s_add_u32 s52, s52, s53
  s_lshl_b32 s53, s52, 11
  s_add_u32 s53, s53, 5341184
  s_add_u32 s53, s53, s50
  v_and_b32 v4, 31, v0
  v_lshlrev_b32 v4, 6, v4
  v_lshrrev_b32 v5, 5, v0
  v_lshl_add_u32 v4, v5, 5, v4
  s_mul_i32 s54, s52, 36864
  s_add_u32 s54, s54, 5734400
  s_add_u32 s54, s54, s50
  s_add_u32 s55, s54, 36864
  s_mul_i32 s44, s52, 294912
  s_mul_i32 s46, s39, 9216
  s_add_u32 s44, s44, s46
  s_add_u32 s44, s44, 8093696
  s_add_u32 s44, s44, s50
  s_add_u32 s45, s44, 294912
  s_mul_i32 s41, s3, 9216
  s_mul_i32 s40, s39, 331776
  s_add_u32 s40, s40, 0
  s_add_u32 s40, s40, s41
  s_lshr_b32 s61, s36, 1
  s_lshl_b32 s61, s61, 2
  s_lshr_b32 s47, s37, 3
  s_add_u32 s61, s61, s47
  s_mul_i32 s61, s61, 331776
  s_add_u32 s61, s61, 10911744
  s_mul_i32 s47, s3, 9216
  s_add_u32 s61, s61, s47
  s_lshl_b32 s46, s38, 2
  s_add_u32 s46, s46, s3
  s_lshl_b32 s46, s46, 2
  s_lshr_b32 s47, s39, 3
  s_add_u32 s46, s46, s47
  s_lshl_b32 s46, s46, 7
  s_add_u32 s46, s46, 5210112
  s_add_u32 s46, s46, s50
  v_mov_b32 v9, s49
  v_writelane_b32 v9, s46, 0
  v_mov_b32 v10, 1
  s_waitcnt vmcnt(0)
  s_barrier
  buffer_store_dword v3, v2, s[4:7], 0 offen sc1
  buffer_load_dwordx4 v1, s[4:7], s12 offen offset:0 sc1 lds
  buffer_load_dwordx4 v1, s[4:7], s12 offen offset:1024 sc1 lds
  s_mul_i32 s15, s14, 9216
  s_add_u32 s15, s15, 10616832
  s_mul_i32 s13, s3, 3072
  s_add_u32 s12, s15, s13
  s_add_u32 s12, s12, 0
  s_add_u32 m0, s13, 147456
  s_nop 0
  buffer_load_dwordx4 v1, s[4:7], s12 offen offset:0 sc1 lds
  buffer_load_dwordx4 v1, s[4:7], s12 offen offset:1024 sc1 lds
  buffer_load_dwordx4 v1, s[4:7], s12 offen offset:2048 sc1 lds
  s_lshr_b32 s15, s36, 1
  s_lshl_b32 s15, s15, 3
  s_lshr_b32 s13, s37, 2
  s_add_u32 s14, s15, s13
  s_mul_i32 s15, s14, 331776
  s_add_u32 s15, s15, 0
  s_mul_i32 s13, s3, 3072
  s_add_u32 s12, s15, s13
  s_add_u32 s12, s12, 24576
  s_add_u32 m0, s13, 36864
  s_nop 0
  buffer_load_dwordx4 v1, s[4:7], s12 offen offset:0 sc1 lds
  buffer_load_dwordx4 v1, s[4:7], s12 offen offset:1024 sc1 lds
  buffer_load_dwordx4 v1, s[4:7], s12 offen offset:2048 sc1 lds
  s_mul_i32 s13, s3, 3072
  s_add_u32 s12, s15, s13
  s_add_u32 s12, s12, 61440
  s_add_u32 m0, s13, 49152
  s_nop 0
  buffer_load_dwordx4 v1, s[4:7], s12 offen offset:0 sc1 lds
  buffer_load_dwordx4 v1, s[4:7], s12 offen offset:1024 sc1 lds
  buffer_load_dwordx4 v1, s[4:7], s12 offen offset:2048 sc1 lds
  s_mul_i32 s13, s3, 3072
  s_add_u32 s12, s15, s13
  s_add_u32 s12, s12, 98304
  s_add_u32 m0, s13, 61440
  s_nop 0
  buffer_load_dwordx4 v1, s[4:7], s12 offen offset:0 sc1 lds
  buffer_load_dwordx4 v1, s[4:7], s12 offen offset:1024 sc1 lds
  buffer_load_dwordx4 v1, s[4:7], s12 offen offset:2048 sc1 lds
  s_mul_i32 s13, s3, 9216
  s_add_u32 s12, s15, s13
  s_add_u32 s12, s12, 110592
  s_add_u32 m0, s13, 0
  s_nop 0
  buffer_load_dwordx4 v1, s[4:7], s12 offen offset:0 sc1 lds
  s_cmp_lg_u32 s3, 0
  s_cbranch_scc1 W2_done
  s_lshl_b32 s46, s38, 12
  s_add_u32 s46, s46, 5242880
  s_add_u32 s46, s46, s50
  v_and_b32 v2, 31, v0
  v_lshlrev_b32 v2, 7, v2
  s_mov_b32 s47, 0
W2_poll:
  buffer_load_dword v3, v2, s[4:7], s46 offen sc1
  s_add_u32 s47, s47, 1
  s_waitcnt vmcnt(0)
  v_cmp_ne_u32 vcc, 1, v3
  s_cmp_gt_u32 s47, 131072
  s_cbranch_scc1 W2_done
  s_cmp_eq_u64 vcc, 0
  s_cbranch_scc0 W2_poll
W2_done:
  s_waitcnt vmcnt(0) lgkmcnt(0)
  s_barrier
  v_add_u32 v2, 0x10000, v1
  v_add_u32 v3, 0x20000, v1
  buffer_load_dwordx4 a[0:3], v1, s[4:7], s54 offen offset:0 sc1
  buffer_load_dwordx4 a[4:7], v1, s[4:7], s55 offen offset:0 sc1
  buffer_load_dwordx4 a[8:11], v1, s[4:7], s54 offen offset:1024 sc1
  buffer_load_dwordx4 a[12:15], v1, s[4:7], s55 offen offset:1024 sc1
  buffer_load_dwordx4 a[16:19], v1, s[4:7], s54 offen offset:2048 sc1
  buffer_load_dwordx4 a[20:23], v1, s[4:7], s55 offen offset:2048 sc1
  buffer_load_dwordx4 a[24:27], v1, s[4:7], s54 offen offset:3072 sc1
  buffer_load_dwordx4 a[28:31], v1, s[4:7], s55 offen offset:3072 sc1
  s_add_u32 s54, s54, 4096
  s_add_u32 s55, s55, 4096
  buffer_load_dwordx4 v1, s[4:7], s12 offen offset:1024 sc1 lds
  buffer_load_dwordx4 a[32:35], v1, s[4:7], s54 offen offset:0 sc1
  buffer_load_dwordx4 a[36:39], v1, s[4:7], s55 offen offset:0 sc1
  buffer_load_dwordx4 v1, s[4:7], s12 offen offset:2048 sc1 lds
  buffer_load_dwordx4 a[40:43], v1, s[4:7], s54 offen offset:1024 sc1
  buffer_load_dwordx4 a[44:47], v1, s[4:7], s55 offen offset:1024 sc1
  ds_read_b128 v[144:147], v2 offset:8192
  ds_read_b128 v[148:151], v2 offset:32768
  ds_read_b128 v[152:155], v2 offset:57344
  ds_read_b128 v[156:159], v2 offset:9216
  ds_read_b128 v[160:163], v2 offset:33792
  ds_read_b128 v[164:167], v2 offset:58368
  s_waitcnt vmcnt(12)
  s_waitcnt lgkmcnt(5)
  v_mfma_f32_32x32x16_bf16 v[16:31], v[144:147], a[0:3], 0
  buffer_load_dwordx4 v1, s[4:7], s12 offen offset:3072 sc1 lds
  s_add_u32 s12, s12, 4096
  s_add_u32 m0, m0, 4096
  v_mfma_f32_32x32x16_bf16 v[32:47], v[144:147], a[4:7], 0
  ds_read_b128 v[144:147], v2 offset:10240
  s_waitcnt lgkmcnt(5)
  v_mfma_f32_32x32x16_bf16 v[48:63], v[148:151], a[0:3], 0
  buffer_load_dwordx4 a[48:51], v1, s[4:7], s54 offen offset:2048 sc1
  v_mfma_f32_32x32x16_bf16 v[64:79], v[148:151], a[4:7], 0
  ds_read_b128 v[148:151], v2 offset:34816
  s_waitcnt lgkmcnt(5)
  v_mfma_f32_32x32x16_bf16 v[80:95], v[152:155], a[0:3], 0
  buffer_load_dwordx4 a[52:55], v1, s[4:7], s55 offen offset:2048 sc1
  v_mfma_f32_32x32x16_bf16 v[96:111], v[152:155], a[4:7], 0
  ds_read_b128 v[152:155], v2 offset:59392
  s_waitcnt vmcnt(13)
  s_waitcnt lgkmcnt(5)
  v_mfma_f32_32x32x16_bf16 v[16:31], v[156:159], a[8:11], v[16:31]
  buffer_load_dwordx4 v1, s[4:7], s12 offen offset:0 sc1 lds
  v_mfma_f32_32x32x16_bf16 v[32:47], v[156:159], a[12:15], v[32:47]
  ds_read_b128 v[156:159], v2 offset:11264
  s_waitcnt lgkmcnt(5)
  v_mfma_f32_32x32x16_bf16 v[48:63], v[160:163], a[8:11], v[48:63]
  buffer_load_dwordx4 a[56:59], v1, s[4:7], s54 offen offset:3072 sc1
  v_mfma_f32_32x32x16_bf16 v[64:79], v[160:163], a[12:15], v[64:79]
  ds_read_b128 v[160:163], v2 offset:35840
  s_waitcnt lgkmcnt(5)
  v_mfma_f32_32x32x16_bf16 v[80:95], v[164:167], a[8:11], v[80:95]
  buffer_load_dwordx4 a[60:63], v1, s[4:7], s55 offen offset:3072 sc1
  s_add_u32 s54, s54, 4096
  s_add_u32 s55, s55, 4096
  v_mfma_f32_32x32x16_bf16 v[96:111], v[164:167], a[12:15], v[96:111]
  ds_read_b128 v[164:167], v2 offset:60416
  s_waitcnt vmcnt(14)
  s_waitcnt lgkmcnt(5)
  v_mfma_f32_32x32x16_bf16 v[16:31], v[144:147], a[16:19], v[16:31]
  buffer_load_dwordx4 v1, s[4:7], s12 offen offset:1024 sc1 lds
  v_mfma_f32_32x32x16_bf16 v[32:47], v[144:147], a[20:23], v[32:47]
  ds_read_b128 v[144:147], v2 offset:12288
  s_waitcnt lgkmcnt(5)
  v_mfma_f32_32x32x16_bf16 v[48:63], v[148:151], a[16:19], v[48:63]
  buffer_load_dwordx4 a[64:67], v1, s[4:7], s54 offen offset:0 sc1
  v_mfma_f32_32x32x16_bf16 v[64:79], v[148:151], a[20:23], v[64:79]
  ds_read_b128 v[148:151], v2 offset:36864
  s_waitcnt lgkmcnt(5)
  v_mfma_f32_32x32x16_bf16 v[80:95], v[152:155], a[16:19], v[80:95]
  buffer_load_dwordx4 a[68:71], v1, s[4:7], s55 offen offset:0 sc1
  v_mfma_f32_32x32x16_bf16 v[96:111], v[152:155], a[20:23], v[96:111]
  ds_read_b128 v[152:155], v2 offset:61440
  s_waitcnt vmcnt(15)
  s_waitcnt lgkmcnt(5)
  v_mfma_f32_32x32x16_bf16 v[16:31], v[156:159], a[24:27], v[16:31]
  buffer_load_dwordx4 v1, s[4:7], s12 offen offset:2048 sc1 lds
  v_mfma_f32_32x32x16_bf16 v[32:47], v[156:159], a[28:31], v[32:47]
  ds_read_b128 v[156:159], v2 offset:13312
  s_waitcnt lgkmcnt(5)
  v_mfma_f32_32x32x16_bf16 v[48:63], v[160:163], a[24:27], v[48:63]
  buffer_load_dwordx4 a[72:75], v1, s[4:7], s54 offen offset:1024 sc1
  v_mfma_f32_32x32x16_bf16 v[64:79], v[160:163], a[28:31], v[64:79]
  ds_read_b128 v[160:163], v2 offset:37888
  s_waitcnt lgkmcnt(5)
  v_mfma_f32_32x32x16_bf16 v[80:95], v[164:167], a[24:27], v[80:95]
  buffer_load_dwordx4 a[76:79], v1, s[4:7], s55 offen offset:1024 sc1
  v_mfma_f32_32x32x16_bf16 v[96:111], v[164:167], a[28:31], v[96:111]
  ds_read_b128 v[164:167], v2 offset:62464
  s_waitcnt vmcnt(15)
  s_waitcnt lgkmcnt(5)
  v_mfma_f32_32x32x16_bf16 v[16:31], v[144:147], a[32:35], v[16:31]
  buffer_load_dwordx4 v1, s[4:7], s12 offen offset:3072 sc1 lds
  s_add_u32 s12, s12, 4096
  s_add_u32 m0, m0, 4096
  v_mfma_f32_32x32x16_bf16 v[32:47], v[144:147], a[36:39], v[32:47]
  ds_read_b128 v[144:147], v2 offset:14336
  s_waitcnt lgkmcnt(5)
  v_mfma_f32_32x32x16_bf16 v[48:63], v[148:151], a[32:35], v[48:63]
  buffer_load_dwordx4 a[80:83], v1, s[4:7], s54 offen offset:2048 sc1
  v_mfma_f32_32x32x16_bf16 v[64:79], v[148:151], a[36:39], v[64:79]
  ds_read_b128 v[148:151], v2 offset:38912
  s_waitcnt lgkmcnt(5)
  v_mfma_f32_32x32x16_bf16 v[80:95], v[152:155], a[32:35], v[80:95]
  buffer_load_dwordx4 a[84:87], v1, s[4:7], s55 offen offset:2048 sc1
  v_mfma_f32_32x32x16_bf16 v[96:111], v[152:155], a[36:39], v[96:111]
  ds_read_b128 v[152:155], v2 offset:63488
  s_waitcnt vmcnt(15)
  s_waitcnt lgkmcnt(5)
  v_mfma_f32_32x32x16_bf16 v[16:31], v[156:159], a[40:43], v[16:31]
  buffer_load_dwordx4 v1, s[4:7], s12 offen offset:0 sc1 lds
  v_mfma_f32_32x32x16_bf16 v[32:47], v[156:159], a[44:47], v[32:47]
  ds_read_b128 v[156:159], v2 offset:15360
  s_waitcnt lgkmcnt(5)
  v_mfma_f32_32x32x16_bf16 v[48:63], v[160:163], a[40:43], v[48:63]
  buffer_load_dwordx4 a[88:91], v1, s[4:7], s54 offen offset:3072 sc1
  v_mfma_f32_32x32x16_bf16 v[64:79], v[160:163], a[44:47], v[64:79]
  ds_read_b128 v[160:163], v2 offset:39936
  s_waitcnt lgkmcnt(5)
  v_mfma_f32_32x32x16_bf16 v[80:95], v[164:167], a[40:43], v[80:95]
  buffer_load_dwordx4 a[92:95], v1, s[4:7], s55 offen offset:3072 sc1
  s_add_u32 s54, s54, 4096
  s_add_u32 s55, s55, 4096
  v_mfma_f32_32x32x16_bf16 v[96:111], v[164:167], a[44:47], v[96:111]
  ds_read_b128 v[164:167], v2 offset:64512
  s_waitcnt vmcnt(15)
  s_waitcnt lgkmcnt(5)
  v_mfma_f32_32x32x16_bf16 v[16:31], v[144:147], a[48:51], v[16:31]
  buffer_load_dwordx4 a[96:99], v1, s[4:7], s54 offen offset:0 sc1
  v_mfma_f32_32x32x16_bf16 v[32:47], v[144:147], a[52:55], v[32:47]
  ds_read_b128 v[144:147], v2 offset:16384
  s_waitcnt lgkmcnt(5)
  v_mfma_f32_32x32x16_bf16 v[48:63], v[148:151], a[48:51], v[48:63]
  buffer_load_dwordx4 a[100:103], v1, s[4:7], s55 offen offset:0 sc1
  v_mfma_f32_32x32x16_bf16 v[64:79], v[148:151], a[52:55], v[64:79]
  ds_read_b128 v[148:151], v2 offset:40960
  s_waitcnt lgkmcnt(5)
  v_mfma_f32_32x32x16_bf16 v[80:95], v[152:155], a[48:51], v[80:95]
  v_mfma_f32_32x32x16_bf16 v[96:111], v[152:155], a[52:55], v[96:111]
  ds_read_b128 v[152:155], v3 offset:0
  s_waitcnt vmcnt(14)
  s_waitcnt lgkmcnt(5)
  v_mfma_f32_32x32x16_bf16 v[16:31], v[156:159], a[56:59], v[16:31]
  buffer_load_dwordx4 a[104:107], v1, s[4:7], s54 offen offset:1024 sc1
  v_mfma_f32_32x32x16_bf16 v[32:47], v[156:159], a[60:63], v[32:47]
  ds_read_b128 v[156:159], v2 offset:17408
  s_waitcnt lgkmcnt(5)
  v_mfma_f32_32x32x16_bf16 v[48:63], v[160:163], a[56:59], v[48:63]
  buffer_load_dwordx4 a[108:111], v1, s[4:7], s55 offen offset:1024 sc1
  v_mfma_f32_32x32x16_bf16 v[64:79], v[160:163], a[60:63], v[64:79]
  ds_read_b128 v[160:163], v2 offset:41984
  s_waitcnt lgkmcnt(5)
  v_mfma_f32_32x32x16_bf16 v[80:95], v[164:167], a[56:59], v[80:95]
  v_mfma_f32_32x32x16_bf16 v[96:111], v[164:167], a[60:63], v[96:111]
  ds_read_b128 v[164:167], v3 offset:1024
  s_waitcnt vmcnt(13)
  s_waitcnt lgkmcnt(5)
  v_mfma_f32_32x32x16_bf16 v[16:31], v[144:147], a[64:67], v[16:31]
  buffer_load_dwordx4 a[112:115], v1, s[4:7], s54 offen offset:2048 sc1
  v_mfma_f32_32x32x16_bf16 v[32:47], v[144:147], a[68:71], v[32:47]
  ds_read_b128 v[144:147], v2 offset:18432
  s_waitcnt lgkmcnt(5)
  v_mfma_f32_32x32x16_bf16 v[48:63], v[148:151], a[64:67], v[48:63]
  buffer_load_dwordx4 a[116:119], v1, s[4:7], s55 offen offset:2048 sc1
  v_mfma_f32_32x32x16_bf16 v[64:79], v[148:151], a[68:71], v[64:79]
  ds_read_b128 v[148:151], v2 offset:43008
  s_waitcnt lgkmcnt(5)
  v_mfma_f32_32x32x16_bf16 v[80:95], v[152:155], a[64:67], v[80:95]
  v_mfma_f32_32x32x16_bf16 v[96:111], v[152:155], a[68:71], v[96:111]
  ds_read_b128 v[152:155], v3 offset:2048
  s_waitcnt vmcnt(12)
  s_waitcnt lgkmcnt(5)
  v_mfma_f32_32x32x16_bf16 v[16:31], v[156:159], a[72:75], v[16:31]
  buffer_load_dwordx4 a[120:123], v1, s[4:7], s54 offen offset:3072 sc1
  v_mfma_f32_32x32x16_bf16 v[32:47], v[156:159], a[76:79], v[32:47]
  ds_read_b128 v[156:159], v2 offset:19456
  s_waitcnt lgkmcnt(5)
  v_mfma_f32_32x32x16_bf16 v[48:63], v[160:163], a[72:75], v[48:63]
  buffer_load_dwordx4 a[124:127], v1, s[4:7], s55 offen offset:3072 sc1
  s_add_u32 s54, s54, 4096
  s_add_u32 s55, s55, 4096
  v_mfma_f32_32x32x16_bf16 v[64:79], v[160:163], a[76:79], v[64:79]
  ds_read_b128 v[160:163], v2 offset:44032
  s_waitcnt lgkmcnt(5)
  v_mfma_f32_32x32x16_bf16 v[80:95], v[164:167], a[72:75], v[80:95]
  v_mfma_f32_32x32x16_bf16 v[96:111], v[164:167], a[76:79], v[96:111]
  ds_read_b128 v[164:167], v3 offset:3072
  s_waitcnt vmcnt(11)
  s_waitcnt lgkmcnt(5)
  v_mfma_f32_32x32x16_bf16 v[16:31], v[144:147], a[80:83], v[16:31]
  buffer_load_dwordx4 a[128:131], v1, s[4:7], s54 offen offset:0 sc1
  v_mfma_f32_32x32x16_bf16 v[32:47], v[144:147], a[84:87], v[32:47]
  ds_read_b128 v[144:147], v2 offset:20480
  s_waitcnt lgkmcnt(5)
  v_mfma_f32_32x32x16_bf16 v[48:63], v[148:151], a[80:83], v[48:63]
  buffer_load_dwordx4 a[132:135], v1, s[4:7], s55 offen offset:0 sc1
  v_mfma_f32_32x32x16_bf16 v[64:79], v[148:151], a[84:87], v[64:79]
  ds_read_b128 v[148:151], v2 offset:45056
  s_waitcnt lgkmcnt(5)
  v_mfma_f32_32x32x16_bf16 v[80:95], v[152:155], a[80:83], v[80:95]
  v_mfma_f32_32x32x16_bf16 v[96:111], v[152:155], a[84:87], v[96:111]
  ds_read_b128 v[152:155], v3 offset:4096
  s_waitcnt vmcnt(10)
  s_waitcnt lgkmcnt(5)
  v_mfma_f32_32x32x16_bf16 v[16:31], v[156:159], a[88:91], v[16:31]
  buffer_load_dwordx4 a[136:139], v1, s[4:7], s54 offen offset:1024 sc1
  v_mfma_f32_32x32x16_bf16 v[32:47], v[156:159], a[92:95], v[32:47]
  ds_read_b128 v[156:159], v2 offset:21504
  s_waitcnt lgkmcnt(5)
  v_mfma_f32_32x32x16_bf16 v[48:63], v[160:163], a[88:91], v[48:63]
  buffer_load_dwordx4 a[140:143], v1, s[4:7], s55 offen offset:1024 sc1
  v_mfma_f32_32x32x16_bf16 v[64:79], v[160:163], a[92:95], v[64:79]
  ds_read_b128 v[160:163], v2 offset:46080
  s_waitcnt lgkmcnt(5)
  v_mfma_f32_32x32x16_bf16 v[80:95], v[164:167], a[88:91], v[80:95]
  v_mfma_f32_32x32x16_bf16 v[96:111], v[164:167], a[92:95], v[96:111]
  ds_read_b128 v[164:167], v3 offset:5120
  s_waitcnt vmcnt(10)
  s_waitcnt lgkmcnt(5)
  v_mfma_f32_32x32x16_bf16 v[16:31], v[144:147], a[96:99], v[16:31]
  buffer_load_dwordx4 a[144:147], v1, s[4:7], s54 offen offset:2048 sc1
  v_mfma_f32_32x32x16_bf16 v[32:47], v[144:147], a[100:103], v[32:47]
  ds_read_b128 v[144:147], v2 offset:22528
  s_waitcnt lgkmcnt(5)
  v_mfma_f32_32x32x16_bf16 v[48:63], v[148:151], a[96:99], v[48:63]
  buffer_load_dwordx4 a[148:151], v1, s[4:7], s55 offen offset:2048 sc1
  v_mfma_f32_32x32x16_bf16 v[64:79], v[148:151], a[100:103], v[64:79]
  ds_read_b128 v[148:151], v2 offset:47104
  s_waitcnt lgkmcnt(5)
  v_mfma_f32_32x32x16_bf16 v[80:95], v[152:155], a[96:99], v[80:95]
  v_mfma_f32_32x32x16_bf16 v[96:111], v[152:155], a[100:103], v[96:111]
  ds_read_b128 v[152:155], v3 offset:6144
  s_waitcnt vmcnt(10)
  s_waitcnt lgkmcnt(5)
  v_mfma_f32_32x32x16_bf16 v[16:31], v[156:159], a[104:107], v[16:31]
  buffer_load_dwordx4 a[152:155], v1, s[4:7], s54 offen offset:3072 sc1
  v_mfma_f32_32x32x16_bf16 v[32:47], v[156:159], a[108:111], v[32:47]
  ds_read_b128 v[156:159], v2 offset:23552
  s_waitcnt lgkmcnt(5)
  v_mfma_f32_32x32x16_bf16 v[48:63], v[160:163], a[104:107], v[48:63]
  buffer_load_dwordx4 a[156:159], v1, s[4:7], s55 offen offset:3072 sc1
  s_add_u32 s54, s54, 4096
  s_add_u32 s55, s55, 4096
  v_mfma_f32_32x32x16_bf16 v[64:79], v[160:163], a[108:111], v[64:79]
  ds_read_b128 v[160:163], v2 offset:48128
  s_waitcnt lgkmcnt(5)
  v_mfma_f32_32x32x16_bf16 v[80:95], v[164:167], a[104:107], v[80:95]
  v_mfma_f32_32x32x16_bf16 v[96:111], v[164:167], a[108:111], v[96:111]
  ds_read_b128 v[164:167], v3 offset:7168
  s_waitcnt vmcnt(10)
  s_waitcnt lgkmcnt(5)
  v_mfma_f32_32x32x16_bf16 v[16:31], v[144:147], a[112:115], v[16:31]
  buffer_load_dwordx4 a[160:163], v1, s[4:7], s54 offen offset:0 sc1
  v_mfma_f32_32x32x16_bf16 v[32:47], v[144:147], a[116:119], v[32:47]
  ds_read_b128 v[144:147], v2 offset:24576
  s_waitcnt lgkmcnt(5)
  v_mfma_f32_32x32x16_bf16 v[48:63], v[148:151], a[112:115], v[48:63]
  buffer_load_dwordx4 a[164:167], v1, s[4:7], s55 offen offset:0 sc1
  v_mfma_f32_32x32x16_bf16 v[64:79], v[148:151], a[116:119], v[64:79]
  ds_read_b128 v[148:151], v2 offset:49152
  s_waitcnt lgkmcnt(5)
  v_mfma_f32_32x32x16_bf16 v[80:95], v[152:155], a[112:115], v[80:95]
  v_mfma_f32_32x32x16_bf16 v[96:111], v[152:155], a[116:119], v[96:111]
  ds_read_b128 v[152:155], v3 offset:8192
  s_waitcnt vmcnt(10)
  s_waitcnt lgkmcnt(5)
  v_mfma_f32_32x32x16_bf16 v[16:31], v[156:159], a[120:123], v[16:31]
  buffer_load_dwordx4 a[168:171], v1, s[4:7], s54 offen offset:1024 sc1
  v_mfma_f32_32x32x16_bf16 v[32:47], v[156:159], a[124:127], v[32:47]
  ds_read_b128 v[156:159], v2 offset:25600
  s_waitcnt lgkmcnt(5)
  v_mfma_f32_32x32x16_bf16 v[48:63], v[160:163], a[120:123], v[48:63]
  buffer_load_dwordx4 a[172:175], v1, s[4:7], s55 offen offset:1024 sc1
  v_mfma_f32_32x32x16_bf16 v[64:79], v[160:163], a[124:127], v[64:79]
  ds_read_b128 v[160:163], v2 offset:50176
  s_waitcnt lgkmcnt(5)
  v_mfma_f32_32x32x16_bf16 v[80:95], v[164:167], a[120:123], v[80:95]
  v_mfma_f32_32x32x16_bf16 v[96:111], v[164:167], a[124:127], v[96:111]
  ds_read_b128 v[164:167], v3 offset:9216
  s_waitcnt vmcnt(10)
  s_waitcnt lgkmcnt(5)
  v_mfma_f32_32x32x16_bf16 v[16:31], v[144:147], a[128:131], v[16:31]
  buffer_load_dwordx4 a[176:179], v1, s[4:7], s54 offen offset:2048 sc1
  v_mfma_f32_32x32x16_bf16 v[32:47], v[144:147], a[132:135], v[32:47]
  ds_read_b128 v[144:147], v2 offset:26624
  s_waitcnt lgkmcnt(5)
  v_mfma_f32_32x32x16_bf16 v[48:63], v[148:151], a[128:131], v[48:63]
  buffer_load_dwordx4 a[180:183], v1, s[4:7], s55 offen offset:2048 sc1
  v_mfma_f32_32x32x16_bf16 v[64:79], v[148:151], a[132:135], v[64:79]
  ds_read_b128 v[148:151], v2 offset:51200
  s_waitcnt lgkmcnt(5)
  v_mfma_f32_32x32x16_bf16 v[80:95], v[152:155], a[128:131], v[80:95]
  v_mfma_f32_32x32x16_bf16 v[96:111], v[152:155], a[132:135], v[96:111]
  ds_read_b128 v[152:155], v3 offset:10240
  s_waitcnt vmcnt(10)
  s_waitcnt lgkmcnt(5)
  v_mfma_f32_32x32x16_bf16 v[16:31], v[156:159], a[136:139], v[16:31]
  buffer_load_dwordx4 a[184:187], v1, s[4:7], s54 offen offset:3072 sc1
  v_mfma_f32_32x32x16_bf16 v[32:47], v[156:159], a[140:143], v[32:47]
  ds_read_b128 v[156:159], v2 offset:27648
  s_waitcnt lgkmcnt(5)
  v_mfma_f32_32x32x16_bf16 v[48:63], v[160:163], a[136:139], v[48:63]
  buffer_load_dwordx4 a[188:191], v1, s[4:7], s55 offen offset:3072 sc1
  s_add_u32 s54, s54, 4096
  s_add_u32 s55, s55, 4096
  v_mfma_f32_32x32x16_bf16 v[64:79], v[160:163], a[140:143], v[64:79]
  ds_read_b128 v[160:163], v2 offset:52224
  s_waitcnt lgkmcnt(5)
  v_mfma_f32_32x32x16_bf16 v[80:95], v[164:167], a[136:139], v[80:95]
  v_mfma_f32_32x32x16_bf16 v[96:111], v[164:167], a[140:143], v[96:111]
  ds_read_b128 v[164:167], v3 offset:11264
  s_waitcnt vmcnt(10)
  s_waitcnt lgkmcnt(5)
  v_mfma_f32_32x32x16_bf16 v[16:31], v[144:147], a[144:147], v[16:31]
  buffer_load_dwordx4 a[192:195], v1, s[4:7], s54 offen offset:0 sc1
  v_mfma_f32_32x32x16_bf16 v[32:47], v[144:147], a[148:151], v[32:47]
  ds_read_b128 v[144:147], v2 offset:28672
  s_waitcnt lgkmcnt(5)
  v_mfma_f32_32x32x16_bf16 v[48:63], v[148:151], a[144:147], v[48:63]
  buffer_load_dwordx4 a[196:199], v1, s[4:7], s55 offen offset:0 sc1
  v_mfma_f32_32x32x16_bf16 v[64:79], v[148:151], a[148:151], v[64:79]
  ds_read_b128 v[148:151], v2 offset:53248
  s_waitcnt lgkmcnt(5)
  v_mfma_f32_32x32x16_bf16 v[80:95], v[152:155], a[144:147], v[80:95]
  v_mfma_f32_32x32x16_bf16 v[96:111], v[152:155], a[148:151], v[96:111]
  ds_read_b128 v[152:155], v3 offset:12288
  s_waitcnt vmcnt(10)
  s_waitcnt lgkmcnt(5)
  v_mfma_f32_32x32x16_bf16 v[16:31], v[156:159], a[152:155], v[16:31]
  buffer_load_dwordx4 a[200:203], v1, s[4:7], s54 offen offset:1024 sc1
  v_mfma_f32_32x32x16_bf16 v[32:47], v[156:159], a[156:159], v[32:47]
  ds_read_b128 v[156:159], v2 offset:29696
  s_waitcnt lgkmcnt(5)
  v_mfma_f32_32x32x16_bf16 v[48:63], v[160:163], a[152:155], v[48:63]
  buffer_load_dwordx4 a[204:207], v1, s[4:7], s55 offen offset:1024 sc1
  v_mfma_f32_32x32x16_bf16 v[64:79], v[160:163], a[156:159], v[64:79]
  ds_read_b128 v[160:163], v2 offset:54272
  s_waitcnt lgkmcnt(5)
  v_mfma_f32_32x32x16_bf16 v[80:95], v[164:167], a[152:155], v[80:95]
  v_mfma_f32_32x32x16_bf16 v[96:111], v[164:167], a[156:159], v[96:111]
  ds_read_b128 v[164:167], v3 offset:13312
  s_waitcnt vmcnt(10)
  s_waitcnt lgkmcnt(5)
  v_mfma_f32_32x32x16_bf16 v[16:31], v[144:147], a[160:163], v[16:31]
  buffer_load_dwordx4 a[208:211], v1, s[4:7], s54 offen offset:2048 sc1
  v_mfma_f32_32x32x16_bf16 v[32:47], v[144:147], a[164:167], v[32:47]
  ds_read_b128 v[144:147], v2 offset:30720
  s_waitcnt lgkmcnt(5)
  v_mfma_f32_32x32x16_bf16 v[48:63], v[148:151], a[160:163], v[48:63]
  buffer_load_dwordx4 a[212:215], v1, s[4:7], s55 offen offset:2048 sc1
  v_mfma_f32_32x32x16_bf16 v[64:79], v[148:151], a[164:167], v[64:79]
  ds_read_b128 v[148:151], v2 offset:55296
  s_waitcnt lgkmcnt(5)
  v_mfma_f32_32x32x16_bf16 v[80:95], v[152:155], a[160:163], v[80:95]
  v_mfma_f32_32x32x16_bf16 v[96:111], v[152:155], a[164:167], v[96:111]
  ds_read_b128 v[152:155], v3 offset:14336
  s_waitcnt vmcnt(10)
  s_waitcnt lgkmcnt(5)
  v_mfma_f32_32x32x16_bf16 v[16:31], v[156:159], a[168:171], v[16:31]
  buffer_load_dwordx4 a[216:219], v1, s[4:7], s54 offen offset:3072 sc1
  v_mfma_f32_32x32x16_bf16 v[32:47], v[156:159], a[172:175], v[32:47]
  ds_read_b128 v[156:159], v2 offset:31744
  s_waitcnt lgkmcnt(5)
  v_mfma_f32_32x32x16_bf16 v[48:63], v[160:163], a[168:171], v[48:63]
  buffer_load_dwordx4 a[220:223], v1, s[4:7], s55 offen offset:3072 sc1
  s_add_u32 s54, s54, 4096
  s_add_u32 s55, s55, 4096
  v_mfma_f32_32x32x16_bf16 v[64:79], v[160:163], a[172:175], v[64:79]
  ds_read_b128 v[160:163], v2 offset:56320
  s_waitcnt lgkmcnt(5)
  v_mfma_f32_32x32x16_bf16 v[80:95], v[164:167], a[168:171], v[80:95]
  v_mfma_f32_32x32x16_bf16 v[96:111], v[164:167], a[172:175], v[96:111]
  ds_read_b128 v[164:167], v3 offset:15360
  s_waitcnt vmcnt(10)
  s_waitcnt lgkmcnt(5)
  v_mfma_f32_32x32x16_bf16 v[16:31], v[144:147], a[176:179], v[16:31]
  buffer_load_dwordx4 a[224:227], v1, s[4:7], s54 offen offset:0 sc1
  v_mfma_f32_32x32x16_bf16 v[32:47], v[144:147], a[180:183], v[32:47]
  s_barrier
  ds_read_b128 v[144:147], v1 offset:36864
  s_waitcnt lgkmcnt(5)
  v_mfma_f32_32x32x16_bf16 v[48:63], v[148:151], a[176:179], v[48:63]
  buffer_load_dwordx4 a[228:231], v1, s[4:7], s55 offen offset:0 sc1
  v_mfma_f32_32x32x16_bf16 v[64:79], v[148:151], a[180:183], v[64:79]
  ds_read_b128 v[148:151], v1 offset:49152
  s_waitcnt lgkmcnt(5)
  v_mfma_f32_32x32x16_bf16 v[80:95], v[152:155], a[176:179], v[80:95]
  v_mfma_f32_32x32x16_bf16 v[96:111], v[152:155], a[180:183], v[96:111]
  ds_read_b128 v[152:155], v1 offset:61440
  s_waitcnt vmcnt(10)
  s_waitcnt lgkmcnt(5)
  v_mfma_f32_32x32x16_bf16 v[16:31], v[156:159], a[184:187], v[16:31]
  buffer_load_dwordx4 v[112:115], v1, s[4:7], s53 offen offset:0 sc1
  v_mfma_f32_32x32x16_bf16 v[32:47], v[156:159], a[188:191], v[32:47]
  ds_read_b128 v[156:159], v1 offset:37888
  s_waitcnt lgkmcnt(5)
  v_mfma_f32_32x32x16_bf16 v[48:63], v[160:163], a[184:187], v[48:63]
  buffer_load_dwordx4 v[116:119], v1, s[4:7], s53 offen offset:1024 sc1
  v_mfma_f32_32x32x16_bf16 v[64:79], v[160:163], a[188:191], v[64:79]
  ds_read_b128 v[160:163], v1 offset:50176
  s_waitcnt lgkmcnt(5)
  v_mfma_f32_32x32x16_bf16 v[80:95], v[164:167], a[184:187], v[80:95]
  buffer_load_dwordx4 v[128:131], v1, s[4:7], s53 offen offset:2048 sc1
  buffer_load_dwordx4 v[132:135], v1, s[4:7], s53 offen offset:3072 sc1
  buffer_load_dwordx4 a[232:235], v1, s[4:7], s54 offen offset:1024 sc1
  buffer_load_dwordx4 a[236:239], v1, s[4:7], s55 offen offset:1024 sc1
  v_mfma_f32_32x32x16_bf16 v[96:111], v[164:167], a[188:191], v[96:111]
  ds_read_b128 v[164:167], v1 offset:62464
  s_waitcnt vmcnt(14)
  s_waitcnt lgkmcnt(5)
  v_mfma_f32_32x32x16_bf16 v[16:31], v[144:147], a[192:195], v[16:31]
  buffer_load_dwordx4 a[240:243], v1, s[4:7], s54 offen offset:2048 sc1
  v_mfma_f32_32x32x16_bf16 v[32:47], v[144:147], a[196:199], v[32:47]
  ds_read_b128 v[144:147], v1 offset:38912
  s_waitcnt lgkmcnt(5)
  v_mfma_f32_32x32x16_bf16 v[48:63], v[148:151], a[192:195], v[48:63]
  buffer_load_dwordx4 a[244:247], v1, s[4:7], s55 offen offset:2048 sc1
  v_mfma_f32_32x32x16_bf16 v[64:79], v[148:151], a[196:199], v[64:79]
  ds_read_b128 v[148:151], v1 offset:51200
  s_waitcnt lgkmcnt(5)
  v_mfma_f32_32x32x16_bf16 v[80:95], v[152:155], a[192:195], v[80:95]
  v_mfma_f32_32x32x16_bf16 v[96:111], v[152:155], a[196:199], v[96:111]
  ds_read_b128 v[152:155], v1 offset:63488
  s_waitcnt vmcnt(14)
  s_waitcnt lgkmcnt(5)
  v_mfma_f32_32x32x16_bf16 v[16:31], v[156:159], a[200:203], v[16:31]
  buffer_load_dwordx4 a[248:251], v1, s[4:7], s54 offen offset:3072 sc1
  v_mfma_f32_32x32x16_bf16 v[32:47], v[156:159], a[204:207], v[32:47]
  s_barrier
  ds_read_b128 v[156:159], v1 offset:39936
  s_waitcnt lgkmcnt(5)
  v_mfma_f32_32x32x16_bf16 v[48:63], v[160:163], a[200:203], v[48:63]
  buffer_load_dwordx4 a[252:255], v1, s[4:7], s55 offen offset:3072 sc1
  s_add_u32 s54, s54, 4096
  s_add_u32 s55, s55, 4096
  v_mfma_f32_32x32x16_bf16 v[64:79], v[160:163], a[204:207], v[64:79]
  ds_read_b128 v[160:163], v1 offset:52224
  s_waitcnt lgkmcnt(5)
  v_mfma_f32_32x32x16_bf16 v[80:95], v[164:167], a[200:203], v[80:95]
  v_mfma_f32_32x32x16_bf16 v[96:111], v[164:167], a[204:207], v[96:111]
  ds_read_b128 v[164:167], v1 offset:64512
  s_waitcnt vmcnt(14)
  s_waitcnt lgkmcnt(5)
  v_mfma_f32_32x32x16_bf16 v[16:31], v[144:147], a[208:211], v[16:31]
  buffer_load_dwordx4 v[224:227], v1, s[4:7], s54 offen offset:0 sc1
  v_mfma_f32_32x32x16_bf16 v[32:47], v[144:147], a[212:215], v[32:47]
  ds_read_b128 v[144:147], v1 offset:40960
  s_waitcnt lgkmcnt(5)
  v_mfma_f32_32x32x16_bf16 v[48:63], v[148:151], a[208:211], v[48:63]
  buffer_load_dwordx4 v[228:231], v1, s[4:7], s55 offen offset:0 sc1
  v_mfma_f32_32x32x16_bf16 v[64:79], v[148:151], a[212:215], v[64:79]
  ds_read_b128 v[148:151], v1 offset:53248
  s_waitcnt lgkmcnt(5)
  v_mfma_f32_32x32x16_bf16 v[80:95], v[152:155], a[208:211], v[80:95]
  v_mfma_f32_32x32x16_bf16 v[96:111], v[152:155], a[212:215], v[96:111]
  ds_read_b128 v[152:155], v2 offset:0
  s_waitcnt vmcnt(14)
  s_waitcnt lgkmcnt(5)
  v_mfma_f32_32x32x16_bf16 v[16:31], v[156:159], a[216:219], v[16:31]
  buffer_load_dwordx4 v[232:235], v1, s[4:7], s54 offen offset:1024 sc1
  v_mfma_f32_32x32x16_bf16 v[32:47], v[156:159], a[220:223], v[32:47]
  ds_read_b128 v[156:159], v1 offset:41984
  s_waitcnt lgkmcnt(5)
  v_mfma_f32_32x32x16_bf16 v[48:63], v[160:163], a[216:219], v[48:63]
  buffer_load_dwordx4 v[236:239], v1, s[4:7], s55 offen offset:1024 sc1
  v_mfma_f32_32x32x16_bf16 v[64:79], v[160:163], a[220:223], v[64:79]
  ds_read_b128 v[160:163], v1 offset:54272
  s_waitcnt lgkmcnt(5)
  v_mfma_f32_32x32x16_bf16 v[80:95], v[164:167], a[216:219], v[80:95]
  v_mfma_f32_32x32x16_bf16 v[96:111], v[164:167], a[220:223], v[96:111]
  ds_read_b128 v[164:167], v2 offset:1024
  s_waitcnt vmcnt(14)
  s_waitcnt lgkmcnt(5)
  v_mfma_f32_32x32x16_bf16 v[16:31], v[144:147], a[224:227], v[16:31]
  buffer_load_dwordx4 v[240:243], v1, s[4:7], s54 offen offset:2048 sc1
  v_mfma_f32_32x32x16_bf16 v[32:47], v[144:147], a[228:231], v[32:47]
  ds_read_b128 v[144:147], v1 offset:43008
  s_waitcnt lgkmcnt(5)
  v_mfma_f32_32x32x16_bf16 v[48:63], v[148:151], a[224:227], v[48:63]
  buffer_load_dwordx4 v[244:247], v1, s[4:7], s55 offen offset:2048 sc1
  v_mfma_f32_32x32x16_bf16 v[64:79], v[148:151], a[228:231], v[64:79]
  ds_read_b128 v[148:151], v1 offset:55296
  s_waitcnt lgkmcnt(5)
  v_mfma_f32_32x32x16_bf16 v[80:95], v[152:155], a[224:227], v[80:95]
  v_mfma_f32_32x32x16_bf16 v[96:111], v[152:155], a[228:231], v[96:111]
  ds_read_b128 v[152:155], v2 offset:2048
  s_waitcnt vmcnt(10)
  s_waitcnt lgkmcnt(5)
  v_mfma_f32_32x32x16_bf16 v[16:31], v[156:159], a[232:235], v[16:31]
  buffer_load_dwordx4 v[248:251], v1, s[4:7], s54 offen offset:3072 sc1
  v_mfma_f32_32x32x16_bf16 v[32:47], v[156:159], a[236:239], v[32:47]
  ds_read_b128 v[156:159], v1 offset:44032
  s_waitcnt lgkmcnt(5)
  v_mfma_f32_32x32x16_bf16 v[48:63], v[160:163], a[232:235], v[48:63]
  buffer_load_dwordx4 v[252:255], v1, s[4:7], s55 offen offset:3072 sc1
  s_add_u32 s54, s54, 4096
  s_add_u32 s55, s55, 4096
  v_mul_f32 v8, 0x3e0e38e4, v112
  v_fmamk_f32 v8, v114, 0x3de38e39, v8
  v_fmamk_f32 v8, v116, 0x3e0e38e4, v8
  v_mfma_f32_32x32x16_bf16 v[64:79], v[160:163], a[236:239], v[64:79]
  v_fmamk_f32 v8, v118, 0x3de38e39, v8
  v_mov_b32 v6, v8
  ds_read_b128 v[160:163], v1 offset:56320
  s_waitcnt lgkmcnt(5)
  v_mfma_f32_32x32x16_bf16 v[80:95], v[164:167], a[232:235], v[80:95]
  v_permlane32_swap_b32 v8, v6
  v_add_f32 v8, v8, v6
  v_mov_b32 v5, v113
  v_mfma_f32_32x32x16_bf16 v[96:111], v[164:167], a[236:239], v[96:111]
  v_add_f32 v5, v5, v115
  v_add_f32 v5, v5, v117
  ds_read_b128 v[164:167], v2 offset:3072
  s_waitcnt vmcnt(10)
  s_waitcnt lgkmcnt(5)
  v_mfma_f32_32x32x16_bf16 v[16:31], v[144:147], a[240:243], v[16:31]
  v_add_f32 v5, v5, v119
  v_sub_f32 v112, v112, v8
  v_mul_f32 v112, v112, v112
  v_mfma_f32_32x32x16_bf16 v[32:47], v[144:147], a[244:247], v[32:47]
  v_fmamk_f32 v5, v112, 0x42a00000, v5
  v_sub_f32 v114, v114, v8
  s_add_u32 s48, s40, 147456
  s_add_u32 m0, s41, 73728
  ds_read_b128 v[144:147], v1 offset:45056
  s_waitcnt lgkmcnt(5)
  v_mfma_f32_32x32x16_bf16 v[48:63], v[148:151], a[240:243], v[48:63]
  v_mul_f32 v114, v114, v114
  v_fmamk_f32 v5, v114, 0x42800000, v5
  v_sub_f32 v116, v116, v8
  v_mfma_f32_32x32x16_bf16 v[64:79], v[148:151], a[244:247], v[64:79]
  v_mul_f32 v116, v116, v116
  v_fmamk_f32 v5, v116, 0x42a00000, v5
  ds_read_b128 v[148:151], v1 offset:57344
  s_waitcnt lgkmcnt(5)
  v_mfma_f32_32x32x16_bf16 v[80:95], v[152:155], a[240:243], v[80:95]
  v_sub_f32 v118, v118, v8
  v_mul_f32 v118, v118, v118
  v_mfma_f32_32x32x16_bf16 v[96:111], v[152:155], a[244:247], v[96:111]
  v_fmamk_f32 v5, v118, 0x42800000, v5
  v_mov_b32 v6, v5
  s_nop 1
  v_permlane32_swap_b32 v5, v6
  buffer_load_dwordx4 v1, s[4:7], s48 offen offset:0 sc1 lds
  ds_read_b128 v[152:155], v2 offset:4096
  s_waitcnt vmcnt(9)
  s_waitcnt lgkmcnt(5)
  v_mfma_f32_32x32x16_bf16 v[16:31], v[156:159], a[248:251], v[16:31]
  v_add_f32 v5, v5, v6
  v_mul_f32 v5, 0x3ae38e39, v5
  v_mfma_f32_32x32x16_bf16 v[32:47], v[156:159], a[252:255], v[32:47]
  v_cvt_pk_bf16_f32 v216, -v8, -v8
  v_cvt_pk_bf16_f32 v5, v5, v5
  v_lshlrev_b32 v5, 16, v5
  ds_read_b128 v[156:159], v1 offset:46080
  s_waitcnt lgkmcnt(5)
  v_mfma_f32_32x32x16_bf16 v[48:63], v[160:163], a[248:251], v[48:63]
  v_add_f32 v5, 0x3727c5ac, v5
  v_cvt_pk_bf16_f32 v5, v5, v5
  v_mfma_f32_32x32x16_bf16 v[64:79], v[160:163], a[252:255], v[64:79]
  v_lshlrev_b32 v5, 16, v5
  v_sqrt_f32 v5, v5
  s_nop 0
  v_cvt_pk_bf16_f32 v6, v5, v5
  buffer_load_dwordx4 v1, s[4:7], s48 offen offset:1024 sc1 lds
  ds_read_b128 v[160:163], v1 offset:58368
  s_waitcnt lgkmcnt(5)
  v_mfma_f32_32x32x16_bf16 v[80:95], v[164:167], a[248:251], v[80:95]
  v_lshlrev_b32 v6, 16, v6
  v_mov_b32 v217, v216
  v_mfma_f32_32x32x16_bf16 v[96:111], v[164:167], a[252:255], v[96:111]
  v_mov_b32 v218, v216
  v_mov_b32 v219, v216
  ds_read_b128 v[164:167], v2 offset:5120
  s_waitcnt vmcnt(8)
  s_waitcnt lgkmcnt(5)
  v_mfma_f32_32x32x16_bf16 v[16:31], v[144:147], v[224:227], v[16:31]
  v_mul_f32 v178, v6, v6
  v_rcp_f32 v6, v6
  s_nop 0
  v_mul_f32 v176, 0xc0135761, v6
  v_mfma_f32_32x32x16_bf16 v[32:47], v[144:147], v[228:231], v[32:47]
  v_mul_f32 v5, v6, v6
  v_mul_f32 v5, 0x3d372713, v5
  buffer_load_dwordx4 v1, s[4:7], s48 offen offset:2048 sc1 lds
  ds_read_b128 v[144:147], v1 offset:47104
  s_waitcnt lgkmcnt(5)
  v_mfma_f32_32x32x16_bf16 v[48:63], v[148:151], v[224:227], v[48:63]
  v_mul_f32 v177, v5, v176
  v_mul_f32 v8, 0x3e0e38e4, v128
  v_fmamk_f32 v8, v130, 0x3de38e39, v8
  v_mfma_f32_32x32x16_bf16 v[64:79], v[148:151], v[228:231], v[64:79]
  v_fmamk_f32 v8, v132, 0x3e0e38e4, v8
  v_fmamk_f32 v8, v134, 0x3de38e39, v8
  ds_read_b128 v[148:151], v1 offset:59392
  s_waitcnt lgkmcnt(5)
  v_mfma_f32_32x32x16_bf16 v[80:95], v[152:155], v[224:227], v[80:95]
  v_mov_b32 v6, v8
  s_nop 1
  v_permlane32_swap_b32 v8, v6
  v_add_f32 v8, v8, v6
  v_mfma_f32_32x32x16_bf16 v[96:111], v[152:155], v[228:231], v[96:111]
  v_mov_b32 v5, v129
  v_add_f32 v5, v5, v131
  buffer_load_dwordx4 v1, s[4:7], s48 offen offset:3072 sc1 lds
  s_add_u32 s48, s48, 4096
  s_add_u32 m0, m0, 4096
  ds_read_b128 v[152:155], v2 offset:6144
  s_waitcnt vmcnt(8)
  s_waitcnt lgkmcnt(5)
  v_mfma_f32_32x32x16_bf16 v[16:31], v[156:159], v[232:235], v[16:31]
  v_add_f32 v5, v5, v133
  v_add_f32 v5, v5, v135
  v_mfma_f32_32x32x16_bf16 v[32:47], v[156:159], v[236:239], v[32:47]
  v_sub_f32 v128, v128, v8
  v_mul_f32 v128, v128, v128
  v_fmamk_f32 v5, v128, 0x42a00000, v5
  ds_read_b128 v[156:159], v1 offset:48128
  s_waitcnt lgkmcnt(5)
  v_mfma_f32_32x32x16_bf16 v[48:63], v[160:163], v[232:235], v[48:63]
  v_sub_f32 v130, v130, v8
  v_mul_f32 v130, v130, v130
  v_mfma_f32_32x32x16_bf16 v[64:79], v[160:163], v[236:239], v[64:79]
  v_fmamk_f32 v5, v130, 0x42800000, v5
  v_sub_f32 v132, v132, v8
  v_mul_f32 v132, v132, v132
  buffer_load_dwordx4 v1, s[4:7], s48 offen offset:0 sc1 lds
  ds_read_b128 v[160:163], v1 offset:60416
  s_waitcnt lgkmcnt(5)
  v_mfma_f32_32x32x16_bf16 v[80:95], v[164:167], v[232:235], v[80:95]
  v_fmamk_f32 v5, v132, 0x42a00000, v5
  v_sub_f32 v134, v134, v8
  v_mfma_f32_32x32x16_bf16 v[96:111], v[164:167], v[236:239], v[96:111]
  v_mul_f32 v134, v134, v134
  v_fmamk_f32 v5, v134, 0x42800000, v5
  v_mov_b32 v6, v5
  ds_read_b128 v[164:167], v2 offset:7168
  s_waitcnt vmcnt(7)
  s_waitcnt lgkmcnt(5)
  v_mfma_f32_32x32x16_bf16 v[16:31], v[144:147], v[240:243], v[16:31]
  v_permlane32_swap_b32 v5, v6
  v_add_f32 v5, v5, v6
  v_mfma_f32_32x32x16_bf16 v[32:47], v[144:147], v[244:247], v[32:47]
  v_mul_f32 v5, 0x3ae38e39, v5
  v_cvt_pk_bf16_f32 v220, -v8, -v8
  buffer_load_dwordx4 v1, s[4:7], s48 offen offset:1024 sc1 lds
  ds_read_b128 v[168:171], v3 offset:16384
  s_waitcnt lgkmcnt(5)
  v_mfma_f32_32x32x16_bf16 v[48:63], v[148:151], v[240:243], v[48:63]
  v_cvt_pk_bf16_f32 v5, v5, v5
  v_lshlrev_b32 v5, 16, v5
  v_add_f32 v5, 0x3727c5ac, v5
  v_mfma_f32_32x32x16_bf16 v[64:79], v[148:151], v[244:247], v[64:79]
  v_cvt_pk_bf16_f32 v5, v5, v5
  v_lshlrev_b32 v5, 16, v5
  ds_read_b128 v[172:175], v3 offset:17408
  s_waitcnt lgkmcnt(5)
  v_mfma_f32_32x32x16_bf16 v[80:95], v[152:155], v[240:243], v[80:95]
  v_sqrt_f32 v5, v5
  s_nop 0
  v_cvt_pk_bf16_f32 v6, v5, v5
  v_lshlrev_b32 v6, 16, v6
  v_mfma_f32_32x32x16_bf16 v[96:111], v[152:155], v[244:247], v[96:111]
  v_mov_b32 v221, v220
  v_mov_b32 v222, v220
  buffer_load_dwordx4 v1, s[4:7], s48 offen offset:2048 sc1 lds
  ds_read_b128 v[184:187], v3 offset:18432
  s_waitcnt vmcnt(7)
  s_waitcnt lgkmcnt(5)
  v_mfma_f32_32x32x16_bf16 v[16:31], v[156:159], v[248:251], v[16:31]
  v_mov_b32 v223, v220
  v_mul_f32 v181, v6, v6
  v_rcp_f32 v6, v6
  v_mfma_f32_32x32x16_bf16 v[32:47], v[156:159], v[252:255], v[32:47]
  v_mul_f32 v179, 0xc0135761, v6
  v_mul_f32 v5, v6, v6
  s_barrier
  ds_read_b128 v[144:147], v1 offset:0
  s_waitcnt lgkmcnt(5)
  v_mfma_f32_32x32x16_bf16 v[48:63], v[160:163], v[248:251], v[48:63]
  v_mul_f32 v5, 0x3d372713, v5
  v_mul_f32 v180, v5, v179
  v_mfma_f32_32x32x16_bf16 v[64:79], v[160:163], v[252:255], v[64:79]
  buffer_load_dwordx4 v1, s[4:7], s48 offen offset:3072 sc1 lds
  s_add_u32 s48, s48, 4096
  s_add_u32 m0, m0, 4096
  ds_read_b128 v[148:151], v1 offset:1024
  s_waitcnt lgkmcnt(5)
  v_mfma_f32_32x32x16_bf16 v[80:95], v[164:167], v[248:251], v[80:95]
  v_mfma_f32_32x32x16_bf16 v[96:111], v[164:167], v[252:255], v[96:111]
  ds_read_b128 v[152:155], v1 offset:2048
  s_waitcnt lgkmcnt(5)
  v_mfma_f32_32x32x16_bf16 v[16:31], v[168:171], v[216:219], v[16:31]
  v_mfma_f32_32x32x16_bf16 v[32:47], v[168:171], v[220:223], v[32:47]
  buffer_load_dwordx4 v1, s[4:7], s48 offen offset:0 sc1 lds
  ds_read_b128 v[156:159], v1 offset:3072
  s_waitcnt lgkmcnt(5)
  v_mfma_f32_32x32x16_bf16 v[48:63], v[172:175], v[216:219], v[48:63]
  v_mfma_f32_32x32x16_bf16 v[64:79], v[172:175], v[220:223], v[64:79]
  ds_read_b128 v[160:163], v1 offset:4096
  s_waitcnt lgkmcnt(5)
  v_mfma_f32_32x32x16_bf16 v[80:95], v[184:187], v[216:219], v[80:95]
  v_mfma_f32_32x32x16_bf16 v[96:111], v[184:187], v[220:223], v[96:111]
  ds_read_b128 v[164:167], v1 offset:5120
  s_waitcnt lgkmcnt(5)
  v_mfma_f32_32x32x16_bf16 v[112:127], v[144:147], a[0:3], 0
  s_add_u32 s48, s40, 184320
  s_add_u32 m0, s41, 110592
  v_mfma_f32_32x32x16_bf16 v[128:143], v[144:147], a[4:7], 0
  ds_read_b128 v[144:147], v1 offset:6144
  s_waitcnt lgkmcnt(5)
  v_mfma_f32_32x32x16_bf16 v[112:127], v[148:151], a[8:11], v[112:127]
  v_mfma_f32_32x32x16_bf16 v[128:143], v[148:151], a[12:15], v[128:143]
  ds_read_b128 v[148:151], v1 offset:7168
  s_waitcnt lgkmcnt(5)
  v_mfma_f32_32x32x16_bf16 v[112:127], v[152:155], a[16:19], v[112:127]
  v_mul_f32 v172, v16, v16
  v_mul_f32 v173, v17, v17
  v_fma_f32 v172, v172, v177, v176
  v_fma_f32 v173, v173, v177, v176
  v_mul_f32 v172, v172, v16
  v_mfma_f32_32x32x16_bf16 v[128:143], v[152:155], a[20:23], v[128:143]
  v_mul_f32 v173, v173, v17
  v_exp_f32 v172, v172
  v_exp_f32 v173, v173
  v_mul_f32 v16, v16, v24
  ds_read_b128 v[152:155], v1 offset:8192
  s_waitcnt lgkmcnt(5)
  v_mfma_f32_32x32x16_bf16 v[112:127], v[156:159], a[24:27], v[112:127]
  buffer_load_dwordx4 v1, s[4:7], s48 offen offset:0 sc1 lds
  v_mul_f32 v17, v17, v25
  v_fma_f32 v172, v172, v178, v178
  v_fma_f32 v173, v173, v178, v178
  v_rcp_f32 v172, v172
  v_mfma_f32_32x32x16_bf16 v[128:143], v[156:159], a[28:31], v[128:143]
  v_rcp_f32 v173, v173
  v_mul_f32 v16, v16, v172
  v_mul_f32 v17, v17, v173
  v_cvt_pk_bf16_f32 v184, v16, v17
  ds_read_b128 v[156:159], v1 offset:9216
  s_waitcnt lgkmcnt(5)
  v_mfma_f32_32x32x16_bf16 v[112:127], v[160:163], a[32:35], v[112:127]
  v_mul_f32 v174, v18, v18
  v_mul_f32 v175, v19, v19
  v_fma_f32 v174, v174, v177, v176
  v_fma_f32 v175, v175, v177, v176
  v_mfma_f32_32x32x16_bf16 v[128:143], v[160:163], a[36:39], v[128:143]
  v_mul_f32 v174, v174, v18
  v_mul_f32 v175, v175, v19
  v_exp_f32 v174, v174
  v_exp_f32 v175, v175
  ds_read_b128 v[160:163], v1 offset:10240
  s_waitcnt lgkmcnt(5)
  v_mfma_f32_32x32x16_bf16 v[112:127], v[164:167], a[40:43], v[112:127]
  v_mul_f32 v18, v18, v26
  v_mul_f32 v19, v19, v27
  v_fma_f32 v174, v174, v178, v178
  v_fma_f32 v175, v175, v178, v178
  v_mfma_f32_32x32x16_bf16 v[128:143], v[164:167], a[44:47], v[128:143]
  v_rcp_f32 v174, v174
  v_rcp_f32 v175, v175
  v_mul_f32 v18, v18, v174
  v_mul_f32 v19, v19, v175
  ds_read_b128 v[164:167], v1 offset:11264
  s_waitcnt lgkmcnt(5)
  v_mfma_f32_32x32x16_bf16 v[112:127], v[144:147], a[48:51], v[112:127]
  buffer_load_dwordx4 v1, s[4:7], s48 offen offset:1024 sc1 lds
  v_cvt_pk_bf16_f32 v185, v18, v19
  v_mul_f32 v172, v20, v20
  v_mul_f32 v173, v21, v21
  v_fma_f32 v172, v172, v177, v176
  v_fma_f32 v173, v173, v177, v176
  v_mfma_f32_32x32x16_bf16 v[128:143], v[144:147], a[52:55], v[128:143]
  v_mul_f32 v172, v172, v20
  v_mul_f32 v173, v173, v21
  v_exp_f32 v172, v172
  v_exp_f32 v173, v173
  ds_read_b128 v[144:147], v1 offset:12288
  s_waitcnt lgkmcnt(5)
  v_mfma_f32_32x32x16_bf16 v[112:127], v[148:151], a[56:59], v[112:127]
  v_mul_f32 v20, v20, v28
  v_mul_f32 v21, v21, v29
  v_fma_f32 v172, v172, v178, v178
  v_fma_f32 v173, v173, v178, v178
  v_mfma_f32_32x32x16_bf16 v[128:143], v[148:151], a[60:63], v[128:143]
  v_rcp_f32 v172, v172
  v_rcp_f32 v173, v173
  v_mul_f32 v20, v20, v172
  v_mul_f32 v21, v21, v173
  ds_read_b128 v[148:151], v1 offset:13312
  s_waitcnt lgkmcnt(5)
  v_mfma_f32_32x32x16_bf16 v[112:127], v[152:155], a[64:67], v[112:127]
  v_cvt_pk_bf16_f32 v186, v20, v21
  v_mul_f32 v174, v22, v22
  v_mul_f32 v175, v23, v23
  v_fma_f32 v174, v174, v177, v176
  v_mfma_f32_32x32x16_bf16 v[128:143], v[152:155], a[68:71], v[128:143]
  v_fma_f32 v175, v175, v177, v176
  v_mul_f32 v174, v174, v22
  v_mul_f32 v175, v175, v23
  v_exp_f32 v174, v174
  ds_read_b128 v[152:155], v1 offset:14336
  s_waitcnt lgkmcnt(5)
  v_mfma_f32_32x32x16_bf16 v[112:127], v[156:159], a[72:75], v[112:127]
  buffer_load_dwordx4 v1, s[4:7], s48 offen offset:2048 sc1 lds
  v_exp_f32 v175, v175
  v_mul_f32 v22, v22, v30
  v_mul_f32 v23, v23, v31
  v_fma_f32 v174, v174, v178, v178
  v_mfma_f32_32x32x16_bf16 v[128:143], v[156:159], a[76:79], v[128:143]
  v_fma_f32 v175, v175, v178, v178
  v_rcp_f32 v174, v174
  v_rcp_f32 v175, v175
  v_mul_f32 v22, v22, v174
  ds_read_b128 v[156:159], v1 offset:15360
  s_waitcnt lgkmcnt(5)
  v_mfma_f32_32x32x16_bf16 v[112:127], v[160:163], a[80:83], v[112:127]
  v_mul_f32 v23, v23, v175
  v_cvt_pk_bf16_f32 v187, v22, v23
  buffer_store_dwordx4 v[184:187], v1, s[4:7], s44 offen sc1
  s_add_u32 s44, s44, 1024
  v_mfma_f32_32x32x16_bf16 v[128:143], v[160:163], a[84:87], v[128:143]
  v_mul_f32 v172, v32, v32
  v_mul_f32 v173, v33, v33
  v_fma_f32 v172, v172, v180, v179
  v_fma_f32 v173, v173, v180, v179
  v_mul_f32 v172, v172, v32
  ds_read_b128 v[160:163], v1 offset:16384
  s_waitcnt lgkmcnt(5)
  v_mfma_f32_32x32x16_bf16 v[112:127], v[164:167], a[88:91], v[112:127]
  v_mul_f32 v173, v173, v33
  v_exp_f32 v172, v172
  v_exp_f32 v173, v173
  v_mul_f32 v32, v32, v40
  v_mfma_f32_32x32x16_bf16 v[128:143], v[164:167], a[92:95], v[128:143]
  v_mul_f32 v33, v33, v41
  v_fma_f32 v172, v172, v181, v181
  v_fma_f32 v173, v173, v181, v181
  v_rcp_f32 v172, v172
  ds_read_b128 v[164:167], v1 offset:17408
  s_waitcnt lgkmcnt(5)
  v_mfma_f32_32x32x16_bf16 v[112:127], v[144:147], a[96:99], v[112:127]
  buffer_load_dwordx4 v1, s[4:7], s48 offen offset:3072 sc1 lds
  s_add_u32 s48, s48, 4096
  s_add_u32 m0, m0, 4096
  v_rcp_f32 v173, v173
  v_mul_f32 v32, v32, v172
  v_mul_f32 v33, v33, v173
  v_cvt_pk_bf16_f32 v188, v32, v33
  v_mfma_f32_32x32x16_bf16 v[128:143], v[144:147], a[100:103], v[128:143]
  v_mul_f32 v174, v34, v34
  v_mul_f32 v175, v35, v35
  v_fma_f32 v174, v174, v180, v179
  v_fma_f32 v175, v175, v180, v179
  ds_read_b128 v[144:147], v1 offset:18432
  s_waitcnt lgkmcnt(5)
  v_mfma_f32_32x32x16_bf16 v[112:127], v[148:151], a[104:107], v[112:127]
  v_mul_f32 v174, v174, v34
  v_mul_f32 v175, v175, v35
  v_exp_f32 v174, v174
  v_exp_f32 v175, v175
  v_mfma_f32_32x32x16_bf16 v[128:143], v[148:151], a[108:111], v[128:143]
  v_mul_f32 v34, v34, v42
  v_mul_f32 v35, v35, v43
  v_fma_f32 v174, v174, v181, v181
  v_fma_f32 v175, v175, v181, v181
  ds_read_b128 v[148:151], v1 offset:19456
  s_waitcnt lgkmcnt(5)
  v_mfma_f32_32x32x16_bf16 v[112:127], v[152:155], a[112:115], v[112:127]
  v_rcp_f32 v174, v174
  v_rcp_f32 v175, v175
  v_mul_f32 v34, v34, v174
  v_mul_f32 v35, v35, v175
  v_mfma_f32_32x32x16_bf16 v[128:143], v[152:155], a[116:119], v[128:143]
  v_cvt_pk_bf16_f32 v189, v34, v35
  v_mul_f32 v172, v36, v36
  v_mul_f32 v173, v37, v37
  v_fma_f32 v172, v172, v180, v179
  v_fma_f32 v173, v173, v180, v179
  ds_read_b128 v[152:155], v1 offset:20480
  s_waitcnt lgkmcnt(5)
  v_mfma_f32_32x32x16_bf16 v[112:127], v[156:159], a[120:123], v[112:127]
  buffer_load_dwordx4 v1, s[4:7], s48 offen offset:0 sc1 lds
  v_mul_f32 v172, v172, v36
  v_mul_f32 v173, v173, v37
  v_exp_f32 v172, v172
  v_exp_f32 v173, v173
  v_mfma_f32_32x32x16_bf16 v[128:143], v[156:159], a[124:127], v[128:143]
  v_mul_f32 v36, v36, v44
  v_mul_f32 v37, v37, v45
  v_fma_f32 v172, v172, v181, v181
  v_fma_f32 v173, v173, v181, v181
  ds_read_b128 v[156:159], v1 offset:21504
  s_waitcnt lgkmcnt(5)
  v_mfma_f32_32x32x16_bf16 v[112:127], v[160:163], a[128:131], v[112:127]
  v_rcp_f32 v172, v172
  v_rcp_f32 v173, v173
  v_mul_f32 v36, v36, v172
  v_mul_f32 v37, v37, v173
  v_mfma_f32_32x32x16_bf16 v[128:143], v[160:163], a[132:135], v[128:143]
  v_cvt_pk_bf16_f32 v190, v36, v37
  v_mul_f32 v174, v38, v38
  v_mul_f32 v175, v39, v39
  v_fma_f32 v174, v174, v180, v179
  ds_read_b128 v[160:163], v1 offset:22528
  s_waitcnt lgkmcnt(5)
  v_mfma_f32_32x32x16_bf16 v[112:127], v[164:167], a[136:139], v[112:127]
  v_fma_f32 v175, v175, v180, v179
  v_mul_f32 v174, v174, v38
  v_mul_f32 v175, v175, v39
  v_exp_f32 v174, v174
  v_mfma_f32_32x32x16_bf16 v[128:143], v[164:167], a[140:143], v[128:143]
  v_exp_f32 v175, v175
  v_mul_f32 v38, v38, v46
  v_mul_f32 v39, v39, v47
  v_fma_f32 v174, v174, v181, v181
  ds_read_b128 v[164:167], v1 offset:23552
  s_waitcnt lgkmcnt(5)
  v_mfma_f32_32x32x16_bf16 v[112:127], v[144:147], a[144:147], v[112:127]
  buffer_load_dwordx4 v1, s[4:7], s48 offen offset:1024 sc1 lds
  v_fma_f32 v175, v175, v181, v181
  v_rcp_f32 v174, v174
  v_rcp_f32 v175, v175
  v_mul_f32 v38, v38, v174
  v_mfma_f32_32x32x16_bf16 v[128:143], v[144:147], a[148:151], v[128:143]
  v_mul_f32 v39, v39, v175
  v_cvt_pk_bf16_f32 v191, v38, v39
  buffer_store_dwordx4 v[188:191], v1, s[4:7], s45 offen sc1
  s_add_u32 s45, s45, 1024
  ds_read_b128 v[144:147], v1 offset:24576
  s_waitcnt lgkmcnt(5)
  v_mfma_f32_32x32x16_bf16 v[112:127], v[148:151], a[152:155], v[112:127]
  v_mul_f32 v172, v48, v48
  v_mul_f32 v173, v49, v49
  v_fma_f32 v172, v172, v177, v176
  v_fma_f32 v173, v173, v177, v176
  v_mul_f32 v172, v172, v48
  v_mfma_f32_32x32x16_bf16 v[128:143], v[148:151], a[156:159], v[128:143]
  v_mul_f32 v173, v173, v49
  v_exp_f32 v172, v172
  v_exp_f32 v173, v173
  v_mul_f32 v48, v48, v56
  ds_read_b128 v[148:151], v1 offset:25600
  s_waitcnt lgkmcnt(5)
  v_mfma_f32_32x32x16_bf16 v[112:127], v[152:155], a[160:163], v[112:127]
  v_mul_f32 v49, v49, v57
  v_fma_f32 v172, v172, v178, v178
  v_fma_f32 v173, v173, v178, v178
  v_rcp_f32 v172, v172
  v_mfma_f32_32x32x16_bf16 v[128:143], v[152:155], a[164:167], v[128:143]
  v_rcp_f32 v173, v173
  v_mul_f32 v48, v48, v172
  v_mul_f32 v49, v49, v173
  v_cvt_pk_bf16_f32 v184, v48, v49
  ds_read_b128 v[152:155], v1 offset:26624
  s_waitcnt lgkmcnt(5)
  v_mfma_f32_32x32x16_bf16 v[112:127], v[156:159], a[168:171], v[112:127]
  buffer_load_dwordx4 v1, s[4:7], s48 offen offset:2048 sc1 lds
  v_mul_f32 v174, v50, v50
  v_mul_f32 v175, v51, v51
  v_fma_f32 v174, v174, v177, v176
  v_fma_f32 v175, v175, v177, v176
  v_mfma_f32_32x32x16_bf16 v[128:143], v[156:159], a[172:175], v[128:143]
  v_mul_f32 v174, v174, v50
  v_mul_f32 v175, v175, v51
  v_exp_f32 v174, v174
  v_exp_f32 v175, v175
  ds_read_b128 v[156:159], v1 offset:27648
  s_waitcnt lgkmcnt(5)
  v_mfma_f32_32x32x16_bf16 v[112:127], v[160:163], a[176:179], v[112:127]
  v_mul_f32 v50, v50, v58
  v_mul_f32 v51, v51, v59
  v_fma_f32 v174, v174, v178, v178
  v_fma_f32 v175, v175, v178, v178
  v_mfma_f32_32x32x16_bf16 v[128:143], v[160:163], a[180:183], v[128:143]
  v_rcp_f32 v174, v174
  v_rcp_f32 v175, v175
  v_mul_f32 v50, v50, v174
  v_mul_f32 v51, v51, v175
  ds_read_b128 v[160:163], v1 offset:28672
  s_waitcnt lgkmcnt(5)
  v_mfma_f32_32x32x16_bf16 v[112:127], v[164:167], a[184:187], v[112:127]
  v_cvt_pk_bf16_f32 v185, v50, v51
  v_mul_f32 v172, v52, v52
  v_mul_f32 v173, v53, v53
  v_fma_f32 v172, v172, v177, v176
  v_fma_f32 v173, v173, v177, v176
  v_mfma_f32_32x32x16_bf16 v[128:143], v[164:167], a[188:191], v[128:143]
  v_mul_f32 v172, v172, v52
  v_mul_f32 v173, v173, v53
  v_exp_f32 v172, v172
  v_exp_f32 v173, v173
  ds_read_b128 v[164:167], v1 offset:29696
  s_waitcnt lgkmcnt(5)
  v_mfma_f32_32x32x16_bf16 v[112:127], v[144:147], a[192:195], v[112:127]
  buffer_load_dwordx4 v1, s[4:7], s48 offen offset:3072 sc1 lds
  s_add_u32 s48, s48, 4096
  s_add_u32 m0, m0, 4096
  v_mul_f32 v52, v52, v60
  v_mul_f32 v53, v53, v61
  v_fma_f32 v172, v172, v178, v178
  v_fma_f32 v173, v173, v178, v178
  v_mfma_f32_32x32x16_bf16 v[128:143], v[144:147], a[196:199], v[128:143]
  v_rcp_f32 v172, v172
  v_rcp_f32 v173, v173
  v_mul_f32 v52, v52, v172
  v_mul_f32 v53, v53, v173
  ds_read_b128 v[144:147], v1 offset:30720
  s_waitcnt lgkmcnt(5)
  v_mfma_f32_32x32x16_bf16 v[112:127], v[148:151], a[200:203], v[112:127]
  v_cvt_pk_bf16_f32 v186, v52, v53
  v_mul_f32 v174, v54, v54
  v_mul_f32 v175, v55, v55
  v_fma_f32 v174, v174, v177, v176
  v_mfma_f32_32x32x16_bf16 v[128:143], v[148:151], a[204:207], v[128:143]
  v_fma_f32 v175, v175, v177, v176
  v_mul_f32 v174, v174, v54
  v_mul_f32 v175, v175, v55
  v_exp_f32 v174, v174
  ds_read_b128 v[148:151], v1 offset:31744
  s_waitcnt lgkmcnt(5)
  v_mfma_f32_32x32x16_bf16 v[112:127], v[152:155], a[208:211], v[112:127]
  v_exp_f32 v175, v175
  v_mul_f32 v54, v54, v62
  v_mul_f32 v55, v55, v63
  v_fma_f32 v174, v174, v178, v178
  v_mfma_f32_32x32x16_bf16 v[128:143], v[152:155], a[212:215], v[128:143]
  v_fma_f32 v175, v175, v178, v178
  v_rcp_f32 v174, v174
  v_rcp_f32 v175, v175
  v_mul_f32 v54, v54, v174
  ds_read_b128 v[152:155], v1 offset:32768
  s_waitcnt lgkmcnt(5)
  v_mfma_f32_32x32x16_bf16 v[112:127], v[156:159], a[216:219], v[112:127]
  buffer_load_dwordx4 v1, s[4:7], s48 offen offset:0 sc1 lds
  v_mul_f32 v55, v55, v175
  v_cvt_pk_bf16_f32 v187, v54, v55
  buffer_store_dwordx4 v[184:187], v1, s[4:7], s44 offen sc1
  s_add_u32 s44, s44, 1024
  v_mfma_f32_32x32x16_bf16 v[128:143], v[156:159], a[220:223], v[128:143]
  v_mul_f32 v172, v64, v64
  v_mul_f32 v173, v65, v65
  v_fma_f32 v172, v172, v180, v179
  v_fma_f32 v173, v173, v180, v179
  v_mul_f32 v172, v172, v64
  ds_read_b128 v[156:159], v1 offset:33792
  s_waitcnt lgkmcnt(5)
  v_mfma_f32_32x32x16_bf16 v[112:127], v[160:163], a[224:227], v[112:127]
  v_mul_f32 v173, v173, v65
  v_exp_f32 v172, v172
  v_exp_f32 v173, v173
  v_mul_f32 v64, v64, v72
  v_mfma_f32_32x32x16_bf16 v[128:143], v[160:163], a[228:231], v[128:143]
  v_mul_f32 v65, v65, v73
  v_fma_f32 v172, v172, v181, v181
  v_fma_f32 v173, v173, v181, v181
  v_rcp_f32 v172, v172
  ds_read_b128 v[160:163], v1 offset:34816
  s_waitcnt lgkmcnt(5)
  v_mfma_f32_32x32x16_bf16 v[112:127], v[164:167], a[232:235], v[112:127]
  v_rcp_f32 v173, v173
  v_mul_f32 v64, v64, v172
  v_mul_f32 v65, v65, v173
  v_cvt_pk_bf16_f32 v188, v64, v65
  v_mfma_f32_32x32x16_bf16 v[128:143], v[164:167], a[236:239], v[128:143]
  v_mul_f32 v174, v66, v66
  v_mul_f32 v175, v67, v67
  v_fma_f32 v174, v174, v180, v179
  v_fma_f32 v175, v175, v180, v179
  ds_read_b128 v[164:167], v1 offset:35840
  s_waitcnt lgkmcnt(5)
  v_mfma_f32_32x32x16_bf16 v[112:127], v[144:147], a[240:243], v[112:127]
  v_mul_f32 v174, v174, v66
  v_mul_f32 v175, v175, v67
  v_exp_f32 v174, v174
  v_exp_f32 v175, v175
  v_mfma_f32_32x32x16_bf16 v[128:143], v[144:147], a[244:247], v[128:143]
  v_mul_f32 v66, v66, v74
  v_mul_f32 v67, v67, v75
  v_fma_f32 v174, v174, v181, v181
  v_fma_f32 v175, v175, v181, v181
  ds_read_b128 v[168:171], v3 offset:19456
  s_waitcnt lgkmcnt(5)
  v_mfma_f32_32x32x16_bf16 v[112:127], v[148:151], a[248:251], v[112:127]
  v_rcp_f32 v174, v174
  v_rcp_f32 v175, v175
  v_mul_f32 v66, v66, v174
  v_mul_f32 v67, v67, v175
  v_mfma_f32_32x32x16_bf16 v[128:143], v[148:151], a[252:255], v[128:143]
  v_cvt_pk_bf16_f32 v189, v66, v67
  v_mul_f32 v172, v68, v68
  v_mul_f32 v173, v69, v69
  v_fma_f32 v172, v172, v180, v179
  v_fma_f32 v173, v173, v180, v179
  s_waitcnt vmcnt(12)
  s_barrier
  ds_read_b128 v[144:147], v2 offset:8192
  s_waitcnt lgkmcnt(5)
  v_mfma_f32_32x32x16_bf16 v[112:127], v[152:155], v[224:227], v[112:127]
  v_mul_f32 v172, v172, v68
  v_mul_f32 v173, v173, v69
  v_exp_f32 v172, v172
  v_exp_f32 v173, v173
  v_mfma_f32_32x32x16_bf16 v[128:143], v[152:155], v[228:231], v[128:143]
  v_mul_f32 v68, v68, v76
  v_mul_f32 v69, v69, v77
  v_fma_f32 v172, v172, v181, v181
  v_fma_f32 v173, v173, v181, v181
  ds_read_b128 v[148:151], v2 offset:9216
  s_waitcnt lgkmcnt(5)
  v_mfma_f32_32x32x16_bf16 v[112:127], v[156:159], v[232:235], v[112:127]
  v_rcp_f32 v172, v172
  v_rcp_f32 v173, v173
  v_mul_f32 v68, v68, v172
  v_mul_f32 v69, v69, v173
  v_mfma_f32_32x32x16_bf16 v[128:143], v[156:159], v[236:239], v[128:143]
  v_cvt_pk_bf16_f32 v190, v68, v69
  v_mul_f32 v174, v70, v70
  v_mul_f32 v175, v71, v71
  v_fma_f32 v174, v174, v180, v179
  ds_read_b128 v[152:155], v2 offset:10240
  s_waitcnt lgkmcnt(5)
  v_mfma_f32_32x32x16_bf16 v[112:127], v[160:163], v[240:243], v[112:127]
  v_fma_f32 v175, v175, v180, v179
  v_mul_f32 v174, v174, v70
  v_mul_f32 v175, v175, v71
  v_exp_f32 v174, v174
  v_mfma_f32_32x32x16_bf16 v[128:143], v[160:163], v[244:247], v[128:143]
  v_exp_f32 v175, v175
  v_mul_f32 v70, v70, v78
  v_mul_f32 v71, v71, v79
  v_fma_f32 v174, v174, v181, v181
  ds_read_b128 v[156:159], v2 offset:11264
  s_waitcnt lgkmcnt(5)
  v_mfma_f32_32x32x16_bf16 v[112:127], v[164:167], v[248:251], v[112:127]
  v_fma_f32 v175, v175, v181, v181
  v_rcp_f32 v174, v174
  v_rcp_f32 v175, v175
  v_mul_f32 v70, v70, v174
  v_mfma_f32_32x32x16_bf16 v[128:143], v[164:167], v[252:255], v[128:143]
  v_mul_f32 v71, v71, v175
  v_cvt_pk_bf16_f32 v191, v70, v71
  buffer_store_dwordx4 v[188:191], v1, s[4:7], s45 offen sc1
  s_add_u32 s45, s45, 1024
  ds_read_b128 v[160:163], v2 offset:12288
  s_waitcnt lgkmcnt(5)
  v_mfma_f32_32x32x16_bf16 v[112:127], v[168:171], v[216:219], v[112:127]
  v_mfma_f32_32x32x16_bf16 v[128:143], v[168:171], v[220:223], v[128:143]
  ds_read_b128 v[164:167], v2 offset:13312
  s_waitcnt lgkmcnt(5)
  v_mfma_f32_32x32x16_bf16 v[16:31], v[144:147], a[0:3], 0
  s_add_u32 s48, s40, 221184
  s_add_u32 m0, s41, 36864
  v_mfma_f32_32x32x16_bf16 v[32:47], v[144:147], a[4:7], 0
  ds_read_b128 v[144:147], v2 offset:14336
  s_waitcnt lgkmcnt(5)
  v_mfma_f32_32x32x16_bf16 v[16:31], v[148:151], a[8:11], v[16:31]
  v_mul_f32 v172, v80, v80
  v_mul_f32 v173, v81, v81
  v_fma_f32 v172, v172, v177, v176
  v_fma_f32 v173, v173, v177, v176
  v_mfma_f32_32x32x16_bf16 v[32:47], v[148:151], a[12:15], v[32:47]
  v_mul_f32 v172, v172, v80
  v_mul_f32 v173, v173, v81
  v_exp_f32 v172, v172
  v_exp_f32 v173, v173
  ds_read_b128 v[148:151], v2 offset:15360
  s_waitcnt lgkmcnt(5)
  v_mfma_f32_32x32x16_bf16 v[16:31], v[152:155], a[16:19], v[16:31]
  v_mul_f32 v80, v80, v88
  v_mul_f32 v81, v81, v89
  v_fma_f32 v172, v172, v178, v178
  v_fma_f32 v173, v173, v178, v178
  v_mfma_f32_32x32x16_bf16 v[32:47], v[152:155], a[20:23], v[32:47]
  v_rcp_f32 v172, v172
  v_rcp_f32 v173, v173
  v_mul_f32 v80, v80, v172
  v_mul_f32 v81, v81, v173
  ds_read_b128 v[152:155], v2 offset:16384
  s_waitcnt lgkmcnt(5)
  v_mfma_f32_32x32x16_bf16 v[16:31], v[156:159], a[24:27], v[16:31]
  buffer_load_dwordx4 v1, s[4:7], s48 offen offset:0 sc1 lds
  v_cvt_pk_bf16_f32 v184, v80, v81
  v_mul_f32 v174, v82, v82
  v_mul_f32 v175, v83, v83
  v_fma_f32 v174, v174, v177, v176
  v_mfma_f32_32x32x16_bf16 v[32:47], v[156:159], a[28:31], v[32:47]
  v_fma_f32 v175, v175, v177, v176
  v_mul_f32 v174, v174, v82
  v_mul_f32 v175, v175, v83
  v_exp_f32 v174, v174
  ds_read_b128 v[156:159], v2 offset:17408
  s_waitcnt lgkmcnt(5)
  v_mfma_f32_32x32x16_bf16 v[16:31], v[160:163], a[32:35], v[16:31]
  v_exp_f32 v175, v175
  v_mul_f32 v82, v82, v90
  v_mul_f32 v83, v83, v91
  v_fma_f32 v174, v174, v178, v178
  v_mfma_f32_32x32x16_bf16 v[32:47], v[160:163], a[36:39], v[32:47]
  v_fma_f32 v175, v175, v178, v178
  v_rcp_f32 v174, v174
  v_rcp_f32 v175, v175
  v_mul_f32 v82, v82, v174
  ds_read_b128 v[160:163], v2 offset:18432
  s_waitcnt lgkmcnt(5)
  v_mfma_f32_32x32x16_bf16 v[16:31], v[164:167], a[40:43], v[16:31]
  v_mul_f32 v83, v83, v175
  v_cvt_pk_bf16_f32 v185, v82, v83
  v_mul_f32 v172, v84, v84
  v_mul_f32 v173, v85, v85
  v_mfma_f32_32x32x16_bf16 v[32:47], v[164:167], a[44:47], v[32:47]
  v_fma_f32 v172, v172, v177, v176
  v_fma_f32 v173, v173, v177, v176
  v_mul_f32 v172, v172, v84
  v_mul_f32 v173, v173, v85
  ds_read_b128 v[164:167], v2 offset:19456
  s_waitcnt lgkmcnt(5)
  v_mfma_f32_32x32x16_bf16 v[16:31], v[144:147], a[48:51], v[16:31]
  buffer_load_dwordx4 v1, s[4:7], s48 offen offset:1024 sc1 lds
  v_exp_f32 v172, v172
  v_exp_f32 v173, v173
  v_mul_f32 v84, v84, v92
  v_mul_f32 v85, v85, v93
  v_mfma_f32_32x32x16_bf16 v[32:47], v[144:147], a[52:55], v[32:47]
  v_fma_f32 v172, v172, v178, v178
  v_fma_f32 v173, v173, v178, v178
  v_rcp_f32 v172, v172
  v_rcp_f32 v173, v173
  ds_read_b128 v[144:147], v2 offset:20480
  s_waitcnt lgkmcnt(5)
  v_mfma_f32_32x32x16_bf16 v[16:31], v[148:151], a[56:59], v[16:31]
  v_mul_f32 v84, v84, v172
  v_mul_f32 v85, v85, v173
  v_cvt_pk_bf16_f32 v186, v84, v85
  v_mul_f32 v174, v86, v86
  v_mfma_f32_32x32x16_bf16 v[32:47], v[148:151], a[60:63], v[32:47]
  v_mul_f32 v175, v87, v87
  v_fma_f32 v174, v174, v177, v176
  v_fma_f32 v175, v175, v177, v176
  v_mul_f32 v174, v174, v86
  ds_read_b128 v[148:151], v2 offset:21504
  s_waitcnt lgkmcnt(5)
  v_mfma_f32_32x32x16_bf16 v[16:31], v[152:155], a[64:67], v[16:31]
  v_mul_f32 v175, v175, v87
  v_exp_f32 v174, v174
  v_exp_f32 v175, v175
  v_mul_f32 v86, v86, v94
  v_mfma_f32_32x32x16_bf16 v[32:47], v[152:155], a[68:71], v[32:47]
  v_mul_f32 v87, v87, v95
  v_fma_f32 v174, v174, v178, v178
  v_fma_f32 v175, v175, v178, v178
  v_rcp_f32 v174, v174
  ds_read_b128 v[152:155], v2 offset:22528
  s_waitcnt lgkmcnt(5)
  v_mfma_f32_32x32x16_bf16 v[16:31], v[156:159], a[72:75], v[16:31]
  buffer_load_dwordx4 v1, s[4:7], s48 offen offset:2048 sc1 lds
  v_rcp_f32 v175, v175
  v_mul_f32 v86, v86, v174
  v_mul_f32 v87, v87, v175
  v_cvt_pk_bf16_f32 v187, v86, v87
  v_mfma_f32_32x32x16_bf16 v[32:47], v[156:159], a[76:79], v[32:47]
  buffer_store_dwordx4 v[184:187], v1, s[4:7], s44 offen sc1
  s_add_u32 s44, s44, 1024
  v_mul_f32 v172, v96, v96
  v_mul_f32 v173, v97, v97
  ds_read_b128 v[156:159], v2 offset:23552
  s_waitcnt lgkmcnt(5)
  v_mfma_f32_32x32x16_bf16 v[16:31], v[160:163], a[80:83], v[16:31]
  v_fma_f32 v172, v172, v180, v179
  v_fma_f32 v173, v173, v180, v179
  v_mul_f32 v172, v172, v96
  v_mul_f32 v173, v173, v97
  v_mfma_f32_32x32x16_bf16 v[32:47], v[160:163], a[84:87], v[32:47]
  v_exp_f32 v172, v172
  v_exp_f32 v173, v173
  v_mul_f32 v96, v96, v104
  v_mul_f32 v97, v97, v105
  ds_read_b128 v[160:163], v2 offset:24576
  s_waitcnt lgkmcnt(5)
  v_mfma_f32_32x32x16_bf16 v[16:31], v[164:167], a[88:91], v[16:31]
  v_fma_f32 v172, v172, v181, v181
  v_fma_f32 v173, v173, v181, v181
  v_rcp_f32 v172, v172
  v_rcp_f32 v173, v173
  v_mfma_f32_32x32x16_bf16 v[32:47], v[164:167], a[92:95], v[32:47]
  v_mul_f32 v96, v96, v172
  v_mul_f32 v97, v97, v173
  v_cvt_pk_bf16_f32 v188, v96, v97
  v_mul_f32 v174, v98, v98
  ds_read_b128 v[164:167], v2 offset:25600
  s_waitcnt lgkmcnt(5)
  v_mfma_f32_32x32x16_bf16 v[16:31], v[144:147], a[96:99], v[16:31]
  buffer_load_dwordx4 v1, s[4:7], s48 offen offset:3072 sc1 lds
  s_add_u32 s48, s48, 4096
  s_add_u32 m0, m0, 4096
  v_mul_f32 v175, v99, v99
  v_fma_f32 v174, v174, v180, v179
  v_fma_f32 v175, v175, v180, v179
  v_mul_f32 v174, v174, v98
  v_mfma_f32_32x32x16_bf16 v[32:47], v[144:147], a[100:103], v[32:47]
  v_mul_f32 v175, v175, v99
  v_exp_f32 v174, v174
  v_exp_f32 v175, v175
  v_mul_f32 v98, v98, v106
  ds_read_b128 v[144:147], v2 offset:26624
  s_waitcnt lgkmcnt(5)
  v_mfma_f32_32x32x16_bf16 v[16:31], v[148:151], a[104:107], v[16:31]
  v_mul_f32 v99, v99, v107
  v_fma_f32 v174, v174, v181, v181
  v_fma_f32 v175, v175, v181, v181
  v_rcp_f32 v174, v174
  v_mfma_f32_32x32x16_bf16 v[32:47], v[148:151], a[108:111], v[32:47]
  v_rcp_f32 v175, v175
  v_mul_f32 v98, v98, v174
  v_mul_f32 v99, v99, v175
  v_cvt_pk_bf16_f32 v189, v98, v99
  ds_read_b128 v[148:151], v2 offset:27648
  s_waitcnt lgkmcnt(5)
  v_mfma_f32_32x32x16_bf16 v[16:31], v[152:155], a[112:115], v[16:31]
  v_mul_f32 v172, v100, v100
  v_mul_f32 v173, v101, v101
  v_fma_f32 v172, v172, v180, v179
  v_fma_f32 v173, v173, v180, v179
  v_mfma_f32_32x32x16_bf16 v[32:47], v[152:155], a[116:119], v[32:47]
  v_mul_f32 v172, v172, v100
  v_mul_f32 v173, v173, v101
  v_exp_f32 v172, v172
  v_exp_f32 v173, v173
  ds_read_b128 v[152:155], v2 offset:28672
  s_waitcnt lgkmcnt(5)
  v_mfma_f32_32x32x16_bf16 v[16:31], v[156:159], a[120:123], v[16:31]
  buffer_load_dwordx4 v1, s[4:7], s48 offen offset:0 sc1 lds
  v_mul_f32 v100, v100, v108
  v_mul_f32 v101, v101, v109
  v_fma_f32 v172, v172, v181, v181
  v_fma_f32 v173, v173, v181, v181
  v_mfma_f32_32x32x16_bf16 v[32:47], v[156:159], a[124:127], v[32:47]
  v_rcp_f32 v172, v172
  v_rcp_f32 v173, v173
  v_mul_f32 v100, v100, v172
  v_mul_f32 v101, v101, v173
  ds_read_b128 v[156:159], v2 offset:29696
  s_waitcnt lgkmcnt(5)
  v_mfma_f32_32x32x16_bf16 v[16:31], v[160:163], a[128:131], v[16:31]
  v_cvt_pk_bf16_f32 v190, v100, v101
  v_mul_f32 v174, v102, v102
  v_mul_f32 v175, v103, v103
  v_fma_f32 v174, v174, v180, v179
  v_mfma_f32_32x32x16_bf16 v[32:47], v[160:163], a[132:135], v[32:47]
  v_fma_f32 v175, v175, v180, v179
  v_mul_f32 v174, v174, v102
  v_mul_f32 v175, v175, v103
  v_exp_f32 v174, v174
  ds_read_b128 v[160:163], v2 offset:30720
  s_waitcnt lgkmcnt(5)
  v_mfma_f32_32x32x16_bf16 v[16:31], v[164:167], a[136:139], v[16:31]
  v_exp_f32 v175, v175
  v_mul_f32 v102, v102, v110
  v_mul_f32 v103, v103, v111
  v_fma_f32 v174, v174, v181, v181
  v_mfma_f32_32x32x16_bf16 v[32:47], v[164:167], a[140:143], v[32:47]
  v_fma_f32 v175, v175, v181, v181
  v_rcp_f32 v174, v174
  v_rcp_f32 v175, v175
  v_mul_f32 v102, v102, v174
  ds_read_b128 v[164:167], v2 offset:31744
  s_waitcnt lgkmcnt(5)
  v_mfma_f32_32x32x16_bf16 v[16:31], v[144:147], a[144:147], v[16:31]
  buffer_load_dwordx4 v1, s[4:7], s48 offen offset:1024 sc1 lds
  v_mul_f32 v103, v103, v175
  v_cvt_pk_bf16_f32 v191, v102, v103
  buffer_store_dwordx4 v[188:191], v1, s[4:7], s45 offen sc1
  s_add_u32 s45, s45, 1024
  v_mfma_f32_32x32x16_bf16 v[32:47], v[144:147], a[148:151], v[32:47]
  v_mul_f32 v172, v112, v112
  v_mul_f32 v173, v113, v113
  v_fma_f32 v172, v172, v177, v176
  v_fma_f32 v173, v173, v177, v176
  ds_read_b128 v[144:147], v2 offset:32768
  s_waitcnt lgkmcnt(5)
  v_mfma_f32_32x32x16_bf16 v[16:31], v[148:151], a[152:155], v[16:31]
  v_mul_f32 v172, v172, v112
  v_mul_f32 v173, v173, v113
  v_exp_f32 v172, v172
  v_exp_f32 v173, v173
  v_mfma_f32_32x32x16_bf16 v[32:47], v[148:151], a[156:159], v[32:47]
  v_mul_f32 v112, v112, v120
  v_mul_f32 v113, v113, v121
  v_fma_f32 v172, v172, v178, v178
  v_fma_f32 v173, v173, v178, v178
  ds_read_b128 v[148:151], v2 offset:33792
  s_waitcnt lgkmcnt(5)
  v_mfma_f32_32x32x16_bf16 v[16:31], v[152:155], a[160:163], v[16:31]
  v_rcp_f32 v172, v172
  v_rcp_f32 v173, v173
  v_mul_f32 v112, v112, v172
  v_mul_f32 v113, v113, v173
  v_mfma_f32_32x32x16_bf16 v[32:47], v[152:155], a[164:167], v[32:47]
  v_cvt_pk_bf16_f32 v184, v112, v113
  v_mul_f32 v174, v114, v114
  v_mul_f32 v175, v115, v115
  v_fma_f32 v174, v174, v177, v176
  ds_read_b128 v[152:155], v2 offset:34816
  s_waitcnt lgkmcnt(5)
  v_mfma_f32_32x32x16_bf16 v[16:31], v[156:159], a[168:171], v[16:31]
  buffer_load_dwordx4 v1, s[4:7], s48 offen offset:2048 sc1 lds
  v_fma_f32 v175, v175, v177, v176
  v_mul_f32 v174, v174, v114
  v_mul_f32 v175, v175, v115
  v_exp_f32 v174, v174
  v_mfma_f32_32x32x16_bf16 v[32:47], v[156:159], a[172:175], v[32:47]
  v_exp_f32 v175, v175
  v_mul_f32 v114, v114, v122
  v_mul_f32 v115, v115, v123
  v_fma_f32 v174, v174, v178, v178
  ds_read_b128 v[156:159], v2 offset:35840
  s_waitcnt lgkmcnt(5)
  v_mfma_f32_32x32x16_bf16 v[16:31], v[160:163], a[176:179], v[16:31]
  v_fma_f32 v175, v175, v178, v178
  v_rcp_f32 v174, v174
  v_rcp_f32 v175, v175
  v_mul_f32 v114, v114, v174
  v_mfma_f32_32x32x16_bf16 v[32:47], v[160:163], a[180:183], v[32:47]
  v_mul_f32 v115, v115, v175
  v_cvt_pk_bf16_f32 v185, v114, v115
  v_mul_f32 v172, v116, v116
  v_mul_f32 v173, v117, v117
  ds_read_b128 v[160:163], v2 offset:36864
  s_waitcnt lgkmcnt(5)
  v_mfma_f32_32x32x16_bf16 v[16:31], v[164:167], a[184:187], v[16:31]
  v_fma_f32 v172, v172, v177, v176
  v_fma_f32 v173, v173, v177, v176
  v_mul_f32 v172, v172, v116
  v_mul_f32 v173, v173, v117
  v_mfma_f32_32x32x16_bf16 v[32:47], v[164:167], a[188:191], v[32:47]
  v_exp_f32 v172, v172
  v_exp_f32 v173, v173
  v_mul_f32 v116, v116, v124
  v_mul_f32 v117, v117, v125
  ds_read_b128 v[164:167], v2 offset:37888
  s_waitcnt lgkmcnt(5)
  v_mfma_f32_32x32x16_bf16 v[16:31], v[144:147], a[192:195], v[16:31]
  buffer_load_dwordx4 v1, s[4:7], s48 offen offset:3072 sc1 lds
  s_add_u32 s48, s48, 4096
  s_add_u32 m0, m0, 4096
  v_fma_f32 v172, v172, v178, v178
  v_fma_f32 v173, v173, v178, v178
  v_rcp_f32 v172, v172
  v_rcp_f32 v173, v173
  v_mfma_f32_32x32x16_bf16 v[32:47], v[144:147], a[196:199], v[32:47]
  v_mul_f32 v116, v116, v172
  v_mul_f32 v117, v117, v173
  v_cvt_pk_bf16_f32 v186, v116, v117
  v_mul_f32 v174, v118, v118
  ds_read_b128 v[144:147], v2 offset:38912
  s_waitcnt lgkmcnt(5)
  v_mfma_f32_32x32x16_bf16 v[16:31], v[148:151], a[200:203], v[16:31]
  v_mul_f32 v175, v119, v119
  v_fma_f32 v174, v174, v177, v176
  v_fma_f32 v175, v175, v177, v176
  v_mul_f32 v174, v174, v118
  v_mfma_f32_32x32x16_bf16 v[32:47], v[148:151], a[204:207], v[32:47]
  v_mul_f32 v175, v175, v119
  v_exp_f32 v174, v174
  v_exp_f32 v175, v175
  v_mul_f32 v118, v118, v126
  ds_read_b128 v[148:151], v2 offset:39936
  s_waitcnt lgkmcnt(5)
  v_mfma_f32_32x32x16_bf16 v[16:31], v[152:155], a[208:211], v[16:31]
  v_mul_f32 v119, v119, v127
  v_fma_f32 v174, v174, v178, v178
  v_fma_f32 v175, v175, v178, v178
  v_rcp_f32 v174, v174
  v_mfma_f32_32x32x16_bf16 v[32:47], v[152:155], a[212:215], v[32:47]
  v_rcp_f32 v175, v175
  v_mul_f32 v118, v118, v174
  v_mul_f32 v119, v119, v175
  v_cvt_pk_bf16_f32 v187, v118, v119
  ds_read_b128 v[152:155], v2 offset:40960
  s_waitcnt lgkmcnt(5)
  v_mfma_f32_32x32x16_bf16 v[16:31], v[156:159], a[216:219], v[16:31]
  buffer_load_dwordx4 v1, s[4:7], s48 offen offset:0 sc1 lds
  buffer_store_dwordx4 v[184:187], v1, s[4:7], s44 offen sc1
  s_add_u32 s44, s44, 1024
  v_mul_f32 v172, v128, v128
  v_mul_f32 v173, v129, v129
  v_mfma_f32_32x32x16_bf16 v[32:47], v[156:159], a[220:223], v[32:47]
  v_fma_f32 v172, v172, v180, v179
  v_fma_f32 v173, v173, v180, v179
  v_mul_f32 v172, v172, v128
  v_mul_f32 v173, v173, v129
  ds_read_b128 v[156:159], v2 offset:41984
  s_waitcnt lgkmcnt(5)
  v_mfma_f32_32x32x16_bf16 v[16:31], v[160:163], a[224:227], v[16:31]
  v_exp_f32 v172, v172
  v_exp_f32 v173, v173
  v_mul_f32 v128, v128, v136
  v_mul_f32 v129, v129, v137
  v_mfma_f32_32x32x16_bf16 v[32:47], v[160:163], a[228:231], v[32:47]
  v_fma_f32 v172, v172, v181, v181
  v_fma_f32 v173, v173, v181, v181
  v_rcp_f32 v172, v172
  v_rcp_f32 v173, v173
  ds_read_b128 v[160:163], v2 offset:43008
  s_waitcnt lgkmcnt(5)
  v_mfma_f32_32x32x16_bf16 v[16:31], v[164:167], a[232:235], v[16:31]
  v_mul_f32 v128, v128, v172
  v_mul_f32 v129, v129, v173
  v_cvt_pk_bf16_f32 v188, v128, v129
  v_mul_f32 v174, v130, v130
  v_mfma_f32_32x32x16_bf16 v[32:47], v[164:167], a[236:239], v[32:47]
  v_mul_f32 v175, v131, v131
  v_fma_f32 v174, v174, v180, v179
  v_fma_f32 v175, v175, v180, v179
  v_mul_f32 v174, v174, v130
  ds_read_b128 v[164:167], v2 offset:44032
  s_waitcnt lgkmcnt(5)
  v_mfma_f32_32x32x16_bf16 v[16:31], v[144:147], a[240:243], v[16:31]
  v_mul_f32 v175, v175, v131
  v_exp_f32 v174, v174
  v_exp_f32 v175, v175
  v_mul_f32 v130, v130, v138
  v_mfma_f32_32x32x16_bf16 v[32:47], v[144:147], a[244:247], v[32:47]
  v_mul_f32 v131, v131, v139
  v_fma_f32 v174, v174, v181, v181
  v_fma_f32 v175, v175, v181, v181
  v_rcp_f32 v174, v174
  ds_read_b128 v[168:171], v3 offset:20480
  s_waitcnt lgkmcnt(5)
  v_mfma_f32_32x32x16_bf16 v[16:31], v[148:151], a[248:251], v[16:31]
  v_rcp_f32 v175, v175
  v_mul_f32 v130, v130, v174
  v_mul_f32 v131, v131, v175
  v_cvt_pk_bf16_f32 v189, v130, v131
  v_mfma_f32_32x32x16_bf16 v[32:47], v[148:151], a[252:255], v[32:47]
  v_mul_f32 v172, v132, v132
  v_mul_f32 v173, v133, v133
  v_fma_f32 v172, v172, v180, v179
  v_fma_f32 v173, v173, v180, v179
  s_waitcnt vmcnt(14)
  s_barrier
  ds_read_b128 v[144:147], v2 offset:45056
  s_waitcnt lgkmcnt(5)
  v_mfma_f32_32x32x16_bf16 v[16:31], v[152:155], v[224:227], v[16:31]
  v_mul_f32 v172, v172, v132
  v_mul_f32 v173, v173, v133
  v_exp_f32 v172, v172
  v_exp_f32 v173, v173
  v_mfma_f32_32x32x16_bf16 v[32:47], v[152:155], v[228:231], v[32:47]
  v_mul_f32 v132, v132, v140
  v_mul_f32 v133, v133, v141
  v_fma_f32 v172, v172, v181, v181
  v_fma_f32 v173, v173, v181, v181
  ds_read_b128 v[148:151], v2 offset:46080
  s_waitcnt lgkmcnt(5)
  v_mfma_f32_32x32x16_bf16 v[16:31], v[156:159], v[232:235], v[16:31]
  v_rcp_f32 v172, v172
  v_rcp_f32 v173, v173
  v_mul_f32 v132, v132, v172
  v_mul_f32 v133, v133, v173
  v_mfma_f32_32x32x16_bf16 v[32:47], v[156:159], v[236:239], v[32:47]
  v_cvt_pk_bf16_f32 v190, v132, v133
  v_mul_f32 v174, v134, v134
  v_mul_f32 v175, v135, v135
  v_fma_f32 v174, v174, v180, v179
  ds_read_b128 v[152:155], v2 offset:47104
  s_waitcnt lgkmcnt(5)
  v_mfma_f32_32x32x16_bf16 v[16:31], v[160:163], v[240:243], v[16:31]
  v_fma_f32 v175, v175, v180, v179
  v_mul_f32 v174, v174, v134
  v_mul_f32 v175, v175, v135
  v_exp_f32 v174, v174
  v_mfma_f32_32x32x16_bf16 v[32:47], v[160:163], v[244:247], v[32:47]
  v_exp_f32 v175, v175
  v_mul_f32 v134, v134, v142
  v_mul_f32 v135, v135, v143
  v_fma_f32 v174, v174, v181, v181
  ds_read_b128 v[156:159], v2 offset:48128
  s_waitcnt lgkmcnt(5)
  v_mfma_f32_32x32x16_bf16 v[16:31], v[164:167], v[248:251], v[16:31]
  v_fma_f32 v175, v175, v181, v181
  v_rcp_f32 v174, v174
  v_rcp_f32 v175, v175
  v_mul_f32 v134, v134, v174
  v_mfma_f32_32x32x16_bf16 v[32:47], v[164:167], v[252:255], v[32:47]
  v_mul_f32 v135, v135, v175
  v_cvt_pk_bf16_f32 v191, v134, v135
  buffer_store_dwordx4 v[188:191], v1, s[4:7], s45 offen sc1
  s_add_u32 s45, s45, 1024
  ds_read_b128 v[160:163], v2 offset:49152
  s_waitcnt lgkmcnt(5)
  v_mfma_f32_32x32x16_bf16 v[16:31], v[168:171], v[216:219], v[16:31]
  v_mfma_f32_32x32x16_bf16 v[32:47], v[168:171], v[220:223], v[32:47]
  ds_read_b128 v[164:167], v2 offset:50176
  s_waitcnt lgkmcnt(5)
  v_mfma_f32_32x32x16_bf16 v[48:63], v[144:147], a[0:3], 0
  s_add_u32 s48, s40, 258048
  s_add_u32 m0, s41, 0
  v_mfma_f32_32x32x16_bf16 v[64:79], v[144:147], a[4:7], 0
  ds_read_b128 v[144:147], v2 offset:51200
  s_waitcnt lgkmcnt(5)
  v_mfma_f32_32x32x16_bf16 v[48:63], v[148:151], a[8:11], v[48:63]
  v_mfma_f32_32x32x16_bf16 v[64:79], v[148:151], a[12:15], v[64:79]
  ds_read_b128 v[148:151], v2 offset:52224
  s_waitcnt lgkmcnt(5)
  v_mfma_f32_32x32x16_bf16 v[48:63], v[152:155], a[16:19], v[48:63]
  v_mul_f32 v172, v16, v16
  v_mul_f32 v173, v17, v17
  v_fma_f32 v172, v172, v177, v176
  v_mfma_f32_32x32x16_bf16 v[64:79], v[152:155], a[20:23], v[64:79]
  v_fma_f32 v173, v173, v177, v176
  v_mul_f32 v172, v172, v16
  ds_read_b128 v[152:155], v2 offset:53248
  s_waitcnt lgkmcnt(5)
  v_mfma_f32_32x32x16_bf16 v[48:63], v[156:159], a[24:27], v[48:63]
  buffer_load_dwordx4 v1, s[4:7], s48 offen offset:0 sc1 lds
  v_mul_f32 v173, v173, v17
  v_exp_f32 v172, v172
  v_mfma_f32_32x32x16_bf16 v[64:79], v[156:159], a[28:31], v[64:79]
  v_exp_f32 v173, v173
  v_mul_f32 v16, v16, v24
  ds_read_b128 v[156:159], v2 offset:54272
  s_waitcnt lgkmcnt(5)
  v_mfma_f32_32x32x16_bf16 v[48:63], v[160:163], a[32:35], v[48:63]
  v_mul_f32 v17, v17, v25
  v_fma_f32 v172, v172, v178, v178
  v_mfma_f32_32x32x16_bf16 v[64:79], v[160:163], a[36:39], v[64:79]
  v_fma_f32 v173, v173, v178, v178
  v_rcp_f32 v172, v172
  ds_read_b128 v[160:163], v2 offset:55296
  s_waitcnt lgkmcnt(5)
  v_mfma_f32_32x32x16_bf16 v[48:63], v[164:167], a[40:43], v[48:63]
  v_rcp_f32 v173, v173
  v_mul_f32 v16, v16, v172
  v_mfma_f32_32x32x16_bf16 v[64:79], v[164:167], a[44:47], v[64:79]
  v_mul_f32 v17, v17, v173
  v_cvt_pk_bf16_f32 v184, v16, v17
  ds_read_b128 v[164:167], v2 offset:56320
  s_waitcnt lgkmcnt(5)
  v_mfma_f32_32x32x16_bf16 v[48:63], v[144:147], a[48:51], v[48:63]
  buffer_load_dwordx4 v1, s[4:7], s48 offen offset:1024 sc1 lds
  v_mul_f32 v174, v18, v18
  v_mul_f32 v175, v19, v19
  v_fma_f32 v174, v174, v177, v176
  v_mfma_f32_32x32x16_bf16 v[64:79], v[144:147], a[52:55], v[64:79]
  v_fma_f32 v175, v175, v177, v176
  v_mul_f32 v174, v174, v18
  ds_read_b128 v[144:147], v2 offset:57344
  s_waitcnt lgkmcnt(5)
  v_mfma_f32_32x32x16_bf16 v[48:63], v[148:151], a[56:59], v[48:63]
  v_mul_f32 v175, v175, v19
  v_exp_f32 v174, v174
  v_mfma_f32_32x32x16_bf16 v[64:79], v[148:151], a[60:63], v[64:79]
  v_exp_f32 v175, v175
  v_mul_f32 v18, v18, v26
  ds_read_b128 v[148:151], v2 offset:58368
  s_waitcnt lgkmcnt(5)
  v_mfma_f32_32x32x16_bf16 v[48:63], v[152:155], a[64:67], v[48:63]
  v_mul_f32 v19, v19, v27
  v_fma_f32 v174, v174, v178, v178
  v_mfma_f32_32x32x16_bf16 v[64:79], v[152:155], a[68:71], v[64:79]
  v_fma_f32 v175, v175, v178, v178
  v_rcp_f32 v174, v174
  ds_read_b128 v[152:155], v2 offset:59392
  s_waitcnt lgkmcnt(5)
  v_mfma_f32_32x32x16_bf16 v[48:63], v[156:159], a[72:75], v[48:63]
  buffer_load_dwordx4 v1, s[4:7], s48 offen offset:2048 sc1 lds
  v_rcp_f32 v175, v175
  v_mul_f32 v18, v18, v174
  v_mfma_f32_32x32x16_bf16 v[64:79], v[156:159], a[76:79], v[64:79]
  v_mul_f32 v19, v19, v175
  v_cvt_pk_bf16_f32 v185, v18, v19
  ds_read_b128 v[156:159], v2 offset:60416
  s_waitcnt lgkmcnt(5)
  v_mfma_f32_32x32x16_bf16 v[48:63], v[160:163], a[80:83], v[48:63]
  v_mul_f32 v172, v20, v20
  v_mul_f32 v173, v21, v21
  v_fma_f32 v172, v172, v177, v176
  v_mfma_f32_32x32x16_bf16 v[64:79], v[160:163], a[84:87], v[64:79]
  v_fma_f32 v173, v173, v177, v176
  v_mul_f32 v172, v172, v20
  ds_read_b128 v[160:163], v2 offset:61440
  s_waitcnt lgkmcnt(5)
  v_mfma_f32_32x32x16_bf16 v[48:63], v[164:167], a[88:91], v[48:63]
  v_mul_f32 v173, v173, v21
  v_exp_f32 v172, v172
  v_mfma_f32_32x32x16_bf16 v[64:79], v[164:167], a[92:95], v[64:79]
  v_exp_f32 v173, v173
  v_mul_f32 v20, v20, v28
  ds_read_b128 v[164:167], v2 offset:62464
  s_waitcnt lgkmcnt(5)
  v_mfma_f32_32x32x16_bf16 v[48:63], v[144:147], a[96:99], v[48:63]
  buffer_load_dwordx4 v1, s[4:7], s48 offen offset:3072 sc1 lds
  s_add_u32 s48, s48, 4096
  s_add_u32 m0, m0, 4096
  v_mul_f32 v21, v21, v29
  v_fma_f32 v172, v172, v178, v178
  v_mfma_f32_32x32x16_bf16 v[64:79], v[144:147], a[100:103], v[64:79]
  v_fma_f32 v173, v173, v178, v178
  v_rcp_f32 v172, v172
  ds_read_b128 v[144:147], v2 offset:63488
  s_waitcnt lgkmcnt(5)
  v_mfma_f32_32x32x16_bf16 v[48:63], v[148:151], a[104:107], v[48:63]
  v_rcp_f32 v173, v173
  v_mul_f32 v20, v20, v172
  v_mfma_f32_32x32x16_bf16 v[64:79], v[148:151], a[108:111], v[64:79]
  v_mul_f32 v21, v21, v173
  v_cvt_pk_bf16_f32 v186, v20, v21
  ds_read_b128 v[148:151], v2 offset:64512
  s_waitcnt lgkmcnt(5)
  v_mfma_f32_32x32x16_bf16 v[48:63], v[152:155], a[112:115], v[48:63]
  v_mul_f32 v174, v22, v22
  v_mul_f32 v175, v23, v23
  v_fma_f32 v174, v174, v177, v176
  v_mfma_f32_32x32x16_bf16 v[64:79], v[152:155], a[116:119], v[64:79]
  v_fma_f32 v175, v175, v177, v176
  v_mul_f32 v174, v174, v22
  ds_read_b128 v[152:155], v3 offset:0
  s_waitcnt lgkmcnt(5)
  v_mfma_f32_32x32x16_bf16 v[48:63], v[156:159], a[120:123], v[48:63]
  buffer_load_dwordx4 v1, s[4:7], s48 offen offset:0 sc1 lds
  v_mul_f32 v175, v175, v23
  v_exp_f32 v174, v174
  v_mfma_f32_32x32x16_bf16 v[64:79], v[156:159], a[124:127], v[64:79]
  v_exp_f32 v175, v175
  v_mul_f32 v22, v22, v30
  ds_read_b128 v[156:159], v3 offset:1024
  s_waitcnt lgkmcnt(5)
  v_mfma_f32_32x32x16_bf16 v[48:63], v[160:163], a[128:131], v[48:63]
  v_mul_f32 v23, v23, v31
  v_fma_f32 v174, v174, v178, v178
  v_mfma_f32_32x32x16_bf16 v[64:79], v[160:163], a[132:135], v[64:79]
  v_fma_f32 v175, v175, v178, v178
  v_rcp_f32 v174, v174
  ds_read_b128 v[160:163], v3 offset:2048
  s_waitcnt lgkmcnt(5)
  v_mfma_f32_32x32x16_bf16 v[48:63], v[164:167], a[136:139], v[48:63]
  v_rcp_f32 v175, v175
  v_mul_f32 v22, v22, v174
  v_mfma_f32_32x32x16_bf16 v[64:79], v[164:167], a[140:143], v[64:79]
  v_mul_f32 v23, v23, v175
  v_cvt_pk_bf16_f32 v187, v22, v23
  ds_read_b128 v[164:167], v3 offset:3072
  s_waitcnt lgkmcnt(5)
  v_mfma_f32_32x32x16_bf16 v[48:63], v[144:147], a[144:147], v[48:63]
  buffer_load_dwordx4 v1, s[4:7], s48 offen offset:1024 sc1 lds
  buffer_store_dwordx4 v[184:187], v1, s[4:7], s44 offen sc1
  s_add_u32 s44, s44, 1024
  v_mfma_f32_32x32x16_bf16 v[64:79], v[144:147], a[148:151], v[64:79]
  v_mul_f32 v172, v32, v32
  v_mul_f32 v173, v33, v33
  v_fma_f32 v172, v172, v180, v179
  ds_read_b128 v[144:147], v3 offset:4096
  s_waitcnt lgkmcnt(5)
  v_mfma_f32_32x32x16_bf16 v[48:63], v[148:151], a[152:155], v[48:63]
  v_fma_f32 v173, v173, v180, v179
  v_mul_f32 v172, v172, v32
  v_mfma_f32_32x32x16_bf16 v[64:79], v[148:151], a[156:159], v[64:79]
  v_mul_f32 v173, v173, v33
  v_exp_f32 v172, v172
  ds_read_b128 v[148:151], v3 offset:5120
  s_waitcnt lgkmcnt(5)
  v_mfma_f32_32x32x16_bf16 v[48:63], v[152:155], a[160:163], v[48:63]
  v_exp_f32 v173, v173
  v_mul_f32 v32, v32, v40
  v_mfma_f32_32x32x16_bf16 v[64:79], v[152:155], a[164:167], v[64:79]
  v_mul_f32 v33, v33, v41
  v_fma_f32 v172, v172, v181, v181
  ds_read_b128 v[152:155], v3 offset:6144
  s_waitcnt lgkmcnt(5)
  v_mfma_f32_32x32x16_bf16 v[48:63], v[156:159], a[168:171], v[48:63]
  buffer_load_dwordx4 v1, s[4:7], s48 offen offset:2048 sc1 lds
  v_fma_f32 v173, v173, v181, v181
  v_rcp_f32 v172, v172
  v_mfma_f32_32x32x16_bf16 v[64:79], v[156:159], a[172:175], v[64:79]
  v_rcp_f32 v173, v173
  v_mul_f32 v32, v32, v172
  ds_read_b128 v[156:159], v3 offset:7168
  s_waitcnt lgkmcnt(5)
  v_mfma_f32_32x32x16_bf16 v[48:63], v[160:163], a[176:179], v[48:63]
  v_mul_f32 v33, v33, v173
  v_cvt_pk_bf16_f32 v188, v32, v33
  v_mfma_f32_32x32x16_bf16 v[64:79], v[160:163], a[180:183], v[64:79]
  v_mul_f32 v174, v34, v34
  v_mul_f32 v175, v35, v35
  v_fma_f32 v174, v174, v180, v179
  ds_read_b128 v[160:163], v3 offset:8192
  s_waitcnt lgkmcnt(5)
  v_mfma_f32_32x32x16_bf16 v[48:63], v[164:167], a[184:187], v[48:63]
  v_fma_f32 v175, v175, v180, v179
  v_mul_f32 v174, v174, v34
  v_mfma_f32_32x32x16_bf16 v[64:79], v[164:167], a[188:191], v[64:79]
  v_mul_f32 v175, v175, v35
  v_exp_f32 v174, v174
  ds_read_b128 v[164:167], v3 offset:9216
  s_waitcnt lgkmcnt(5)
  v_mfma_f32_32x32x16_bf16 v[48:63], v[144:147], a[192:195], v[48:63]
  buffer_load_dwordx4 v1, s[4:7], s48 offen offset:3072 sc1 lds
  s_add_u32 s48, s48, 4096
  s_add_u32 m0, m0, 4096
  v_exp_f32 v175, v175
  v_mul_f32 v34, v34, v42
  v_mfma_f32_32x32x16_bf16 v[64:79], v[144:147], a[196:199], v[64:79]
  v_mul_f32 v35, v35, v43
  v_fma_f32 v174, v174, v181, v181
  ds_read_b128 v[144:147], v3 offset:10240
  s_waitcnt lgkmcnt(5)
  v_mfma_f32_32x32x16_bf16 v[48:63], v[148:151], a[200:203], v[48:63]
  v_fma_f32 v175, v175, v181, v181
  v_rcp_f32 v174, v174
  v_mfma_f32_32x32x16_bf16 v[64:79], v[148:151], a[204:207], v[64:79]
  v_rcp_f32 v175, v175
  v_mul_f32 v34, v34, v174
  ds_read_b128 v[148:151], v3 offset:11264
  s_waitcnt lgkmcnt(5)
  v_mfma_f32_32x32x16_bf16 v[48:63], v[152:155], a[208:211], v[48:63]
  v_mul_f32 v35, v35, v175
  v_cvt_pk_bf16_f32 v189, v34, v35
  v_mfma_f32_32x32x16_bf16 v[64:79], v[152:155], a[212:215], v[64:79]
  v_mul_f32 v172, v36, v36
  v_mul_f32 v173, v37, v37
  v_fma_f32 v172, v172, v180, v179
  ds_read_b128 v[152:155], v3 offset:12288
  s_waitcnt lgkmcnt(5)
  v_mfma_f32_32x32x16_bf16 v[48:63], v[156:159], a[216:219], v[48:63]
  buffer_load_dwordx4 v1, s[4:7], s48 offen offset:0 sc1 lds
  v_fma_f32 v173, v173, v180, v179
  v_mul_f32 v172, v172, v36
  v_mfma_f32_32x32x16_bf16 v[64:79], v[156:159], a[220:223], v[64:79]
  v_mul_f32 v173, v173, v37
  v_exp_f32 v172, v172
  ds_read_b128 v[156:159], v3 offset:13312
  s_waitcnt lgkmcnt(5)
  v_mfma_f32_32x32x16_bf16 v[48:63], v[160:163], a[224:227], v[48:63]
  v_exp_f32 v173, v173
  v_mul_f32 v36, v36, v44
  v_mfma_f32_32x32x16_bf16 v[64:79], v[160:163], a[228:231], v[64:79]
  v_mul_f32 v37, v37, v45
  v_fma_f32 v172, v172, v181, v181
  ds_read_b128 v[160:163], v3 offset:14336
  s_waitcnt lgkmcnt(5)
  v_mfma_f32_32x32x16_bf16 v[48:63], v[164:167], a[232:235], v[48:63]
  v_fma_f32 v173, v173, v181, v181
  v_rcp_f32 v172, v172
  v_mfma_f32_32x32x16_bf16 v[64:79], v[164:167], a[236:239], v[64:79]
  v_rcp_f32 v173, v173
  v_mul_f32 v36, v36, v172
  ds_read_b128 v[164:167], v3 offset:15360
  s_waitcnt lgkmcnt(5)
  v_mfma_f32_32x32x16_bf16 v[48:63], v[144:147], a[240:243], v[48:63]
  v_mul_f32 v37, v37, v173
  v_cvt_pk_bf16_f32 v190, v36, v37
  v_mfma_f32_32x32x16_bf16 v[64:79], v[144:147], a[244:247], v[64:79]
  v_mul_f32 v174, v38, v38
  v_mul_f32 v175, v39, v39
  v_fma_f32 v174, v174, v180, v179
  ds_read_b128 v[168:171], v3 offset:21504
  s_waitcnt lgkmcnt(5)
  v_mfma_f32_32x32x16_bf16 v[48:63], v[148:151], a[248:251], v[48:63]
  v_fma_f32 v175, v175, v180, v179
  v_mul_f32 v174, v174, v38
  v_mfma_f32_32x32x16_bf16 v[64:79], v[148:151], a[252:255], v[64:79]
  v_mul_f32 v175, v175, v39
  v_exp_f32 v174, v174
  s_waitcnt vmcnt(12)
  s_barrier
  ds_read_b128 v[144:147], v1 offset:36864
  s_waitcnt lgkmcnt(5)
  v_mfma_f32_32x32x16_bf16 v[48:63], v[152:155], v[224:227], v[48:63]
  v_exp_f32 v175, v175
  v_mul_f32 v38, v38, v46
  v_mfma_f32_32x32x16_bf16 v[64:79], v[152:155], v[228:231], v[64:79]
  v_mul_f32 v39, v39, v47
  v_fma_f32 v174, v174, v181, v181
  ds_read_b128 v[148:151], v1 offset:37888
  s_waitcnt lgkmcnt(5)
  v_mfma_f32_32x32x16_bf16 v[48:63], v[156:159], v[232:235], v[48:63]
  v_fma_f32 v175, v175, v181, v181
  v_rcp_f32 v174, v174
  v_mfma_f32_32x32x16_bf16 v[64:79], v[156:159], v[236:239], v[64:79]
  v_rcp_f32 v175, v175
  v_mul_f32 v38, v38, v174
  ds_read_b128 v[152:155], v1 offset:38912
  s_waitcnt lgkmcnt(5)
  v_mfma_f32_32x32x16_bf16 v[48:63], v[160:163], v[240:243], v[48:63]
  v_mul_f32 v39, v39, v175
  v_cvt_pk_bf16_f32 v191, v38, v39
  v_mfma_f32_32x32x16_bf16 v[64:79], v[160:163], v[244:247], v[64:79]
  buffer_store_dwordx4 v[188:191], v1, s[4:7], s45 offen sc1
  s_add_u32 s45, s45, 1024
  ds_read_b128 v[156:159], v1 offset:39936
  s_waitcnt lgkmcnt(5)
  v_mfma_f32_32x32x16_bf16 v[48:63], v[164:167], v[248:251], v[48:63]
  v_mfma_f32_32x32x16_bf16 v[64:79], v[164:167], v[252:255], v[64:79]
  ds_read_b128 v[160:163], v1 offset:40960
  s_waitcnt lgkmcnt(5)
  v_mfma_f32_32x32x16_bf16 v[48:63], v[168:171], v[216:219], v[48:63]
  v_mfma_f32_32x32x16_bf16 v[64:79], v[168:171], v[220:223], v[64:79]
  ds_read_b128 v[164:167], v1 offset:41984
  s_waitcnt lgkmcnt(5)
  v_mfma_f32_32x32x16_bf16 v[16:31], v[144:147], a[0:3], 0
  s_add_u32 s48, s40, 294912
  s_add_u32 m0, s41, 73728
  v_mfma_f32_32x32x16_bf16 v[32:47], v[144:147], a[4:7], 0
  ds_read_b128 v[144:147], v1 offset:43008
  s_waitcnt lgkmcnt(5)
  v_mfma_f32_32x32x16_bf16 v[16:31], v[148:151], a[8:11], v[16:31]
  v_mfma_f32_32x32x16_bf16 v[32:47], v[148:151], a[12:15], v[32:47]
  ds_read_b128 v[148:151], v1 offset:44032
  s_waitcnt lgkmcnt(5)
  v_mfma_f32_32x32x16_bf16 v[16:31], v[152:155], a[16:19], v[16:31]
  v_mul_f32 v172, v48, v48
  v_mul_f32 v173, v49, v49
  v_fma_f32 v172, v172, v177, v176
  v_mfma_f32_32x32x16_bf16 v[32:47], v[152:155], a[20:23], v[32:47]
  v_fma_f32 v173, v173, v177, v176
  v_mul_f32 v172, v172, v48
  ds_read_b128 v[152:155], v1 offset:45056
  s_waitcnt lgkmcnt(5)
  v_mfma_f32_32x32x16_bf16 v[16:31], v[156:159], a[24:27], v[16:31]
  buffer_load_dwordx4 v1, s[4:7], s48 offen offset:0 sc1 lds
  v_mul_f32 v173, v173, v49
  v_exp_f32 v172, v172
  v_mfma_f32_32x32x16_bf16 v[32:47], v[156:159], a[28:31], v[32:47]
  v_exp_f32 v173, v173
  v_mul_f32 v48, v48, v56
  ds_read_b128 v[156:159], v1 offset:46080
  s_waitcnt lgkmcnt(5)
  v_mfma_f32_32x32x16_bf16 v[16:31], v[160:163], a[32:35], v[16:31]
  v_mul_f32 v49, v49, v57
  v_fma_f32 v172, v172, v178, v178
  v_mfma_f32_32x32x16_bf16 v[32:47], v[160:163], a[36:39], v[32:47]
  v_fma_f32 v173, v173, v178, v178
  v_rcp_f32 v172, v172
  ds_read_b128 v[160:163], v1 offset:47104
  s_waitcnt lgkmcnt(5)
  v_mfma_f32_32x32x16_bf16 v[16:31], v[164:167], a[40:43], v[16:31]
  v_rcp_f32 v173, v173
  v_mul_f32 v48, v48, v172
  v_mfma_f32_32x32x16_bf16 v[32:47], v[164:167], a[44:47], v[32:47]
  v_mul_f32 v49, v49, v173
  v_cvt_pk_bf16_f32 v184, v48, v49
  ds_read_b128 v[164:167], v1 offset:48128
  s_waitcnt lgkmcnt(5)
  v_mfma_f32_32x32x16_bf16 v[16:31], v[144:147], a[48:51], v[16:31]
  buffer_load_dwordx4 v1, s[4:7], s48 offen offset:1024 sc1 lds
  v_mul_f32 v174, v50, v50
  v_mul_f32 v175, v51, v51
  v_fma_f32 v174, v174, v177, v176
  v_mfma_f32_32x32x16_bf16 v[32:47], v[144:147], a[52:55], v[32:47]
  v_fma_f32 v175, v175, v177, v176
  v_mul_f32 v174, v174, v50
  ds_read_b128 v[144:147], v1 offset:49152
  s_waitcnt lgkmcnt(5)
  v_mfma_f32_32x32x16_bf16 v[16:31], v[148:151], a[56:59], v[16:31]
  v_mul_f32 v175, v175, v51
  v_exp_f32 v174, v174
  v_mfma_f32_32x32x16_bf16 v[32:47], v[148:151], a[60:63], v[32:47]
  v_exp_f32 v175, v175
  v_mul_f32 v50, v50, v58
  ds_read_b128 v[148:151], v1 offset:50176
  s_waitcnt lgkmcnt(5)
  v_mfma_f32_32x32x16_bf16 v[16:31], v[152:155], a[64:67], v[16:31]
  v_mul_f32 v51, v51, v59
  v_fma_f32 v174, v174, v178, v178
  v_mfma_f32_32x32x16_bf16 v[32:47], v[152:155], a[68:71], v[32:47]
  v_fma_f32 v175, v175, v178, v178
  v_rcp_f32 v174, v174
  ds_read_b128 v[152:155], v1 offset:51200
  s_waitcnt lgkmcnt(5)
  v_mfma_f32_32x32x16_bf16 v[16:31], v[156:159], a[72:75], v[16:31]
  buffer_load_dwordx4 v1, s[4:7], s48 offen offset:2048 sc1 lds
  v_rcp_f32 v175, v175
  v_mul_f32 v50, v50, v174
  v_mfma_f32_32x32x16_bf16 v[32:47], v[156:159], a[76:79], v[32:47]
  v_mul_f32 v51, v51, v175
  v_cvt_pk_bf16_f32 v185, v50, v51
  ds_read_b128 v[156:159], v1 offset:52224
  s_waitcnt lgkmcnt(5)
  v_mfma_f32_32x32x16_bf16 v[16:31], v[160:163], a[80:83], v[16:31]
  v_mul_f32 v172, v52, v52
  v_mul_f32 v173, v53, v53
  v_fma_f32 v172, v172, v177, v176
  v_mfma_f32_32x32x16_bf16 v[32:47], v[160:163], a[84:87], v[32:47]
  v_fma_f32 v173, v173, v177, v176
  v_mul_f32 v172, v172, v52
  ds_read_b128 v[160:163], v1 offset:53248
  s_waitcnt lgkmcnt(5)
  v_mfma_f32_32x32x16_bf16 v[16:31], v[164:167], a[88:91], v[16:31]
  v_mul_f32 v173, v173, v53
  v_exp_f32 v172, v172
  v_mfma_f32_32x32x16_bf16 v[32:47], v[164:167], a[92:95], v[32:47]
  v_exp_f32 v173, v173
  v_mul_f32 v52, v52, v60
  ds_read_b128 v[164:167], v1 offset:54272
  s_waitcnt lgkmcnt(5)
  v_mfma_f32_32x32x16_bf16 v[16:31], v[144:147], a[96:99], v[16:31]
  buffer_load_dwordx4 v1, s[4:7], s48 offen offset:3072 sc1 lds
  s_add_u32 s48, s48, 4096
  s_add_u32 m0, m0, 4096
  v_mul_f32 v53, v53, v61
  v_fma_f32 v172, v172, v178, v178
  v_mfma_f32_32x32x16_bf16 v[32:47], v[144:147], a[100:103], v[32:47]
  v_fma_f32 v173, v173, v178, v178
  v_rcp_f32 v172, v172
  ds_read_b128 v[144:147], v1 offset:55296
  s_waitcnt lgkmcnt(5)
  v_mfma_f32_32x32x16_bf16 v[16:31], v[148:151], a[104:107], v[16:31]
  v_rcp_f32 v173, v173
  v_mul_f32 v52, v52, v172
  v_mfma_f32_32x32x16_bf16 v[32:47], v[148:151], a[108:111], v[32:47]
  v_mul_f32 v53, v53, v173
  v_cvt_pk_bf16_f32 v186, v52, v53
  ds_read_b128 v[148:151], v1 offset:56320
  s_waitcnt lgkmcnt(5)
  v_mfma_f32_32x32x16_bf16 v[16:31], v[152:155], a[112:115], v[16:31]
  v_mul_f32 v174, v54, v54
  v_mul_f32 v175, v55, v55
  v_fma_f32 v174, v174, v177, v176
  v_mfma_f32_32x32x16_bf16 v[32:47], v[152:155], a[116:119], v[32:47]
  v_fma_f32 v175, v175, v177, v176
  v_mul_f32 v174, v174, v54
  ds_read_b128 v[152:155], v1 offset:57344
  s_waitcnt lgkmcnt(5)
  v_mfma_f32_32x32x16_bf16 v[16:31], v[156:159], a[120:123], v[16:31]
  buffer_load_dwordx4 v1, s[4:7], s48 offen offset:0 sc1 lds
  v_mul_f32 v175, v175, v55
  v_exp_f32 v174, v174
  v_mfma_f32_32x32x16_bf16 v[32:47], v[156:159], a[124:127], v[32:47]
  v_exp_f32 v175, v175
  v_mul_f32 v54, v54, v62
  ds_read_b128 v[156:159], v1 offset:58368
  s_waitcnt lgkmcnt(5)
  v_mfma_f32_32x32x16_bf16 v[16:31], v[160:163], a[128:131], v[16:31]
  v_mul_f32 v55, v55, v63
  v_fma_f32 v174, v174, v178, v178
  v_mfma_f32_32x32x16_bf16 v[32:47], v[160:163], a[132:135], v[32:47]
  v_fma_f32 v175, v175, v178, v178
  v_rcp_f32 v174, v174
  ds_read_b128 v[160:163], v1 offset:59392
  s_waitcnt lgkmcnt(5)
  v_mfma_f32_32x32x16_bf16 v[16:31], v[164:167], a[136:139], v[16:31]
  v_rcp_f32 v175, v175
  v_mul_f32 v54, v54, v174
  v_mfma_f32_32x32x16_bf16 v[32:47], v[164:167], a[140:143], v[32:47]
  v_mul_f32 v55, v55, v175
  v_cvt_pk_bf16_f32 v187, v54, v55
  ds_read_b128 v[164:167], v1 offset:60416
  s_waitcnt lgkmcnt(5)
  v_mfma_f32_32x32x16_bf16 v[16:31], v[144:147], a[144:147], v[16:31]
  buffer_load_dwordx4 v1, s[4:7], s48 offen offset:1024 sc1 lds
  buffer_store_dwordx4 v[184:187], v1, s[4:7], s44 offen sc1
  s_add_u32 s44, s44, 1024
  v_mfma_f32_32x32x16_bf16 v[32:47], v[144:147], a[148:151], v[32:47]
  v_mul_f32 v172, v64, v64
  v_mul_f32 v173, v65, v65
  v_fma_f32 v172, v172, v180, v179
  ds_read_b128 v[144:147], v1 offset:61440
  s_waitcnt lgkmcnt(5)
  v_mfma_f32_32x32x16_bf16 v[16:31], v[148:151], a[152:155], v[16:31]
  v_fma_f32 v173, v173, v180, v179
  v_mul_f32 v172, v172, v64
  v_mfma_f32_32x32x16_bf16 v[32:47], v[148:151], a[156:159], v[32:47]
  v_mul_f32 v173, v173, v65
  v_exp_f32 v172, v172
  ds_read_b128 v[148:151], v1 offset:62464
  s_waitcnt lgkmcnt(5)
  v_mfma_f32_32x32x16_bf16 v[16:31], v[152:155], a[160:163], v[16:31]
  v_exp_f32 v173, v173
  v_mul_f32 v64, v64, v72
  v_mfma_f32_32x32x16_bf16 v[32:47], v[152:155], a[164:167], v[32:47]
  v_mul_f32 v65, v65, v73
  v_fma_f32 v172, v172, v181, v181
  ds_read_b128 v[152:155], v1 offset:63488
  s_waitcnt lgkmcnt(5)
  v_mfma_f32_32x32x16_bf16 v[16:31], v[156:159], a[168:171], v[16:31]
  buffer_load_dwordx4 v1, s[4:7], s48 offen offset:2048 sc1 lds
  v_fma_f32 v173, v173, v181, v181
  v_rcp_f32 v172, v172
  v_mfma_f32_32x32x16_bf16 v[32:47], v[156:159], a[172:175], v[32:47]
  v_rcp_f32 v173, v173
  v_mul_f32 v64, v64, v172
  ds_read_b128 v[156:159], v1 offset:64512
  s_waitcnt lgkmcnt(5)
  v_mfma_f32_32x32x16_bf16 v[16:31], v[160:163], a[176:179], v[16:31]
  v_mul_f32 v65, v65, v173
  v_cvt_pk_bf16_f32 v188, v64, v65
  v_mfma_f32_32x32x16_bf16 v[32:47], v[160:163], a[180:183], v[32:47]
  v_mul_f32 v174, v66, v66
  v_mul_f32 v175, v67, v67
  v_fma_f32 v174, v174, v180, v179
  ds_read_b128 v[160:163], v2 offset:0
  s_waitcnt lgkmcnt(5)
  v_mfma_f32_32x32x16_bf16 v[16:31], v[164:167], a[184:187], v[16:31]
  v_fma_f32 v175, v175, v180, v179
  v_mul_f32 v174, v174, v66
  v_mfma_f32_32x32x16_bf16 v[32:47], v[164:167], a[188:191], v[32:47]
  v_mul_f32 v175, v175, v67
  v_exp_f32 v174, v174
  ds_read_b128 v[164:167], v2 offset:1024
  s_waitcnt lgkmcnt(5)
  v_mfma_f32_32x32x16_bf16 v[16:31], v[144:147], a[192:195], v[16:31]
  buffer_load_dwordx4 v1, s[4:7], s48 offen offset:3072 sc1 lds
  s_add_u32 s48, s48, 4096
  s_add_u32 m0, m0, 4096
  v_exp_f32 v175, v175
  v_mul_f32 v66, v66, v74
  v_mfma_f32_32x32x16_bf16 v[32:47], v[144:147], a[196:199], v[32:47]
  v_mul_f32 v67, v67, v75
  v_fma_f32 v174, v174, v181, v181
  ds_read_b128 v[144:147], v2 offset:2048
  s_waitcnt lgkmcnt(5)
  v_mfma_f32_32x32x16_bf16 v[16:31], v[148:151], a[200:203], v[16:31]
  v_fma_f32 v175, v175, v181, v181
  v_rcp_f32 v174, v174
  v_mfma_f32_32x32x16_bf16 v[32:47], v[148:151], a[204:207], v[32:47]
  v_rcp_f32 v175, v175
  v_mul_f32 v66, v66, v174
  ds_read_b128 v[148:151], v2 offset:3072
  s_waitcnt lgkmcnt(5)
  v_mfma_f32_32x32x16_bf16 v[16:31], v[152:155], a[208:211], v[16:31]
  v_mul_f32 v67, v67, v175
  v_cvt_pk_bf16_f32 v189, v66, v67
  v_mfma_f32_32x32x16_bf16 v[32:47], v[152:155], a[212:215], v[32:47]
  v_mul_f32 v172, v68, v68
  v_mul_f32 v173, v69, v69
  v_fma_f32 v172, v172, v180, v179
  ds_read_b128 v[152:155], v2 offset:4096
  s_waitcnt lgkmcnt(5)
  v_mfma_f32_32x32x16_bf16 v[16:31], v[156:159], a[216:219], v[16:31]
  buffer_load_dwordx4 v1, s[4:7], s48 offen offset:0 sc1 lds
  v_fma_f32 v173, v173, v180, v179
  v_mul_f32 v172, v172, v68
  v_mfma_f32_32x32x16_bf16 v[32:47], v[156:159], a[220:223], v[32:47]
  v_mul_f32 v173, v173, v69
  v_exp_f32 v172, v172
  ds_read_b128 v[156:159], v2 offset:5120
  s_waitcnt lgkmcnt(5)
  v_mfma_f32_32x32x16_bf16 v[16:31], v[160:163], a[224:227], v[16:31]
  v_exp_f32 v173, v173
  v_mul_f32 v68, v68, v76
  v_mfma_f32_32x32x16_bf16 v[32:47], v[160:163], a[228:231], v[32:47]
  v_mul_f32 v69, v69, v77
  v_fma_f32 v172, v172, v181, v181
  ds_read_b128 v[160:163], v2 offset:6144
  s_waitcnt lgkmcnt(5)
  v_mfma_f32_32x32x16_bf16 v[16:31], v[164:167], a[232:235], v[16:31]
  v_fma_f32 v173, v173, v181, v181
  v_rcp_f32 v172, v172
  v_mfma_f32_32x32x16_bf16 v[32:47], v[164:167], a[236:239], v[32:47]
  v_rcp_f32 v173, v173
  v_mul_f32 v68, v68, v172
  ds_read_b128 v[164:167], v2 offset:7168
  s_waitcnt lgkmcnt(5)
  v_mfma_f32_32x32x16_bf16 v[16:31], v[144:147], a[240:243], v[16:31]
  v_mul_f32 v69, v69, v173
  v_cvt_pk_bf16_f32 v190, v68, v69
  v_mfma_f32_32x32x16_bf16 v[32:47], v[144:147], a[244:247], v[32:47]
  v_mul_f32 v174, v70, v70
  v_mul_f32 v175, v71, v71
  v_fma_f32 v174, v174, v180, v179
  ds_read_b128 v[168:171], v3 offset:22528
  s_waitcnt lgkmcnt(5)
  v_mfma_f32_32x32x16_bf16 v[16:31], v[148:151], a[248:251], v[16:31]
  v_fma_f32 v175, v175, v180, v179
  v_mul_f32 v174, v174, v70
  v_mfma_f32_32x32x16_bf16 v[32:47], v[148:151], a[252:255], v[32:47]
  v_mul_f32 v175, v175, v71
  v_exp_f32 v174, v174
  s_waitcnt vmcnt(11)
  s_barrier
  ds_read_b128 v[144:147], v1 offset:0
  s_waitcnt lgkmcnt(5)
  v_mfma_f32_32x32x16_bf16 v[16:31], v[152:155], v[224:227], v[16:31]
  v_exp_f32 v175, v175
  v_mul_f32 v70, v70, v78
  v_mfma_f32_32x32x16_bf16 v[32:47], v[152:155], v[228:231], v[32:47]
  v_mul_f32 v71, v71, v79
  v_fma_f32 v174, v174, v181, v181
  ds_read_b128 v[148:151], v1 offset:1024
  s_waitcnt lgkmcnt(5)
  v_mfma_f32_32x32x16_bf16 v[16:31], v[156:159], v[232:235], v[16:31]
  v_fma_f32 v175, v175, v181, v181
  v_rcp_f32 v174, v174
  v_mfma_f32_32x32x16_bf16 v[32:47], v[156:159], v[236:239], v[32:47]
  v_rcp_f32 v175, v175
  v_mul_f32 v70, v70, v174
  ds_read_b128 v[152:155], v1 offset:2048
  s_waitcnt lgkmcnt(5)
  v_mfma_f32_32x32x16_bf16 v[16:31], v[160:163], v[240:243], v[16:31]
  v_mul_f32 v71, v71, v175
  v_cvt_pk_bf16_f32 v191, v70, v71
  v_mfma_f32_32x32x16_bf16 v[32:47], v[160:163], v[244:247], v[32:47]
  buffer_store_dwordx4 v[188:191], v1, s[4:7], s45 offen sc1
  s_add_u32 s45, s45, 1024
  ds_read_b128 v[156:159], v1 offset:3072
  s_waitcnt lgkmcnt(5)
  v_mfma_f32_32x32x16_bf16 v[16:31], v[164:167], v[248:251], v[16:31]
  v_mfma_f32_32x32x16_bf16 v[32:47], v[164:167], v[252:255], v[32:47]
  ds_read_b128 v[160:163], v1 offset:4096
  s_waitcnt lgkmcnt(5)
  v_mfma_f32_32x32x16_bf16 v[16:31], v[168:171], v[216:219], v[16:31]
  v_mfma_f32_32x32x16_bf16 v[32:47], v[168:171], v[220:223], v[32:47]
  s_and_b32 s38, s36, 1
  s_lshl_b32 s38, s38, 3
  s_and_b32 s39, s37, 7
  s_add_u32 s38, s38, s39
  s_lshr_b32 s39, s37, 3
  s_lshr_b32 s57, s36, 1
  s_lshl_b32 s52, s38, 2
  s_add_u32 s52, s52, s3
  s_mul_i32 s54, s52, 294912
  s_mul_i32 s46, s57, 73728
  s_add_u32 s54, s54, s46
  s_add_u32 s54, s54, 8093696
  s_add_u32 s54, s54, s50
  v_and_b32 v8, 15, v0
  v_lshrrev_b32 v15, 4, v0
  v_lshlrev_b32 v4, 4, v8
  v_lshl_add_u32 v4, v15, 9, v4
  s_lshr_b32 s59, s52, 1
  s_lshl_b32 s59, s59, 2
  s_add_u32 s59, s59, s57
  s_lshl_b32 s59, s59, 7
  s_add_u32 s59, s59, 5210112
  s_add_u32 s59, s59, s50
  v_mov_b32 v192, s59
  s_movk_i32 s58, 0x4000
  ds_read_b128 v[164:167], v1 offset:5120
  s_waitcnt lgkmcnt(5)
  v_mfma_f32_32x32x16_bf16 v[48:63], v[144:147], a[0:3], 0
  s_add_u32 s48, s61, 0
  s_add_u32 m0, s41, 110592
  v_mfma_f32_32x32x16_bf16 v[64:79], v[144:147], a[4:7], 0
  ds_read_b128 v[144:147], v1 offset:6144
  s_waitcnt lgkmcnt(5)
  v_mfma_f32_32x32x16_bf16 v[48:63], v[148:151], a[8:11], v[48:63]
  v_mfma_f32_32x32x16_bf16 v[64:79], v[148:151], a[12:15], v[64:79]
  buffer_load_dwordx4 v1, s[4:7], s48 offen offset:0 sc1 lds
  ds_read_b128 v[148:151], v1 offset:7168
  s_waitcnt lgkmcnt(5)
  v_mfma_f32_32x32x16_bf16 v[48:63], v[152:155], a[16:19], v[48:63]
  v_mul_f32 v172, v16, v16
  v_mul_f32 v173, v17, v17
  v_fma_f32 v172, v172, v177, v176
  v_mfma_f32_32x32x16_bf16 v[64:79], v[152:155], a[20:23], v[64:79]
  v_fma_f32 v173, v173, v177, v176
  v_mul_f32 v172, v172, v16
  ds_read_b128 v[152:155], v1 offset:8192
  s_waitcnt lgkmcnt(5)
  v_mfma_f32_32x32x16_bf16 v[48:63], v[156:159], a[24:27], v[48:63]
  buffer_load_dwordx4 v1, s[4:7], s48 offen offset:1024 sc1 lds
  v_mul_f32 v173, v173, v17
  v_exp_f32 v172, v172
  v_mfma_f32_32x32x16_bf16 v[64:79], v[156:159], a[28:31], v[64:79]
  v_exp_f32 v173, v173
  v_mul_f32 v16, v16, v24
  ds_read_b128 v[156:159], v1 offset:9216
  s_waitcnt lgkmcnt(5)
  v_mfma_f32_32x32x16_bf16 v[48:63], v[160:163], a[32:35], v[48:63]
  v_mul_f32 v17, v17, v25
  v_fma_f32 v172, v172, v178, v178
  v_mfma_f32_32x32x16_bf16 v[64:79], v[160:163], a[36:39], v[64:79]
  buffer_load_dwordx4 v1, s[4:7], s48 offen offset:2048 sc1 lds
  v_fma_f32 v173, v173, v178, v178
  v_rcp_f32 v172, v172
  ds_read_b128 v[160:163], v1 offset:10240
  s_waitcnt lgkmcnt(5)
  v_mfma_f32_32x32x16_bf16 v[48:63], v[164:167], a[40:43], v[48:63]
  v_rcp_f32 v173, v173
  v_mul_f32 v16, v16, v172
  v_mfma_f32_32x32x16_bf16 v[64:79], v[164:167], a[44:47], v[64:79]
  v_mul_f32 v17, v17, v173
  v_cvt_pk_bf16_f32 v184, v16, v17
  ds_read_b128 v[164:167], v1 offset:11264
  s_waitcnt lgkmcnt(5)
  v_mfma_f32_32x32x16_bf16 v[48:63], v[144:147], a[48:51], v[48:63]
  buffer_load_dwordx4 v1, s[4:7], s48 offen offset:3072 sc1 lds
  s_add_u32 s48, s48, 4096
  s_add_u32 m0, m0, 4096
  s_barrier
  v_mul_f32 v174, v18, v18
  v_mul_f32 v175, v19, v19
  v_fma_f32 v174, v174, v177, v176
  v_mfma_f32_32x32x16_bf16 v[64:79], v[144:147], a[52:55], v[64:79]
  v_fma_f32 v175, v175, v177, v176
  v_mul_f32 v174, v174, v18
  ds_read_b128 v[144:147], v1 offset:12288
  s_waitcnt lgkmcnt(5)
  v_mfma_f32_32x32x16_bf16 v[48:63], v[148:151], a[56:59], v[48:63]
  v_mul_f32 v175, v175, v19
  v_exp_f32 v174, v174
  v_mfma_f32_32x32x16_bf16 v[64:79], v[148:151], a[60:63], v[64:79]
  buffer_load_dwordx4 v1, s[4:7], s48 offen offset:0 sc1 lds
  v_exp_f32 v175, v175
  v_mul_f32 v18, v18, v26
  ds_read_b128 v[148:151], v1 offset:13312
  s_waitcnt lgkmcnt(5)
  v_mfma_f32_32x32x16_bf16 v[48:63], v[152:155], a[64:67], v[48:63]
  s_waitcnt vmcnt(5)
  buffer_atomic_add v10, v9, s[4:7], 0 offen
  v_mul_f32 v19, v19, v27
  v_fma_f32 v174, v174, v178, v178
  v_mfma_f32_32x32x16_bf16 v[64:79], v[152:155], a[68:71], v[64:79]
  v_fma_f32 v175, v175, v178, v178
  v_rcp_f32 v174, v174
  ds_read_b128 v[152:155], v1 offset:14336
  s_waitcnt lgkmcnt(5)
  v_mfma_f32_32x32x16_bf16 v[48:63], v[156:159], a[72:75], v[48:63]
  buffer_load_dwordx4 v1, s[4:7], s48 offen offset:1024 sc1 lds
  v_rcp_f32 v175, v175
  v_mul_f32 v18, v18, v174
  v_mfma_f32_32x32x16_bf16 v[64:79], v[156:159], a[76:79], v[64:79]
  v_mul_f32 v19, v19, v175
  v_cvt_pk_bf16_f32 v185, v18, v19
  ds_read_b128 v[156:159], v1 offset:15360
  s_waitcnt lgkmcnt(5)
  v_mfma_f32_32x32x16_bf16 v[48:63], v[160:163], a[80:83], v[48:63]
  v_mul_f32 v172, v20, v20
  v_mul_f32 v173, v21, v21
  v_fma_f32 v172, v172, v177, v176
  v_mfma_f32_32x32x16_bf16 v[64:79], v[160:163], a[84:87], v[64:79]
  buffer_load_dwordx4 v1, s[4:7], s48 offen offset:2048 sc1 lds
  v_fma_f32 v173, v173, v177, v176
  v_mul_f32 v172, v172, v20
  ds_read_b128 v[160:163], v1 offset:16384
  s_waitcnt lgkmcnt(5)
  v_mfma_f32_32x32x16_bf16 v[48:63], v[164:167], a[88:91], v[48:63]
  v_mul_f32 v173, v173, v21
  v_exp_f32 v172, v172
  v_mfma_f32_32x32x16_bf16 v[64:79], v[164:167], a[92:95], v[64:79]
  v_exp_f32 v173, v173
  v_mul_f32 v20, v20, v28
  ds_read_b128 v[164:167], v1 offset:17408
  s_waitcnt lgkmcnt(5)
  v_mfma_f32_32x32x16_bf16 v[48:63], v[144:147], a[96:99], v[48:63]
  buffer_load_dwordx4 v1, s[4:7], s48 offen offset:3072 sc1 lds
  s_add_u32 s48, s48, 4096
  s_add_u32 m0, m0, 4096
  v_mul_f32 v21, v21, v29
  v_fma_f32 v172, v172, v178, v178
  v_mfma_f32_32x32x16_bf16 v[64:79], v[144:147], a[100:103], v[64:79]
  v_fma_f32 v173, v173, v178, v178
  v_rcp_f32 v172, v172
  ds_read_b128 v[144:147], v1 offset:18432
  s_waitcnt lgkmcnt(5)
  v_mfma_f32_32x32x16_bf16 v[48:63], v[148:151], a[104:107], v[48:63]
  v_rcp_f32 v173, v173
  v_mul_f32 v20, v20, v172
  v_mfma_f32_32x32x16_bf16 v[64:79], v[148:151], a[108:111], v[64:79]
  buffer_load_dwordx4 v1, s[4:7], s48 offen offset:0 sc1 lds
  v_mul_f32 v21, v21, v173
  v_cvt_pk_bf16_f32 v186, v20, v21
  ds_read_b128 v[148:151], v1 offset:19456
  s_waitcnt lgkmcnt(5)
  v_mfma_f32_32x32x16_bf16 v[48:63], v[152:155], a[112:115], v[48:63]
  v_mul_f32 v174, v22, v22
  v_mul_f32 v175, v23, v23
  v_fma_f32 v174, v174, v177, v176
  v_mfma_f32_32x32x16_bf16 v[64:79], v[152:155], a[116:119], v[64:79]
  v_fma_f32 v175, v175, v177, v176
  v_mul_f32 v174, v174, v22
  ds_read_b128 v[152:155], v1 offset:20480
  s_waitcnt lgkmcnt(5)
  v_mfma_f32_32x32x16_bf16 v[48:63], v[156:159], a[120:123], v[48:63]
  s_add_u32 s48, s61, 36864
  s_add_u32 m0, s41, 36864
  v_mul_f32 v175, v175, v23
  v_exp_f32 v174, v174
  v_mfma_f32_32x32x16_bf16 v[64:79], v[156:159], a[124:127], v[64:79]
  v_exp_f32 v175, v175
  v_mul_f32 v22, v22, v30
  ds_read_b128 v[156:159], v1 offset:21504
  s_waitcnt lgkmcnt(5)
  v_mfma_f32_32x32x16_bf16 v[48:63], v[160:163], a[128:131], v[48:63]
  v_mul_f32 v23, v23, v31
  v_fma_f32 v174, v174, v178, v178
  v_mfma_f32_32x32x16_bf16 v[64:79], v[160:163], a[132:135], v[64:79]
  buffer_load_dwordx4 v1, s[4:7], s48 offen offset:0 sc1 lds
  v_fma_f32 v175, v175, v178, v178
  v_rcp_f32 v174, v174
  ds_read_b128 v[160:163], v1 offset:22528
  s_waitcnt lgkmcnt(5)
  v_mfma_f32_32x32x16_bf16 v[48:63], v[164:167], a[136:139], v[48:63]
  v_rcp_f32 v175, v175
  v_mul_f32 v22, v22, v174
  v_mfma_f32_32x32x16_bf16 v[64:79], v[164:167], a[140:143], v[64:79]
  v_mul_f32 v23, v23, v175
  v_cvt_pk_bf16_f32 v187, v22, v23
  ds_read_b128 v[164:167], v1 offset:23552
  s_waitcnt lgkmcnt(5)
  v_mfma_f32_32x32x16_bf16 v[48:63], v[144:147], a[144:147], v[48:63]
  buffer_load_dwordx4 v1, s[4:7], s48 offen offset:1024 sc1 lds
  buffer_store_dwordx4 v[184:187], v1, s[4:7], s44 offen sc1
  s_add_u32 s44, s44, 1024
  v_mfma_f32_32x32x16_bf16 v[64:79], v[144:147], a[148:151], v[64:79]
  v_mul_f32 v172, v32, v32
  v_mul_f32 v173, v33, v33
  v_fma_f32 v172, v172, v180, v179
  ds_read_b128 v[144:147], v1 offset:24576
  s_waitcnt lgkmcnt(5)
  v_mfma_f32_32x32x16_bf16 v[48:63], v[148:151], a[152:155], v[48:63]
  v_fma_f32 v173, v173, v180, v179
  v_mul_f32 v172, v172, v32
  v_mfma_f32_32x32x16_bf16 v[64:79], v[148:151], a[156:159], v[64:79]
  buffer_load_dwordx4 v1, s[4:7], s48 offen offset:2048 sc1 lds
  v_mul_f32 v173, v173, v33
  v_exp_f32 v172, v172
  ds_read_b128 v[148:151], v1 offset:25600
  s_waitcnt lgkmcnt(5)
  v_mfma_f32_32x32x16_bf16 v[48:63], v[152:155], a[160:163], v[48:63]
  v_exp_f32 v173, v173
  v_mul_f32 v32, v32, v40
  v_mfma_f32_32x32x16_bf16 v[64:79], v[152:155], a[164:167], v[64:79]
  v_mul_f32 v33, v33, v41
  v_fma_f32 v172, v172, v181, v181
  ds_read_b128 v[152:155], v1 offset:26624
  s_waitcnt lgkmcnt(5)
  v_mfma_f32_32x32x16_bf16 v[48:63], v[156:159], a[168:171], v[48:63]
  buffer_load_dwordx4 v1, s[4:7], s48 offen offset:3072 sc1 lds
  s_add_u32 s48, s48, 4096
  s_add_u32 m0, m0, 4096
  v_fma_f32 v173, v173, v181, v181
  v_rcp_f32 v172, v172
  v_mfma_f32_32x32x16_bf16 v[64:79], v[156:159], a[172:175], v[64:79]
  v_rcp_f32 v173, v173
  v_mul_f32 v32, v32, v172
  ds_read_b128 v[156:159], v1 offset:27648
  s_waitcnt lgkmcnt(5)
  v_mfma_f32_32x32x16_bf16 v[48:63], v[160:163], a[176:179], v[48:63]
  v_mul_f32 v33, v33, v173
  v_cvt_pk_bf16_f32 v188, v32, v33
  v_mfma_f32_32x32x16_bf16 v[64:79], v[160:163], a[180:183], v[64:79]
  v_mul_f32 v174, v34, v34
  v_mul_f32 v175, v35, v35
  v_fma_f32 v174, v174, v180, v179
  ds_read_b128 v[160:163], v1 offset:28672
  s_waitcnt lgkmcnt(5)
  v_mfma_f32_32x32x16_bf16 v[48:63], v[164:167], a[184:187], v[48:63]
  buffer_load_dwordx4 v1, s[4:7], s48 offen offset:0 sc1 lds
  v_fma_f32 v175, v175, v180, v179
  v_mul_f32 v174, v174, v34
  v_mfma_f32_32x32x16_bf16 v[64:79], v[164:167], a[188:191], v[64:79]
  v_mul_f32 v175, v175, v35
  v_exp_f32 v174, v174
  ds_read_b128 v[164:167], v1 offset:29696
  s_waitcnt lgkmcnt(5)
  v_mfma_f32_32x32x16_bf16 v[48:63], v[144:147], a[192:195], v[48:63]
  v_exp_f32 v175, v175
  v_mul_f32 v34, v34, v42
  v_mfma_f32_32x32x16_bf16 v[64:79], v[144:147], a[196:199], v[64:79]
  buffer_load_dwordx4 v1, s[4:7], s48 offen offset:1024 sc1 lds
  v_mul_f32 v35, v35, v43
  v_fma_f32 v174, v174, v181, v181
  ds_read_b128 v[144:147], v1 offset:30720
  s_waitcnt lgkmcnt(5)
  v_mfma_f32_32x32x16_bf16 v[48:63], v[148:151], a[200:203], v[48:63]
  v_fma_f32 v175, v175, v181, v181
  v_rcp_f32 v174, v174
  v_mfma_f32_32x32x16_bf16 v[64:79], v[148:151], a[204:207], v[64:79]
  v_rcp_f32 v175, v175
  v_mul_f32 v34, v34, v174
  ds_read_b128 v[148:151], v1 offset:31744
  s_waitcnt lgkmcnt(5)
  v_mfma_f32_32x32x16_bf16 v[48:63], v[152:155], a[208:211], v[48:63]
  buffer_load_dwordx4 v1, s[4:7], s48 offen offset:2048 sc1 lds
  v_mul_f32 v35, v35, v175
  v_cvt_pk_bf16_f32 v189, v34, v35
  v_mfma_f32_32x32x16_bf16 v[64:79], v[152:155], a[212:215], v[64:79]
  v_mul_f32 v172, v36, v36
  v_mul_f32 v173, v37, v37
  v_fma_f32 v172, v172, v180, v179
  ds_read_b128 v[152:155], v1 offset:32768
  s_waitcnt lgkmcnt(5)
  v_mfma_f32_32x32x16_bf16 v[48:63], v[156:159], a[216:219], v[48:63]
  v_fma_f32 v173, v173, v180, v179
  v_mul_f32 v172, v172, v36
  v_mfma_f32_32x32x16_bf16 v[64:79], v[156:159], a[220:223], v[64:79]
  buffer_load_dwordx4 v1, s[4:7], s48 offen offset:3072 sc1 lds
  s_add_u32 s48, s48, 4096
  s_add_u32 m0, m0, 4096
  v_mul_f32 v173, v173, v37
  v_exp_f32 v172, v172
  ds_read_b128 v[156:159], v1 offset:33792
  s_waitcnt lgkmcnt(5)
  v_mfma_f32_32x32x16_bf16 v[48:63], v[160:163], a[224:227], v[48:63]
  v_exp_f32 v173, v173
  v_mul_f32 v36, v36, v44
  v_mfma_f32_32x32x16_bf16 v[64:79], v[160:163], a[228:231], v[64:79]
  v_mul_f32 v37, v37, v45
  v_fma_f32 v172, v172, v181, v181
  ds_read_b128 v[160:163], v1 offset:34816
  s_waitcnt lgkmcnt(5)
  v_mfma_f32_32x32x16_bf16 v[48:63], v[164:167], a[232:235], v[48:63]
  buffer_load_dwordx4 v1, s[4:7], s48 offen offset:0 sc1 lds
  v_fma_f32 v173, v173, v181, v181
  v_rcp_f32 v172, v172
  v_mfma_f32_32x32x16_bf16 v[64:79], v[164:167], a[236:239], v[64:79]
  v_rcp_f32 v173, v173
  v_mul_f32 v36, v36, v172
  ds_read_b128 v[164:167], v1 offset:35840
  s_waitcnt lgkmcnt(5)
  v_mfma_f32_32x32x16_bf16 v[48:63], v[144:147], a[240:243], v[48:63]
  v_mul_f32 v37, v37, v173
  v_cvt_pk_bf16_f32 v190, v36, v37
  v_mfma_f32_32x32x16_bf16 v[64:79], v[144:147], a[244:247], v[64:79]
  v_mul_f32 v174, v38, v38
  v_mul_f32 v175, v39, v39
  v_fma_f32 v174, v174, v180, v179
  ds_read_b128 v[168:171], v3 offset:23552
  s_waitcnt lgkmcnt(5)
  v_mfma_f32_32x32x16_bf16 v[48:63], v[148:151], a[248:251], v[48:63]
  v_fma_f32 v175, v175, v180, v179
  v_mul_f32 v174, v174, v38
  v_mfma_f32_32x32x16_bf16 v[64:79], v[148:151], a[252:255], v[64:79]
  v_mul_f32 v175, v175, v39
  v_exp_f32 v174, v174
  s_barrier
  ds_read_b128 v[144:147], v2 offset:8192
  s_waitcnt lgkmcnt(5)
  v_mfma_f32_32x32x16_bf16 v[48:63], v[152:155], v[224:227], v[48:63]
  buffer_load_dword v193, v192, s[4:7], 0 offen sc1
  v_exp_f32 v175, v175
  v_mul_f32 v38, v38, v46
  v_mfma_f32_32x32x16_bf16 v[64:79], v[152:155], v[228:231], v[64:79]
  v_mul_f32 v39, v39, v47
  v_fma_f32 v174, v174, v181, v181
  ds_read_b128 v[148:151], v2 offset:9216
  s_waitcnt lgkmcnt(5)
  v_mfma_f32_32x32x16_bf16 v[48:63], v[156:159], v[232:235], v[48:63]
  v_fma_f32 v175, v175, v181, v181
  v_rcp_f32 v174, v174
  v_mfma_f32_32x32x16_bf16 v[64:79], v[156:159], v[236:239], v[64:79]
  v_rcp_f32 v175, v175
  v_mul_f32 v38, v38, v174
  ds_read_b128 v[152:155], v2 offset:10240
  s_waitcnt lgkmcnt(5)
  v_mfma_f32_32x32x16_bf16 v[48:63], v[160:163], v[240:243], v[48:63]
  v_mul_f32 v39, v39, v175
  v_cvt_pk_bf16_f32 v191, v38, v39
  v_mfma_f32_32x32x16_bf16 v[64:79], v[160:163], v[244:247], v[64:79]
  buffer_store_dwordx4 v[188:191], v1, s[4:7], s45 offen sc1
  s_add_u32 s45, s45, 1024
  ds_read_b128 v[156:159], v2 offset:11264
  s_waitcnt lgkmcnt(5)
  v_mfma_f32_32x32x16_bf16 v[48:63], v[164:167], v[248:251], v[48:63]
  v_mfma_f32_32x32x16_bf16 v[64:79], v[164:167], v[252:255], v[64:79]
  ds_read_b128 v[160:163], v2 offset:12288
  s_waitcnt lgkmcnt(5)
  v_mfma_f32_32x32x16_bf16 v[48:63], v[168:171], v[216:219], v[48:63]
  v_mfma_f32_32x32x16_bf16 v[64:79], v[168:171], v[220:223], v[64:79]
  ds_read_b128 v[164:167], v2 offset:13312
  s_waitcnt lgkmcnt(5)
  v_mfma_f32_32x32x16_bf16 v[16:31], v[144:147], a[0:3], 0
  v_mfma_f32_32x32x16_bf16 v[32:47], v[144:147], a[4:7], 0
  s_waitcnt vmcnt(1)
  s_mov_b32 s47, 0
B2_hs0:
  v_readfirstlane_b32 s46, v193
  s_nop 0
  s_cmp_eq_u32 s46, 8
  s_cbranch_scc1 B2_hok0
  s_add_u32 s47, s47, 1
  s_cmp_gt_u32 s47, 0x20000
  s_cbranch_scc1 B2_hok0
  buffer_load_dword v193, v192, s[4:7], 0 offen sc1
  s_waitcnt vmcnt(0)
  s_branch B2_hs0
B2_hok0:
  ds_read_b128 v[144:147], v2 offset:14336
  s_waitcnt lgkmcnt(5)
  v_mfma_f32_32x32x16_bf16 v[16:31], v[148:151], a[8:11], v[16:31]
  s_add_u32 s55, s54, 0
  buffer_load_dwordx4 a[0:3], v4, s[4:7], s55 offen offset:0 sc1
  v_mfma_f32_32x32x16_bf16 v[32:47], v[148:151], a[12:15], v[32:47]
  ds_read_b128 v[148:151], v2 offset:15360
  s_waitcnt lgkmcnt(5)
  v_mfma_f32_32x32x16_bf16 v[16:31], v[152:155], a[16:19], v[16:31]
  buffer_load_dwordx4 a[4:7], v4, s[4:7], s55 offen offset:256 sc1
  v_mul_f32 v172, v48, v48
  v_mul_f32 v173, v49, v49
  v_fma_f32 v172, v172, v177, v176
  v_mfma_f32_32x32x16_bf16 v[32:47], v[152:155], a[20:23], v[32:47]
  v_fma_f32 v173, v173, v177, v176
  v_mul_f32 v172, v172, v48
  ds_read_b128 v[152:155], v2 offset:16384
  s_waitcnt lgkmcnt(5)
  v_mfma_f32_32x32x16_bf16 v[16:31], v[156:159], a[24:27], v[16:31]
  s_add_u32 s55, s54, 2048
  buffer_load_dwordx4 a[8:11], v4, s[4:7], s55 offen offset:0 sc1
  v_mul_f32 v173, v173, v49
  v_exp_f32 v172, v172
  v_mfma_f32_32x32x16_bf16 v[32:47], v[156:159], a[28:31], v[32:47]
  v_exp_f32 v173, v173
  v_mul_f32 v48, v48, v56
  ds_read_b128 v[156:159], v2 offset:17408
  s_waitcnt lgkmcnt(5)
  v_mfma_f32_32x32x16_bf16 v[16:31], v[160:163], a[32:35], v[16:31]
  buffer_load_dwordx4 a[12:15], v4, s[4:7], s55 offen offset:256 sc1
  v_mul_f32 v49, v49, v57
  v_fma_f32 v172, v172, v178, v178
  v_mfma_f32_32x32x16_bf16 v[32:47], v[160:163], a[36:39], v[32:47]
  v_fma_f32 v173, v173, v178, v178
  v_rcp_f32 v172, v172
  ds_read_b128 v[160:163], v2 offset:18432
  s_waitcnt lgkmcnt(5)
  v_mfma_f32_32x32x16_bf16 v[16:31], v[164:167], a[40:43], v[16:31]
  s_add_u32 s55, s54, 4096
  buffer_load_dwordx4 a[16:19], v4, s[4:7], s55 offen offset:0 sc1
  v_rcp_f32 v173, v173
  v_mul_f32 v48, v48, v172
  v_mfma_f32_32x32x16_bf16 v[32:47], v[164:167], a[44:47], v[32:47]
  v_mul_f32 v49, v49, v173
  v_cvt_pk_bf16_f32 v184, v48, v49
  ds_read_b128 v[164:167], v2 offset:19456
  s_waitcnt lgkmcnt(5)
  v_mfma_f32_32x32x16_bf16 v[16:31], v[144:147], a[48:51], v[16:31]
  buffer_load_dwordx4 a[20:23], v4, s[4:7], s55 offen offset:256 sc1
  v_mul_f32 v174, v50, v50
  v_mul_f32 v175, v51, v51
  v_fma_f32 v174, v174, v177, v176
  v_mfma_f32_32x32x16_bf16 v[32:47], v[144:147], a[52:55], v[32:47]
  v_fma_f32 v175, v175, v177, v176
  v_mul_f32 v174, v174, v50
  ds_read_b128 v[144:147], v2 offset:20480
  s_waitcnt lgkmcnt(5)
  v_mfma_f32_32x32x16_bf16 v[16:31], v[148:151], a[56:59], v[16:31]
  v_mul_f32 v175, v175, v51
  v_exp_f32 v174, v174
  v_mfma_f32_32x32x16_bf16 v[32:47], v[148:151], a[60:63], v[32:47]
  s_add_u32 s55, s54, 10240
  buffer_load_dwordx4 a[24:27], v4, s[4:7], s55 offen offset:0 sc1
  v_exp_f32 v175, v175
  v_mul_f32 v50, v50, v58
  ds_read_b128 v[148:151], v2 offset:21504
  s_waitcnt lgkmcnt(5)
  v_mfma_f32_32x32x16_bf16 v[16:31], v[152:155], a[64:67], v[16:31]
  v_mul_f32 v51, v51, v59
  v_fma_f32 v174, v174, v178, v178
  v_mfma_f32_32x32x16_bf16 v[32:47], v[152:155], a[68:71], v[32:47]
  buffer_load_dwordx4 a[28:31], v4, s[4:7], s55 offen offset:256 sc1
  v_fma_f32 v175, v175, v178, v178
  v_rcp_f32 v174, v174
  ds_read_b128 v[152:155], v2 offset:22528
  s_waitcnt lgkmcnt(5)
  v_mfma_f32_32x32x16_bf16 v[16:31], v[156:159], a[72:75], v[16:31]
  v_rcp_f32 v175, v175
  v_mul_f32 v50, v50, v174
  v_mfma_f32_32x32x16_bf16 v[32:47], v[156:159], a[76:79], v[32:47]
  s_add_u32 s55, s54, 12288
  buffer_load_dwordx4 a[32:35], v4, s[4:7], s55 offen offset:0 sc1
  v_mul_f32 v51, v51, v175
  v_cvt_pk_bf16_f32 v185, v50, v51
  ds_read_b128 v[156:159], v2 offset:23552
  s_waitcnt lgkmcnt(5)
  v_mfma_f32_32x32x16_bf16 v[16:31], v[160:163], a[80:83], v[16:31]
  v_mul_f32 v172, v52, v52
  v_mul_f32 v173, v53, v53
  v_fma_f32 v172, v172, v177, v176
  v_mfma_f32_32x32x16_bf16 v[32:47], v[160:163], a[84:87], v[32:47]
  buffer_load_dwordx4 a[36:39], v4, s[4:7], s55 offen offset:256 sc1
  v_fma_f32 v173, v173, v177, v176
  v_mul_f32 v172, v172, v52
  ds_read_b128 v[160:163], v2 offset:24576
  s_waitcnt lgkmcnt(5)
  v_mfma_f32_32x32x16_bf16 v[16:31], v[164:167], a[88:91], v[16:31]
  v_mul_f32 v173, v173, v53
  v_exp_f32 v172, v172
  v_mfma_f32_32x32x16_bf16 v[32:47], v[164:167], a[92:95], v[32:47]
  s_add_u32 s55, s54, 18432
  buffer_load_dwordx4 a[40:43], v4, s[4:7], s55 offen offset:0 sc1
  v_exp_f32 v173, v173
  v_mul_f32 v52, v52, v60
  ds_read_b128 v[164:167], v2 offset:25600
  s_waitcnt lgkmcnt(5)
  v_mfma_f32_32x32x16_bf16 v[16:31], v[144:147], a[96:99], v[16:31]
  v_mul_f32 v53, v53, v61
  v_fma_f32 v172, v172, v178, v178
  v_mfma_f32_32x32x16_bf16 v[32:47], v[144:147], a[100:103], v[32:47]
  v_fma_f32 v173, v173, v178, v178
  v_rcp_f32 v172, v172
  ds_read_b128 v[144:147], v2 offset:26624
  s_waitcnt lgkmcnt(5)
  v_mfma_f32_32x32x16_bf16 v[16:31], v[148:151], a[104:107], v[16:31]
  buffer_load_dwordx4 a[44:47], v4, s[4:7], s55 offen offset:256 sc1
  v_rcp_f32 v173, v173
  v_mul_f32 v52, v52, v172
  v_mfma_f32_32x32x16_bf16 v[32:47], v[148:151], a[108:111], v[32:47]
  v_mul_f32 v53, v53, v173
  v_cvt_pk_bf16_f32 v186, v52, v53
  ds_read_b128 v[148:151], v2 offset:27648
  s_waitcnt lgkmcnt(5)
  v_mfma_f32_32x32x16_bf16 v[16:31], v[152:155], a[112:115], v[16:31]
  s_add_u32 s55, s54, 20480
  buffer_load_dwordx4 a[48:51], v4, s[4:7], s55 offen offset:0 sc1
  v_mul_f32 v174, v54, v54
  v_mul_f32 v175, v55, v55
  v_fma_f32 v174, v174, v177, v176
  v_mfma_f32_32x32x16_bf16 v[32:47], v[152:155], a[116:119], v[32:47]
  v_fma_f32 v175, v175, v177, v176
  v_mul_f32 v174, v174, v54
  ds_read_b128 v[152:155], v2 offset:28672
  s_waitcnt lgkmcnt(5)
  v_mfma_f32_32x32x16_bf16 v[16:31], v[156:159], a[120:123], v[16:31]
  buffer_load_dwordx4 a[52:55], v4, s[4:7], s55 offen offset:256 sc1
  v_mul_f32 v175, v175, v55
  v_exp_f32 v174, v174
  v_mfma_f32_32x32x16_bf16 v[32:47], v[156:159], a[124:127], v[32:47]
  v_exp_f32 v175, v175
  v_mul_f32 v54, v54, v62
  ds_read_b128 v[156:159], v2 offset:29696
  s_waitcnt lgkmcnt(5)
  v_mfma_f32_32x32x16_bf16 v[16:31], v[160:163], a[128:131], v[16:31]
  s_add_u32 s55, s54, 22528
  buffer_load_dwordx4 a[56:59], v4, s[4:7], s55 offen offset:0 sc1
  v_mul_f32 v55, v55, v63
  v_fma_f32 v174, v174, v178, v178
  v_mfma_f32_32x32x16_bf16 v[32:47], v[160:163], a[132:135], v[32:47]
  v_fma_f32 v175, v175, v178, v178
  v_rcp_f32 v174, v174
  ds_read_b128 v[160:163], v2 offset:30720
  s_waitcnt lgkmcnt(5)
  v_mfma_f32_32x32x16_bf16 v[16:31], v[164:167], a[136:139], v[16:31]
  buffer_load_dwordx4 a[60:63], v4, s[4:7], s55 offen offset:256 sc1
  v_rcp_f32 v175, v175
  v_mul_f32 v54, v54, v174
  v_mfma_f32_32x32x16_bf16 v[32:47], v[164:167], a[140:143], v[32:47]
  v_mul_f32 v55, v55, v175
  v_cvt_pk_bf16_f32 v187, v54, v55
  ds_read_b128 v[164:167], v2 offset:31744
  s_waitcnt lgkmcnt(5)
  v_mfma_f32_32x32x16_bf16 v[16:31], v[144:147], a[144:147], v[16:31]
  buffer_store_dwordx4 v[184:187], v1, s[4:7], s44 offen sc1
  s_add_u32 s44, s44, 1024
  v_mfma_f32_32x32x16_bf16 v[32:47], v[144:147], a[148:151], v[32:47]
  s_add_u32 s55, s54, 28672
  buffer_load_dwordx4 a[64:67], v4, s[4:7], s55 offen offset:0 sc1
  v_mul_f32 v172, v64, v64
  v_mul_f32 v173, v65, v65
  v_fma_f32 v172, v172, v180, v179
  ds_read_b128 v[144:147], v2 offset:32768
  s_waitcnt lgkmcnt(5)
  v_mfma_f32_32x32x16_bf16 v[16:31], v[148:151], a[152:155], v[16:31]
  v_fma_f32 v173, v173, v180, v179
  v_mul_f32 v172, v172, v64
  v_mfma_f32_32x32x16_bf16 v[32:47], v[148:151], a[156:159], v[32:47]
  buffer_load_dwordx4 a[68:71], v4, s[4:7], s55 offen offset:256 sc1
  v_mul_f32 v173, v173, v65
  v_exp_f32 v172, v172
  ds_read_b128 v[148:151], v2 offset:33792
  s_waitcnt lgkmcnt(5)
  v_mfma_f32_32x32x16_bf16 v[16:31], v[152:155], a[160:163], v[16:31]
  v_exp_f32 v173, v173
  v_mul_f32 v64, v64, v72
  v_mfma_f32_32x32x16_bf16 v[32:47], v[152:155], a[164:167], v[32:47]
  s_add_u32 s55, s54, 30720
  buffer_load_dwordx4 a[72:75], v4, s[4:7], s55 offen offset:0 sc1
  v_mul_f32 v65, v65, v73
  v_fma_f32 v172, v172, v181, v181
  ds_read_b128 v[152:155], v2 offset:34816
  s_waitcnt lgkmcnt(5)
  v_mfma_f32_32x32x16_bf16 v[16:31], v[156:159], a[168:171], v[16:31]
  v_fma_f32 v173, v173, v181, v181
  v_rcp_f32 v172, v172
  v_mfma_f32_32x32x16_bf16 v[32:47], v[156:159], a[172:175], v[32:47]
  buffer_load_dwordx4 a[76:79], v4, s[4:7], s55 offen offset:256 sc1
  v_rcp_f32 v173, v173
  v_mul_f32 v64, v64, v172
  ds_read_b128 v[156:159], v2 offset:35840
  s_waitcnt lgkmcnt(5)
  v_mfma_f32_32x32x16_bf16 v[16:31], v[160:163], a[176:179], v[16:31]
  v_mul_f32 v65, v65, v173
  v_cvt_pk_bf16_f32 v188, v64, v65
  v_mfma_f32_32x32x16_bf16 v[32:47], v[160:163], a[180:183], v[32:47]
  s_add_u32 s55, s54, 36864
  buffer_load_dwordx4 a[80:83], v4, s[4:7], s55 offen offset:0 sc1
  v_mul_f32 v174, v66, v66
  v_mul_f32 v175, v67, v67
  v_fma_f32 v174, v174, v180, v179
  ds_read_b128 v[160:163], v2 offset:36864
  s_waitcnt lgkmcnt(5)
  v_mfma_f32_32x32x16_bf16 v[16:31], v[164:167], a[184:187], v[16:31]
  v_fma_f32 v175, v175, v180, v179
  v_mul_f32 v174, v174, v66
  v_mfma_f32_32x32x16_bf16 v[32:47], v[164:167], a[188:191], v[32:47]
  buffer_load_dwordx4 a[84:87], v4, s[4:7], s55 offen offset:256 sc1
  v_mul_f32 v175, v175, v67
  v_exp_f32 v174, v174
  ds_read_b128 v[164:167], v2 offset:37888
  s_waitcnt lgkmcnt(5)
  v_mfma_f32_32x32x16_bf16 v[16:31], v[144:147], a[192:195], v[16:31]
  v_exp_f32 v175, v175
  v_mul_f32 v66, v66, v74
  v_mfma_f32_32x32x16_bf16 v[32:47], v[144:147], a[196:199], v[32:47]
  v_mul_f32 v67, v67, v75
  v_fma_f32 v174, v174, v181, v181
  ds_read_b128 v[144:147], v2 offset:38912
  s_waitcnt lgkmcnt(5)
  v_mfma_f32_32x32x16_bf16 v[16:31], v[148:151], a[200:203], v[16:31]
  s_add_u32 s55, s54, 38912
  buffer_load_dwordx4 a[88:91], v4, s[4:7], s55 offen offset:0 sc1
  v_fma_f32 v175, v175, v181, v181
  v_rcp_f32 v174, v174
  v_mfma_f32_32x32x16_bf16 v[32:47], v[148:151], a[204:207], v[32:47]
  v_rcp_f32 v175, v175
  v_mul_f32 v66, v66, v174
  ds_read_b128 v[148:151], v2 offset:39936
  s_waitcnt lgkmcnt(5)
  v_mfma_f32_32x32x16_bf16 v[16:31], v[152:155], a[208:211], v[16:31]
  buffer_load_dwordx4 a[92:95], v4, s[4:7], s55 offen offset:256 sc1
  v_mul_f32 v67, v67, v175
  v_cvt_pk_bf16_f32 v189, v66, v67
  v_mfma_f32_32x32x16_bf16 v[32:47], v[152:155], a[212:215], v[32:47]
  v_mul_f32 v172, v68, v68
  v_mul_f32 v173, v69, v69
  v_fma_f32 v172, v172, v180, v179
  ds_read_b128 v[152:155], v2 offset:40960
  s_waitcnt lgkmcnt(5)
  v_mfma_f32_32x32x16_bf16 v[16:31], v[156:159], a[216:219], v[16:31]
  s_add_u32 s55, s54, 40960
  buffer_load_dwordx4 a[96:99], v4, s[4:7], s55 offen offset:0 sc1
  v_fma_f32 v173, v173, v180, v179
  v_mul_f32 v172, v172, v68
  v_mfma_f32_32x32x16_bf16 v[32:47], v[156:159], a[220:223], v[32:47]
  v_mul_f32 v173, v173, v69
  v_exp_f32 v172, v172
  ds_read_b128 v[156:159], v2 offset:41984
  s_waitcnt lgkmcnt(5)
  v_mfma_f32_32x32x16_bf16 v[16:31], v[160:163], a[224:227], v[16:31]
  buffer_load_dwordx4 a[100:103], v4, s[4:7], s55 offen offset:256 sc1
  v_exp_f32 v173, v173
  v_mul_f32 v68, v68, v76
  v_mfma_f32_32x32x16_bf16 v[32:47], v[160:163], a[228:231], v[32:47]
  v_mul_f32 v69, v69, v77
  v_fma_f32 v172, v172, v181, v181
  ds_read_b128 v[160:163], v2 offset:43008
  s_waitcnt lgkmcnt(5)
  v_mfma_f32_32x32x16_bf16 v[16:31], v[164:167], a[232:235], v[16:31]
  s_add_u32 s55, s54, 47104
  buffer_load_dwordx4 a[104:107], v4, s[4:7], s55 offen offset:0 sc1
  v_fma_f32 v173, v173, v181, v181
  v_rcp_f32 v172, v172
  v_mfma_f32_32x32x16_bf16 v[32:47], v[164:167], a[236:239], v[32:47]
  v_rcp_f32 v173, v173
  v_mul_f32 v68, v68, v172
  ds_read_b128 v[164:167], v2 offset:44032
  s_waitcnt lgkmcnt(5)
  v_mfma_f32_32x32x16_bf16 v[16:31], v[144:147], a[240:243], v[16:31]
  v_mul_f32 v69, v69, v173
  v_cvt_pk_bf16_f32 v190, v68, v69
  v_mfma_f32_32x32x16_bf16 v[32:47], v[144:147], a[244:247], v[32:47]
  buffer_load_dwordx4 a[108:111], v4, s[4:7], s55 offen offset:256 sc1
  v_mul_f32 v174, v70, v70
  v_mul_f32 v175, v71, v71
  v_fma_f32 v174, v174, v180, v179
  ds_read_b128 v[168:171], v3 offset:24576
  s_waitcnt lgkmcnt(5)
  v_mfma_f32_32x32x16_bf16 v[16:31], v[148:151], a[248:251], v[16:31]
  v_fma_f32 v175, v175, v180, v179
  v_mul_f32 v174, v174, v70
  v_mfma_f32_32x32x16_bf16 v[32:47], v[148:151], a[252:255], v[32:47]
  s_add_u32 s55, s54, 49152
  buffer_load_dwordx4 a[112:115], v4, s[4:7], s55 offen offset:0 sc1
  v_mul_f32 v175, v175, v71
  v_exp_f32 v174, v174
  s_waitcnt lgkmcnt(4)
  v_mfma_f32_32x32x16_bf16 v[16:31], v[152:155], v[224:227], v[16:31]
  v_exp_f32 v175, v175
  v_mul_f32 v70, v70, v78
  v_mfma_f32_32x32x16_bf16 v[32:47], v[152:155], v[228:231], v[32:47]
  buffer_load_dwordx4 a[116:119], v4, s[4:7], s55 offen offset:256 sc1
  v_mul_f32 v71, v71, v79
  v_fma_f32 v174, v174, v181, v181
  s_waitcnt lgkmcnt(3)
  v_mfma_f32_32x32x16_bf16 v[16:31], v[156:159], v[232:235], v[16:31]
  v_fma_f32 v175, v175, v181, v181
  v_rcp_f32 v174, v174
  v_mfma_f32_32x32x16_bf16 v[32:47], v[156:159], v[236:239], v[32:47]
  s_add_u32 s55, s54, 55296
  buffer_load_dwordx4 a[120:123], v4, s[4:7], s55 offen offset:0 sc1
  v_rcp_f32 v175, v175
  v_mul_f32 v70, v70, v174
  s_waitcnt lgkmcnt(2)
  v_mfma_f32_32x32x16_bf16 v[16:31], v[160:163], v[240:243], v[16:31]
  v_mul_f32 v71, v71, v175
  v_cvt_pk_bf16_f32 v191, v70, v71
  v_mfma_f32_32x32x16_bf16 v[32:47], v[160:163], v[244:247], v[32:47]
  buffer_load_dwordx4 a[124:127], v4, s[4:7], s55 offen offset:256 sc1
  buffer_store_dwordx4 v[188:191], v1, s[4:7], s45 offen sc1
  s_add_u32 s45, s45, 1024
  s_waitcnt lgkmcnt(1)
  v_mfma_f32_32x32x16_bf16 v[16:31], v[164:167], v[248:251], v[16:31]
  v_mfma_f32_32x32x16_bf16 v[32:47], v[164:167], v[252:255], v[32:47]
  s_waitcnt lgkmcnt(0)
  v_mfma_f32_32x32x16_bf16 v[16:31], v[168:171], v[216:219], v[16:31]
  v_mfma_f32_32x32x16_bf16 v[32:47], v[168:171], v[220:223], v[32:47]
  s_nop 10
  v_pk_mul_f32 v[172:173], v[16:17], v[16:17] op_sel:[0,0] op_sel_hi:[1,1]
  v_pk_mul_f32 v[174:175], v[18:19], v[18:19] op_sel:[0,0] op_sel_hi:[1,1]
  v_pk_fma_f32 v[172:173], v[172:173], v[176:177], v[176:177] op_sel:[0,1,0] op_sel_hi:[1,1,0]
  v_pk_fma_f32 v[174:175], v[174:175], v[176:177], v[176:177] op_sel:[0,1,0] op_sel_hi:[1,1,0]
  v_pk_mul_f32 v[172:173], v[172:173], v[16:17] op_sel:[0,0] op_sel_hi:[1,1]
  v_pk_mul_f32 v[174:175], v[174:175], v[18:19] op_sel:[0,0] op_sel_hi:[1,1]
  v_exp_f32 v172, v172
  v_exp_f32 v174, v174
  v_exp_f32 v173, v173
  v_exp_f32 v175, v175
  v_pk_mul_f32 v[16:17], v[16:17], v[24:25] op_sel:[0,0] op_sel_hi:[1,1]
  v_pk_mul_f32 v[18:19], v[18:19], v[26:27] op_sel:[0,0] op_sel_hi:[1,1]
  v_pk_fma_f32 v[172:173], v[172:173], v[178:179], v[178:179] op_sel:[0,0,0] op_sel_hi:[1,0,0]
  v_pk_fma_f32 v[174:175], v[174:175], v[178:179], v[178:179] op_sel:[0,0,0] op_sel_hi:[1,0,0]
  v_rcp_f32 v172, v172
  v_rcp_f32 v174, v174
  v_rcp_f32 v173, v173
  v_rcp_f32 v175, v175
  v_pk_mul_f32 v[16:17], v[16:17], v[172:173] op_sel:[0,0] op_sel_hi:[1,1]
  v_pk_mul_f32 v[18:19], v[18:19], v[174:175] op_sel:[0,0] op_sel_hi:[1,1]
  v_cvt_pk_bf16_f32 v184, v16, v17
  v_cvt_pk_bf16_f32 v185, v18, v19
  v_pk_mul_f32 v[172:173], v[20:21], v[20:21] op_sel:[0,0] op_sel_hi:[1,1]
  v_pk_mul_f32 v[174:175], v[22:23], v[22:23] op_sel:[0,0] op_sel_hi:[1,1]
  v_pk_fma_f32 v[172:173], v[172:173], v[176:177], v[176:177] op_sel:[0,1,0] op_sel_hi:[1,1,0]
  v_pk_fma_f32 v[174:175], v[174:175], v[176:177], v[176:177] op_sel:[0,1,0] op_sel_hi:[1,1,0]
  v_pk_mul_f32 v[172:173], v[172:173], v[20:21] op_sel:[0,0] op_sel_hi:[1,1]
  v_pk_mul_f32 v[174:175], v[174:175], v[22:23] op_sel:[0,0] op_sel_hi:[1,1]
  v_exp_f32 v172, v172
  v_exp_f32 v174, v174
  v_exp_f32 v173, v173
  v_exp_f32 v175, v175
  v_pk_mul_f32 v[20:21], v[20:21], v[28:29] op_sel:[0,0] op_sel_hi:[1,1]
  v_pk_mul_f32 v[22:23], v[22:23], v[30:31] op_sel:[0,0] op_sel_hi:[1,1]
  v_pk_fma_f32 v[172:173], v[172:173], v[178:179], v[178:179] op_sel:[0,0,0] op_sel_hi:[1,0,0]
  v_pk_fma_f32 v[174:175], v[174:175], v[178:179], v[178:179] op_sel:[0,0,0] op_sel_hi:[1,0,0]
  v_rcp_f32 v172, v172
  v_rcp_f32 v174, v174
  v_rcp_f32 v173, v173
  v_rcp_f32 v175, v175
  v_pk_mul_f32 v[20:21], v[20:21], v[172:173] op_sel:[0,0] op_sel_hi:[1,1]
  v_pk_mul_f32 v[22:23], v[22:23], v[174:175] op_sel:[0,0] op_sel_hi:[1,1]
  v_cvt_pk_bf16_f32 v186, v20, v21
  v_cvt_pk_bf16_f32 v187, v22, v23
  buffer_store_dwordx4 v[184:187], v1, s[4:7], s44 offen sc1
  s_add_u32 s44, s44, 1024
  v_pk_mul_f32 v[172:173], v[32:33], v[32:33] op_sel:[0,0] op_sel_hi:[1,1]
  v_pk_mul_f32 v[174:175], v[34:35], v[34:35] op_sel:[0,0] op_sel_hi:[1,1]
  v_pk_fma_f32 v[172:173], v[172:173], v[180:181], v[178:179] op_sel:[0,0,1] op_sel_hi:[1,0,1]
  v_pk_fma_f32 v[174:175], v[174:175], v[180:181], v[178:179] op_sel:[0,0,1] op_sel_hi:[1,0,1]
  v_pk_mul_f32 v[172:173], v[172:173], v[32:33] op_sel:[0,0] op_sel_hi:[1,1]
  v_pk_mul_f32 v[174:175], v[174:175], v[34:35] op_sel:[0,0] op_sel_hi:[1,1]
  v_exp_f32 v172, v172
  v_exp_f32 v174, v174
  v_exp_f32 v173, v173
  v_exp_f32 v175, v175
  v_pk_mul_f32 v[32:33], v[32:33], v[40:41] op_sel:[0,0] op_sel_hi:[1,1]
  v_pk_mul_f32 v[34:35], v[34:35], v[42:43] op_sel:[0,0] op_sel_hi:[1,1]
  v_pk_fma_f32 v[172:173], v[172:173], v[180:181], v[180:181] op_sel:[0,1,1] op_sel_hi:[1,1,1]
  v_pk_fma_f32 v[174:175], v[174:175], v[180:181], v[180:181] op_sel:[0,1,1] op_sel_hi:[1,1,1]
  v_rcp_f32 v172, v172
  v_rcp_f32 v174, v174
  v_rcp_f32 v173, v173
  v_rcp_f32 v175, v175
  v_pk_mul_f32 v[32:33], v[32:33], v[172:173] op_sel:[0,0] op_sel_hi:[1,1]
  v_pk_mul_f32 v[34:35], v[34:35], v[174:175] op_sel:[0,0] op_sel_hi:[1,1]
  v_cvt_pk_bf16_f32 v188, v32, v33
  v_cvt_pk_bf16_f32 v189, v34, v35
  v_pk_mul_f32 v[172:173], v[36:37], v[36:37] op_sel:[0,0] op_sel_hi:[1,1]
  v_pk_mul_f32 v[174:175], v[38:39], v[38:39] op_sel:[0,0] op_sel_hi:[1,1]
  v_pk_fma_f32 v[172:173], v[172:173], v[180:181], v[178:179] op_sel:[0,0,1] op_sel_hi:[1,0,1]
  v_pk_fma_f32 v[174:175], v[174:175], v[180:181], v[178:179] op_sel:[0,0,1] op_sel_hi:[1,0,1]
  v_pk_mul_f32 v[172:173], v[172:173], v[36:37] op_sel:[0,0] op_sel_hi:[1,1]
  v_pk_mul_f32 v[174:175], v[174:175], v[38:39] op_sel:[0,0] op_sel_hi:[1,1]
  v_exp_f32 v172, v172
  v_exp_f32 v174, v174
  v_exp_f32 v173, v173
  v_exp_f32 v175, v175
  v_pk_mul_f32 v[36:37], v[36:37], v[44:45] op_sel:[0,0] op_sel_hi:[1,1]
  v_pk_mul_f32 v[38:39], v[38:39], v[46:47] op_sel:[0,0] op_sel_hi:[1,1]
  v_pk_fma_f32 v[172:173], v[172:173], v[180:181], v[180:181] op_sel:[0,1,1] op_sel_hi:[1,1,1]
  v_pk_fma_f32 v[174:175], v[174:175], v[180:181], v[180:181] op_sel:[0,1,1] op_sel_hi:[1,1,1]
  v_rcp_f32 v172, v172
  v_rcp_f32 v174, v174
  v_rcp_f32 v173, v173
  v_rcp_f32 v175, v175
  v_pk_mul_f32 v[36:37], v[36:37], v[172:173] op_sel:[0,0] op_sel_hi:[1,1]
  v_pk_mul_f32 v[38:39], v[38:39], v[174:175] op_sel:[0,0] op_sel_hi:[1,1]
  v_cvt_pk_bf16_f32 v190, v36, v37
  v_cvt_pk_bf16_f32 v191, v38, v39
  buffer_store_dwordx4 v[188:191], v1, s[4:7], s45 offen sc1
  s_add_u32 s45, s45, 1024
  s_mul_i32 s41, s3, 9216
  v_mov_b32 v194, v9
  v_mov_b32 v9, v15
  s_lshl_b32 s53, s38, 2
  s_add_u32 s53, s53, s39
  s_mul_i32 s60, s53, 147456
  s_add_u32 s60, s60, 26968064
  s_add_u32 s60, s60, s50
  s_lshl_b32 s46, s3, 10
  s_add_u32 s60, s60, s46
  s_mul_i32 s44, s57, 36864
  s_add_u32 s44, s44, s60
  s_add_u32 s45, s44, 32768
  s_add_u32 s43, s57, 1
  s_and_b32 s43, s43, 3
  s_lshl_b32 s46, s43, 7
  v_mov_b32 v14, s46
  s_lshl_b32 s43, s43, 13
  s_lshl_b32 s53, s53, 2
  s_add_u32 s53, s53, s3
  s_lshl_b32 s53, s53, 9
  s_add_u32 s53, s53, 5046272
  s_add_u32 s53, s53, s50
  s_lshl_b32 s46, s57, 7
  v_mov_b32 v6, s49
  v_writelane_b32 v6, s46, 0
  v_mov_b32 v7, 1
  v_and_b32 v10, 3, v0
  v_lshlrev_b32 v10, 7, v10
  s_add_u32 s46, s57, 1
  s_and_b32 s46, s46, 3
  s_mul_i32 s46, s46, 36864
  s_add_u32 s96, s60, s46
  s_add_u32 s46, s57, 2
  s_and_b32 s46, s46, 3
  s_mul_i32 s46, s46, 36864
  s_add_u32 s97, s60, s46
  s_add_u32 s46, s57, 3
  s_and_b32 s46, s46, 3
  s_mul_i32 s46, s46, 36864
  s_add_u32 s98, s60, s46
  s_lshl_b32 s62, s57, 13
  s_cmp_eq_u32 s3, s57
  s_cselect_b32 s46, 0, s49
  v_add_u32 v11, s46, v1
  v_bfe_u32 v12, v0, 5, 1
  v_lshlrev_b32 v12, 9, v12
  v_lshl_add_u32 v12, v8, 4, v12
  v_bfe_u32 v13, v0, 4, 1
  v_mov_b32 v5, v12
  v_lshl_add_u32 v12, v13, 8, v12
  v_mul_u32_u24 v13, 1152, v8
  v_lshrrev_b32 v195, 1, v9
  v_lshl_add_u32 v13, v195, 4, v13
  s_mul_i32 s40, s52, 36864
  s_mul_i32 s46, s39, 9216
  s_add_u32 s40, s40, s46
  s_mul_i32 s42, s52, 36864
  s_mul_i32 s46, s39, 288
  s_add_u32 s42, s42, s46
  s_add_u32 s46, s40, 64978944
  s_cmp_eq_u32 s51, 0
  s_cselect_b32 s8, s4, s30
  s_cselect_b32 s9, s5, s31
  s_cselect_b32 s10, s6, 2359296
  s_mov_b32 s11, 0x20000
  s_cselect_b32 s42, s46, s42
  s_cselect_b32 s56, 1024, 32
  s_cselect_b32 s63, 0, 1
  s_cselect_b64 vcc, -1, 0
  v_cndmask_b32 v13, v13, v5, vcc
  s_mul_i32 s63, s63, 18176
  s_add_u32 s63, s63, 256
  s_add_u32 s40, s40, 5734400
  s_add_u32 s40, s40, s50
  s_barrier
  ds_read_b128 v[88:91], v2 offset:45056
  ds_read_b128 v[92:95], v2 offset:46080
  ds_read_b128 v[96:99], v2 offset:47104
  ds_read_b128 v[100:103], v2 offset:48128
  ds_read_b128 v[104:107], v2 offset:49152
  ds_read_b128 v[108:111], v2 offset:50176
  s_waitcnt vmcnt(34)
  s_waitcnt lgkmcnt(5)
  v_mfma_f32_16x16x32_bf16 v[16:19], v[88:91], a[0:3], 0
  v_mfma_f32_16x16x32_bf16 v[20:23], v[88:91], a[4:7], 0
  s_add_u32 s48, s61, 73728
  s_add_u32 m0, s41, 0
  ds_read_b128 v[88:91], v2 offset:51200
  s_waitcnt lgkmcnt(5)
  v_mfma_f32_16x16x32_bf16 v[24:27], v[92:95], a[0:3], 0
  v_mfma_f32_16x16x32_bf16 v[28:31], v[92:95], a[4:7], 0
  buffer_load_dwordx4 v1, s[4:7], s48 offen offset:0 sc1 lds
  ds_read_b128 v[92:95], v2 offset:52224
  s_waitcnt lgkmcnt(5)
  v_mfma_f32_16x16x32_bf16 v[32:35], v[96:99], a[0:3], 0
  v_mfma_f32_16x16x32_bf16 v[36:39], v[96:99], a[4:7], 0
  ds_read_b128 v[96:99], v2 offset:53248
  s_waitcnt lgkmcnt(5)
  v_mfma_f32_16x16x32_bf16 v[40:43], v[100:103], a[0:3], 0
  buffer_load_dwordx4 v1, s[4:7], s48 offen offset:1024 sc1 lds
  v_mfma_f32_16x16x32_bf16 v[44:47], v[100:103], a[4:7], 0
  ds_read_b128 v[100:103], v2 offset:54272
  s_waitcnt lgkmcnt(5)
  v_mfma_f32_16x16x32_bf16 v[48:51], v[104:107], a[0:3], 0
  v_mfma_f32_16x16x32_bf16 v[52:55], v[104:107], a[4:7], 0
  buffer_load_dwordx4 v1, s[4:7], s48 offen offset:2048 sc1 lds
  ds_read_b128 v[104:107], v2 offset:55296
  s_waitcnt lgkmcnt(5)
  v_mfma_f32_16x16x32_bf16 v[56:59], v[108:111], a[0:3], 0
  v_mfma_f32_16x16x32_bf16 v[60:63], v[108:111], a[4:7], 0
  ds_read_b128 v[108:111], v2 offset:56320
  s_waitcnt lgkmcnt(5)
  v_mfma_f32_16x16x32_bf16 v[64:67], v[88:91], a[0:3], 0
  buffer_load_dwordx4 v1, s[4:7], s48 offen offset:3072 sc1 lds
  s_add_u32 s48, s48, 4096
  s_add_u32 m0, m0, 4096
  v_mfma_f32_16x16x32_bf16 v[68:71], v[88:91], a[4:7], 0
  ds_read_b128 v[88:91], v2 offset:57344
  s_waitcnt vmcnt(36)
  s_waitcnt lgkmcnt(5)
  v_mfma_f32_16x16x32_bf16 v[16:19], v[92:95], a[8:11], v[16:19]
  v_mfma_f32_16x16x32_bf16 v[20:23], v[92:95], a[12:15], v[20:23]
  buffer_load_dwordx4 v1, s[4:7], s48 offen offset:0 sc1 lds
  ds_read_b128 v[92:95], v2 offset:58368
  s_waitcnt lgkmcnt(5)
  v_mfma_f32_16x16x32_bf16 v[24:27], v[96:99], a[8:11], v[24:27]
  v_mfma_f32_16x16x32_bf16 v[28:31], v[96:99], a[12:15], v[28:31]
  ds_read_b128 v[96:99], v2 offset:59392
  s_waitcnt lgkmcnt(5)
  v_mfma_f32_16x16x32_bf16 v[32:35], v[100:103], a[8:11], v[32:35]
  buffer_load_dwordx4 v1, s[4:7], s48 offen offset:1024 sc1 lds
  v_mfma_f32_16x16x32_bf16 v[36:39], v[100:103], a[12:15], v[36:39]
  ds_read_b128 v[100:103], v2 offset:60416
  s_waitcnt lgkmcnt(5)
  v_mfma_f32_16x16x32_bf16 v[40:43], v[104:107], a[8:11], v[40:43]
  v_mfma_f32_16x16x32_bf16 v[44:47], v[104:107], a[12:15], v[44:47]
  buffer_load_dwordx4 v1, s[4:7], s48 offen offset:2048 sc1 lds
  s_waitcnt vmcnt(7)
  buffer_atomic_add v7, v194, s[4:7], s58 offen
  ds_read_b128 v[104:107], v2 offset:61440
  s_waitcnt lgkmcnt(5)
  v_mfma_f32_16x16x32_bf16 v[48:51], v[108:111], a[8:11], v[48:51]
  v_mfma_f32_16x16x32_bf16 v[52:55], v[108:111], a[12:15], v[52:55]
  ds_read_b128 v[108:111], v2 offset:62464
  s_waitcnt lgkmcnt(5)
  v_mfma_f32_16x16x32_bf16 v[56:59], v[88:91], a[8:11], v[56:59]
  buffer_load_dwordx4 v1, s[4:7], s48 offen offset:3072 sc1 lds
  s_add_u32 s48, s48, 4096
  s_add_u32 m0, m0, 4096
  v_mfma_f32_16x16x32_bf16 v[60:63], v[88:91], a[12:15], v[60:63]
  ds_read_b128 v[88:91], v2 offset:63488
  s_waitcnt lgkmcnt(5)
  v_mfma_f32_16x16x32_bf16 v[64:67], v[92:95], a[8:11], v[64:67]
  v_mfma_f32_16x16x32_bf16 v[68:71], v[92:95], a[12:15], v[68:71]
  buffer_load_dwordx4 v1, s[4:7], s48 offen offset:0 sc1 lds
  ds_read_b128 v[92:95], v2 offset:64512
  s_waitcnt lgkmcnt(5)
  v_mfma_f32_16x16x32_bf16 v[16:19], v[96:99], a[16:19], v[16:19]
  v_mfma_f32_16x16x32_bf16 v[20:23], v[96:99], a[20:23], v[20:23]
  ds_read_b128 v[96:99], v3 offset:0
  s_waitcnt lgkmcnt(5)
  v_mfma_f32_16x16x32_bf16 v[24:27], v[100:103], a[16:19], v[24:27]
  v_mfma_f32_16x16x32_bf16 v[28:31], v[100:103], a[20:23], v[28:31]
  ds_read_b128 v[100:103], v3 offset:1024
  s_waitcnt lgkmcnt(5)
  v_mfma_f32_16x16x32_bf16 v[32:35], v[104:107], a[16:19], v[32:35]
  s_add_u32 s55, s54, 57344
  buffer_load_dwordx4 a[128:131], v4, s[4:7], s55 offen offset:0 sc1
  v_mfma_f32_16x16x32_bf16 v[36:39], v[104:107], a[20:23], v[36:39]
  ds_read_b128 v[104:107], v3 offset:2048
  s_waitcnt lgkmcnt(5)
  v_mfma_f32_16x16x32_bf16 v[40:43], v[108:111], a[16:19], v[40:43]
  v_mfma_f32_16x16x32_bf16 v[44:47], v[108:111], a[20:23], v[44:47]
  ds_read_b128 v[108:111], v3 offset:3072
  s_waitcnt lgkmcnt(5)
  v_mfma_f32_16x16x32_bf16 v[48:51], v[88:91], a[16:19], v[48:51]
  v_mfma_f32_16x16x32_bf16 v[52:55], v[88:91], a[20:23], v[52:55]
  ds_read_b128 v[88:91], v3 offset:4096
  s_waitcnt lgkmcnt(5)
  v_mfma_f32_16x16x32_bf16 v[56:59], v[92:95], a[16:19], v[56:59]
  v_mfma_f32_16x16x32_bf16 v[60:63], v[92:95], a[20:23], v[60:63]
  ds_read_b128 v[92:95], v3 offset:5120
  s_waitcnt lgkmcnt(5)
  v_mfma_f32_16x16x32_bf16 v[64:67], v[96:99], a[16:19], v[64:67]
  buffer_load_dwordx4 a[132:135], v4, s[4:7], s55 offen offset:256 sc1
  v_mfma_f32_16x16x32_bf16 v[68:71], v[96:99], a[20:23], v[68:71]
  ds_read_b128 v[96:99], v3 offset:6144
  s_waitcnt lgkmcnt(5)
  v_mfma_f32_16x16x32_bf16 v[16:19], v[100:103], a[24:27], v[16:19]
  v_mfma_f32_16x16x32_bf16 v[20:23], v[100:103], a[28:31], v[20:23]
  ds_read_b128 v[100:103], v3 offset:7168
  s_waitcnt lgkmcnt(5)
  v_mfma_f32_16x16x32_bf16 v[24:27], v[104:107], a[24:27], v[24:27]
  v_mfma_f32_16x16x32_bf16 v[28:31], v[104:107], a[28:31], v[28:31]
  ds_read_b128 v[104:107], v3 offset:8192
  s_waitcnt lgkmcnt(5)
  v_mfma_f32_16x16x32_bf16 v[32:35], v[108:111], a[24:27], v[32:35]
  v_mfma_f32_16x16x32_bf16 v[36:39], v[108:111], a[28:31], v[36:39]
  ds_read_b128 v[108:111], v3 offset:9216
  s_waitcnt lgkmcnt(5)
  v_mfma_f32_16x16x32_bf16 v[40:43], v[88:91], a[24:27], v[40:43]
  s_add_u32 s55, s54, 59392
  buffer_load_dwordx4 a[136:139], v4, s[4:7], s55 offen offset:0 sc1
  v_mfma_f32_16x16x32_bf16 v[44:47], v[88:91], a[28:31], v[44:47]
  ds_read_b128 v[88:91], v3 offset:10240
  s_waitcnt lgkmcnt(5)
  v_mfma_f32_16x16x32_bf16 v[48:51], v[92:95], a[24:27], v[48:51]
  v_mfma_f32_16x16x32_bf16 v[52:55], v[92:95], a[28:31], v[52:55]
  ds_read_b128 v[92:95], v3 offset:11264
  s_waitcnt lgkmcnt(5)
  v_mfma_f32_16x16x32_bf16 v[56:59], v[96:99], a[24:27], v[56:59]
  v_mfma_f32_16x16x32_bf16 v[60:63], v[96:99], a[28:31], v[60:63]
  ds_read_b128 v[96:99], v3 offset:12288
  s_waitcnt lgkmcnt(5)
  v_mfma_f32_16x16x32_bf16 v[64:67], v[100:103], a[24:27], v[64:67]
  v_mfma_f32_16x16x32_bf16 v[68:71], v[100:103], a[28:31], v[68:71]
  ds_read_b128 v[100:103], v3 offset:13312
  s_waitcnt lgkmcnt(5)
  v_mfma_f32_16x16x32_bf16 v[16:19], v[104:107], a[32:35], v[16:19]
  buffer_load_dwordx4 a[140:143], v4, s[4:7], s55 offen offset:256 sc1
  v_mfma_f32_16x16x32_bf16 v[20:23], v[104:107], a[36:39], v[20:23]
  ds_read_b128 v[104:107], v3 offset:14336
  s_waitcnt lgkmcnt(5)
  v_mfma_f32_16x16x32_bf16 v[24:27], v[108:111], a[32:35], v[24:27]
  v_mfma_f32_16x16x32_bf16 v[28:31], v[108:111], a[36:39], v[28:31]
  ds_read_b128 v[108:111], v3 offset:15360
  s_waitcnt lgkmcnt(5)
  v_mfma_f32_16x16x32_bf16 v[32:35], v[88:91], a[32:35], v[32:35]
  v_mfma_f32_16x16x32_bf16 v[36:39], v[88:91], a[36:39], v[36:39]
  s_barrier
  ds_read_b128 v[88:91], v1 offset:36864
  s_waitcnt lgkmcnt(5)
  v_mfma_f32_16x16x32_bf16 v[40:43], v[92:95], a[32:35], v[40:43]
  v_mfma_f32_16x16x32_bf16 v[44:47], v[92:95], a[36:39], v[44:47]
  ds_read_b128 v[92:95], v1 offset:37888
  s_waitcnt lgkmcnt(5)
  v_mfma_f32_16x16x32_bf16 v[48:51], v[96:99], a[32:35], v[48:51]
  s_add_u32 s55, s54, 65536
  buffer_load_dwordx4 a[144:147], v4, s[4:7], s55 offen offset:0 sc1
  v_mfma_f32_16x16x32_bf16 v[52:55], v[96:99], a[36:39], v[52:55]
  ds_read_b128 v[96:99], v1 offset:38912
  s_waitcnt lgkmcnt(5)
  v_mfma_f32_16x16x32_bf16 v[56:59], v[100:103], a[32:35], v[56:59]
  v_mfma_f32_16x16x32_bf16 v[60:63], v[100:103], a[36:39], v[60:63]
  ds_read_b128 v[100:103], v1 offset:39936
  s_waitcnt lgkmcnt(5)
  v_mfma_f32_16x16x32_bf16 v[64:67], v[104:107], a[32:35], v[64:67]
  v_mfma_f32_16x16x32_bf16 v[68:71], v[104:107], a[36:39], v[68:71]
  ds_read_b128 v[104:107], v1 offset:40960
  s_waitcnt lgkmcnt(5)
  v_mfma_f32_16x16x32_bf16 v[16:19], v[108:111], a[40:43], v[16:19]
  v_mfma_f32_16x16x32_bf16 v[20:23], v[108:111], a[44:47], v[20:23]
  ds_read_b128 v[108:111], v1 offset:41984
  s_waitcnt lgkmcnt(5)
  v_mfma_f32_16x16x32_bf16 v[24:27], v[88:91], a[40:43], v[24:27]
  buffer_load_dwordx4 a[148:151], v4, s[4:7], s55 offen offset:256 sc1
  v_mfma_f32_16x16x32_bf16 v[28:31], v[88:91], a[44:47], v[28:31]
  s_add_u32 s48, s61, 110592
  s_add_u32 m0, s41, 73728
  ds_read_b128 v[88:91], v1 offset:43008
  s_waitcnt lgkmcnt(5)
  v_mfma_f32_16x16x32_bf16 v[32:35], v[92:95], a[40:43], v[32:35]
  v_mfma_f32_16x16x32_bf16 v[36:39], v[92:95], a[44:47], v[36:39]
  buffer_load_dwordx4 v1, s[4:7], s48 offen offset:0 sc1 lds
  ds_read_b128 v[92:95], v1 offset:44032
  s_waitcnt lgkmcnt(5)
  v_mfma_f32_16x16x32_bf16 v[40:43], v[96:99], a[40:43], v[40:43]
  v_mfma_f32_16x16x32_bf16 v[44:47], v[96:99], a[44:47], v[44:47]
  ds_read_b128 v[96:99], v1 offset:45056
  s_waitcnt lgkmcnt(5)
  v_mfma_f32_16x16x32_bf16 v[48:51], v[100:103], a[40:43], v[48:51]
  buffer_load_dwordx4 v1, s[4:7], s48 offen offset:1024 sc1 lds
  v_mfma_f32_16x16x32_bf16 v[52:55], v[100:103], a[44:47], v[52:55]
  ds_read_b128 v[100:103], v1 offset:46080
  s_waitcnt lgkmcnt(5)
  v_mfma_f32_16x16x32_bf16 v[56:59], v[104:107], a[40:43], v[56:59]
  s_add_u32 s55, s54, 67584
  buffer_load_dwordx4 a[152:155], v4, s[4:7], s55 offen offset:0 sc1
  v_mfma_f32_16x16x32_bf16 v[60:63], v[104:107], a[44:47], v[60:63]
  buffer_load_dwordx4 v1, s[4:7], s48 offen offset:2048 sc1 lds
  ds_read_b128 v[104:107], v1 offset:47104
  s_waitcnt lgkmcnt(5)
  v_mfma_f32_16x16x32_bf16 v[64:67], v[108:111], a[40:43], v[64:67]
  v_mfma_f32_16x16x32_bf16 v[68:71], v[108:111], a[44:47], v[68:71]
  ds_read_b128 v[108:111], v1 offset:48128
  s_waitcnt lgkmcnt(5)
  v_mfma_f32_16x16x32_bf16 v[16:19], v[88:91], a[48:51], v[16:19]
  buffer_load_dwordx4 v1, s[4:7], s48 offen offset:3072 sc1 lds
  s_add_u32 s48, s48, 4096
  s_add_u32 m0, m0, 4096
  v_mfma_f32_16x16x32_bf16 v[20:23], v[88:91], a[52:55], v[20:23]
  ds_read_b128 v[88:91], v1 offset:49152
  s_waitcnt lgkmcnt(5)
  v_mfma_f32_16x16x32_bf16 v[24:27], v[92:95], a[48:51], v[24:27]
  v_mfma_f32_16x16x32_bf16 v[28:31], v[92:95], a[52:55], v[28:31]
  buffer_load_dwordx4 v1, s[4:7], s48 offen offset:0 sc1 lds
  ds_read_b128 v[92:95], v1 offset:50176
  s_waitcnt lgkmcnt(5)
  v_mfma_f32_16x16x32_bf16 v[32:35], v[96:99], a[48:51], v[32:35]
  buffer_load_dwordx4 a[156:159], v4, s[4:7], s55 offen offset:256 sc1
  v_mfma_f32_16x16x32_bf16 v[36:39], v[96:99], a[52:55], v[36:39]
  ds_read_b128 v[96:99], v1 offset:51200
  s_waitcnt lgkmcnt(5)
  v_mfma_f32_16x16x32_bf16 v[40:43], v[100:103], a[48:51], v[40:43]
  buffer_load_dwordx4 v1, s[4:7], s48 offen offset:1024 sc1 lds
  v_mfma_f32_16x16x32_bf16 v[44:47], v[100:103], a[52:55], v[44:47]
  ds_read_b128 v[100:103], v1 offset:52224
  s_waitcnt lgkmcnt(5)
  v_mfma_f32_16x16x32_bf16 v[48:51], v[104:107], a[48:51], v[48:51]
  v_mfma_f32_16x16x32_bf16 v[52:55], v[104:107], a[52:55], v[52:55]
  buffer_load_dwordx4 v1, s[4:7], s48 offen offset:2048 sc1 lds
  ds_read_b128 v[104:107], v1 offset:53248
  s_waitcnt lgkmcnt(5)
  v_mfma_f32_16x16x32_bf16 v[56:59], v[108:111], a[48:51], v[56:59]
  v_mfma_f32_16x16x32_bf16 v[60:63], v[108:111], a[52:55], v[60:63]
  ds_read_b128 v[108:111], v1 offset:54272
  s_waitcnt lgkmcnt(5)
  v_mfma_f32_16x16x32_bf16 v[64:67], v[88:91], a[48:51], v[64:67]
  buffer_load_dwordx4 v1, s[4:7], s48 offen offset:3072 sc1 lds
  s_add_u32 s48, s48, 4096
  s_add_u32 m0, m0, 4096
  v_mfma_f32_16x16x32_bf16 v[68:71], v[88:91], a[52:55], v[68:71]
  ds_read_b128 v[88:91], v1 offset:55296
  s_waitcnt lgkmcnt(5)
  v_mfma_f32_16x16x32_bf16 v[16:19], v[92:95], a[56:59], v[16:19]
  v_mfma_f32_16x16x32_bf16 v[20:23], v[92:95], a[60:63], v[20:23]
  buffer_load_dwordx4 v1, s[4:7], s48 offen offset:0 sc1 lds
  ds_read_b128 v[92:95], v1 offset:56320
  s_waitcnt lgkmcnt(5)
  v_mfma_f32_16x16x32_bf16 v[24:27], v[96:99], a[56:59], v[24:27]
  v_mfma_f32_16x16x32_bf16 v[28:31], v[96:99], a[60:63], v[28:31]
  ds_read_b128 v[96:99], v1 offset:57344
  s_waitcnt lgkmcnt(5)
  v_mfma_f32_16x16x32_bf16 v[32:35], v[100:103], a[56:59], v[32:35]
  v_mfma_f32_16x16x32_bf16 v[36:39], v[100:103], a[60:63], v[36:39]
  ds_read_b128 v[100:103], v1 offset:58368
  s_waitcnt lgkmcnt(5)
  v_mfma_f32_16x16x32_bf16 v[40:43], v[104:107], a[56:59], v[40:43]
  v_mfma_f32_16x16x32_bf16 v[44:47], v[104:107], a[60:63], v[44:47]
  ds_read_b128 v[104:107], v1 offset:59392
  s_waitcnt lgkmcnt(5)
  v_mfma_f32_16x16x32_bf16 v[48:51], v[108:111], a[56:59], v[48:51]
  v_mfma_f32_16x16x32_bf16 v[52:55], v[108:111], a[60:63], v[52:55]
  ds_read_b128 v[108:111], v1 offset:60416
  s_waitcnt lgkmcnt(5)
  v_mfma_f32_16x16x32_bf16 v[56:59], v[88:91], a[56:59], v[56:59]
  v_mfma_f32_16x16x32_bf16 v[60:63], v[88:91], a[60:63], v[60:63]
  ds_read_b128 v[88:91], v1 offset:61440
  s_waitcnt lgkmcnt(5)
  v_mfma_f32_16x16x32_bf16 v[64:67], v[92:95], a[56:59], v[64:67]
  v_mfma_f32_16x16x32_bf16 v[68:71], v[92:95], a[60:63], v[68:71]
  ds_read_b128 v[92:95], v1 offset:62464
  s_waitcnt lgkmcnt(5)
  v_mfma_f32_16x16x32_bf16 v[16:19], v[96:99], a[64:67], v[16:19]
  v_mfma_f32_16x16x32_bf16 v[20:23], v[96:99], a[68:71], v[20:23]
  ds_read_b128 v[96:99], v1 offset:63488
  s_waitcnt lgkmcnt(5)
  v_mfma_f32_16x16x32_bf16 v[24:27], v[100:103], a[64:67], v[24:27]
  v_mfma_f32_16x16x32_bf16 v[28:31], v[100:103], a[68:71], v[28:31]
  ds_read_b128 v[100:103], v1 offset:64512
  s_waitcnt lgkmcnt(5)
  v_mfma_f32_16x16x32_bf16 v[32:35], v[104:107], a[64:67], v[32:35]
  v_mfma_f32_16x16x32_bf16 v[36:39], v[104:107], a[68:71], v[36:39]
  ds_read_b128 v[104:107], v2 offset:0
  s_waitcnt lgkmcnt(5)
  v_mfma_f32_16x16x32_bf16 v[40:43], v[108:111], a[64:67], v[40:43]
  v_mfma_f32_16x16x32_bf16 v[44:47], v[108:111], a[68:71], v[44:47]
  ds_read_b128 v[108:111], v2 offset:1024
  s_waitcnt lgkmcnt(5)
  v_mfma_f32_16x16x32_bf16 v[48:51], v[88:91], a[64:67], v[48:51]
  v_mfma_f32_16x16x32_bf16 v[52:55], v[88:91], a[68:71], v[52:55]
  ds_read_b128 v[88:91], v2 offset:2048
  s_waitcnt lgkmcnt(5)
  v_mfma_f32_16x16x32_bf16 v[56:59], v[92:95], a[64:67], v[56:59]
  v_mfma_f32_16x16x32_bf16 v[60:63], v[92:95], a[68:71], v[60:63]
  ds_read_b128 v[92:95], v2 offset:3072
  s_waitcnt lgkmcnt(5)
  v_mfma_f32_16x16x32_bf16 v[64:67], v[96:99], a[64:67], v[64:67]
  v_mfma_f32_16x16x32_bf16 v[68:71], v[96:99], a[68:71], v[68:71]
  ds_read_b128 v[96:99], v2 offset:4096
  s_waitcnt lgkmcnt(5)
  v_mfma_f32_16x16x32_bf16 v[16:19], v[100:103], a[72:75], v[16:19]
  v_mfma_f32_16x16x32_bf16 v[20:23], v[100:103], a[76:79], v[20:23]
  ds_read_b128 v[100:103], v2 offset:5120
  s_waitcnt lgkmcnt(5)
  v_mfma_f32_16x16x32_bf16 v[24:27], v[104:107], a[72:75], v[24:27]
  v_mfma_f32_16x16x32_bf16 v[28:31], v[104:107], a[76:79], v[28:31]
  ds_read_b128 v[104:107], v2 offset:6144
  s_waitcnt lgkmcnt(5)
  v_mfma_f32_16x16x32_bf16 v[32:35], v[108:111], a[72:75], v[32:35]
  buffer_load_dword v193, v192, s[4:7], s58 offen sc1
  v_mfma_f32_16x16x32_bf16 v[36:39], v[108:111], a[76:79], v[36:39]
  ds_read_b128 v[108:111], v2 offset:7168
  s_waitcnt lgkmcnt(5)
  v_mfma_f32_16x16x32_bf16 v[40:43], v[88:91], a[72:75], v[40:43]
  v_mfma_f32_16x16x32_bf16 v[44:47], v[88:91], a[76:79], v[44:47]
  s_waitcnt vmcnt(18)
  s_barrier
  ds_read_b128 v[88:91], v1 offset:0
  s_waitcnt lgkmcnt(5)
  v_mfma_f32_16x16x32_bf16 v[48:51], v[92:95], a[72:75], v[48:51]
  v_mfma_f32_16x16x32_bf16 v[52:55], v[92:95], a[76:79], v[52:55]
  ds_read_b128 v[92:95], v1 offset:1024
  s_waitcnt lgkmcnt(5)
  v_mfma_f32_16x16x32_bf16 v[56:59], v[96:99], a[72:75], v[56:59]
  v_mfma_f32_16x16x32_bf16 v[60:63], v[96:99], a[76:79], v[60:63]
  ds_read_b128 v[96:99], v1 offset:2048
  s_waitcnt lgkmcnt(5)
  v_mfma_f32_16x16x32_bf16 v[64:67], v[100:103], a[72:75], v[64:67]
  v_mfma_f32_16x16x32_bf16 v[68:71], v[100:103], a[76:79], v[68:71]
  ds_read_b128 v[100:103], v1 offset:3072
  s_waitcnt lgkmcnt(5)
  v_mfma_f32_16x16x32_bf16 v[16:19], v[104:107], a[80:83], v[16:19]
  v_mfma_f32_16x16x32_bf16 v[20:23], v[104:107], a[84:87], v[20:23]
  ds_read_b128 v[104:107], v1 offset:4096
  s_waitcnt lgkmcnt(5)
  v_mfma_f32_16x16x32_bf16 v[24:27], v[108:111], a[80:83], v[24:27]
  v_mfma_f32_16x16x32_bf16 v[28:31], v[108:111], a[84:87], v[28:31]
  ds_read_b128 v[108:111], v1 offset:5120
  s_waitcnt lgkmcnt(5)
  v_mfma_f32_16x16x32_bf16 v[32:35], v[88:91], a[80:83], v[32:35]
  v_mfma_f32_16x16x32_bf16 v[36:39], v[88:91], a[84:87], v[36:39]
  s_add_u32 s48, s61, 147456
  s_add_u32 m0, s41, 110592
  ds_read_b128 v[88:91], v1 offset:6144
  s_waitcnt lgkmcnt(5)
  v_mfma_f32_16x16x32_bf16 v[40:43], v[92:95], a[80:83], v[40:43]
  v_mfma_f32_16x16x32_bf16 v[44:47], v[92:95], a[84:87], v[44:47]
  buffer_load_dwordx4 v1, s[4:7], s48 offen offset:0 sc1 lds
  ds_read_b128 v[92:95], v1 offset:7168
  s_waitcnt lgkmcnt(5)
  v_mfma_f32_16x16x32_bf16 v[48:51], v[96:99], a[80:83], v[48:51]
  v_mfma_f32_16x16x32_bf16 v[52:55], v[96:99], a[84:87], v[52:55]
  ds_read_b128 v[96:99], v1 offset:8192
  s_waitcnt lgkmcnt(5)
  v_mfma_f32_16x16x32_bf16 v[56:59], v[100:103], a[80:83], v[56:59]
  buffer_load_dwordx4 v1, s[4:7], s48 offen offset:1024 sc1 lds
  v_mfma_f32_16x16x32_bf16 v[60:63], v[100:103], a[84:87], v[60:63]
  ds_read_b128 v[100:103], v1 offset:9216
  s_waitcnt lgkmcnt(5)
  v_mfma_f32_16x16x32_bf16 v[64:67], v[104:107], a[80:83], v[64:67]
  v_mfma_f32_16x16x32_bf16 v[68:71], v[104:107], a[84:87], v[68:71]
  buffer_load_dwordx4 v1, s[4:7], s48 offen offset:2048 sc1 lds
  ds_read_b128 v[104:107], v1 offset:10240
  s_waitcnt lgkmcnt(5)
  v_mfma_f32_16x16x32_bf16 v[16:19], v[108:111], a[88:91], v[16:19]
  v_mfma_f32_16x16x32_bf16 v[20:23], v[108:111], a[92:95], v[20:23]
  ds_read_b128 v[108:111], v1 offset:11264
  s_waitcnt lgkmcnt(5)
  v_mfma_f32_16x16x32_bf16 v[24:27], v[88:91], a[88:91], v[24:27]
  buffer_load_dwordx4 v1, s[4:7], s48 offen offset:3072 sc1 lds
  s_add_u32 s48, s48, 4096
  s_add_u32 m0, m0, 4096
  v_mfma_f32_16x16x32_bf16 v[28:31], v[88:91], a[92:95], v[28:31]
  ds_read_b128 v[88:91], v1 offset:12288
  s_waitcnt lgkmcnt(5)
  v_mfma_f32_16x16x32_bf16 v[32:35], v[92:95], a[88:91], v[32:35]
  v_mfma_f32_16x16x32_bf16 v[36:39], v[92:95], a[92:95], v[36:39]
  buffer_load_dwordx4 v1, s[4:7], s48 offen offset:0 sc1 lds
  ds_read_b128 v[92:95], v1 offset:13312
  s_waitcnt lgkmcnt(5)
  v_mfma_f32_16x16x32_bf16 v[40:43], v[96:99], a[88:91], v[40:43]
  v_mfma_f32_16x16x32_bf16 v[44:47], v[96:99], a[92:95], v[44:47]
  ds_read_b128 v[96:99], v1 offset:14336
  s_waitcnt lgkmcnt(5)
  v_mfma_f32_16x16x32_bf16 v[48:51], v[100:103], a[88:91], v[48:51]
  buffer_load_dwordx4 v1, s[4:7], s48 offen offset:1024 sc1 lds
  v_mfma_f32_16x16x32_bf16 v[52:55], v[100:103], a[92:95], v[52:55]
  ds_read_b128 v[100:103], v1 offset:15360
  s_waitcnt lgkmcnt(5)
  v_mfma_f32_16x16x32_bf16 v[56:59], v[104:107], a[88:91], v[56:59]
  v_mfma_f32_16x16x32_bf16 v[60:63], v[104:107], a[92:95], v[60:63]
  buffer_load_dwordx4 v1, s[4:7], s48 offen offset:2048 sc1 lds
  ds_read_b128 v[104:107], v1 offset:16384
  s_waitcnt lgkmcnt(5)
  v_mfma_f32_16x16x32_bf16 v[64:67], v[108:111], a[88:91], v[64:67]
  v_mfma_f32_16x16x32_bf16 v[68:71], v[108:111], a[92:95], v[68:71]
  ds_read_b128 v[108:111], v1 offset:17408
  s_waitcnt lgkmcnt(5)
  v_mfma_f32_16x16x32_bf16 v[16:19], v[88:91], a[96:99], v[16:19]
  buffer_load_dwordx4 v1, s[4:7], s48 offen offset:3072 sc1 lds
  s_add_u32 s48, s48, 4096
  s_add_u32 m0, m0, 4096
  v_mfma_f32_16x16x32_bf16 v[20:23], v[88:91], a[100:103], v[20:23]
  ds_read_b128 v[88:91], v1 offset:18432
  s_waitcnt lgkmcnt(5)
  v_mfma_f32_16x16x32_bf16 v[24:27], v[92:95], a[96:99], v[24:27]
  s_waitcnt vmcnt(8)
  s_mov_b32 s47, 0
B2_hs1:
  v_readfirstlane_b32 s46, v193
  s_nop 0
  s_cmp_eq_u32 s46, 8
  s_cbranch_scc1 B2_hok1
  s_add_u32 s47, s47, 1
  s_cmp_gt_u32 s47, 0x20000
  s_cbranch_scc1 B2_hok1
  buffer_load_dword v193, v192, s[4:7], s58 offen sc1
  s_waitcnt vmcnt(0)
  s_branch B2_hs1
B2_hok1:
  v_mfma_f32_16x16x32_bf16 v[28:31], v[92:95], a[100:103], v[28:31]
  buffer_load_dwordx4 v1, s[4:7], s48 offen offset:0 sc1 lds
  ds_read_b128 v[92:95], v1 offset:19456
  s_waitcnt lgkmcnt(5)
  v_mfma_f32_16x16x32_bf16 v[32:35], v[96:99], a[96:99], v[32:35]
  s_add_u32 s55, s54, 6144
  buffer_load_dwordx4 a[160:163], v4, s[4:7], s55 offen offset:0 sc1
  v_mfma_f32_16x16x32_bf16 v[36:39], v[96:99], a[100:103], v[36:39]
  ds_read_b128 v[96:99], v1 offset:20480
  s_waitcnt lgkmcnt(5)
  v_mfma_f32_16x16x32_bf16 v[40:43], v[100:103], a[96:99], v[40:43]
  v_mfma_f32_16x16x32_bf16 v[44:47], v[100:103], a[100:103], v[44:47]
  ds_read_b128 v[100:103], v1 offset:21504
  s_waitcnt lgkmcnt(5)
  v_mfma_f32_16x16x32_bf16 v[48:51], v[104:107], a[96:99], v[48:51]
  v_mfma_f32_16x16x32_bf16 v[52:55], v[104:107], a[100:103], v[52:55]
  ds_read_b128 v[104:107], v1 offset:22528
  s_waitcnt lgkmcnt(5)
  v_mfma_f32_16x16x32_bf16 v[56:59], v[108:111], a[96:99], v[56:59]
  buffer_load_dwordx4 a[164:167], v4, s[4:7], s55 offen offset:256 sc1
  v_mfma_f32_16x16x32_bf16 v[60:63], v[108:111], a[100:103], v[60:63]
  ds_read_b128 v[108:111], v1 offset:23552
  s_waitcnt lgkmcnt(5)
  v_mfma_f32_16x16x32_bf16 v[64:67], v[88:91], a[96:99], v[64:67]
  v_mfma_f32_16x16x32_bf16 v[68:71], v[88:91], a[100:103], v[68:71]
  ds_read_b128 v[88:91], v1 offset:24576
  s_waitcnt lgkmcnt(5)
  v_mfma_f32_16x16x32_bf16 v[16:19], v[92:95], a[104:107], v[16:19]
  v_mfma_f32_16x16x32_bf16 v[20:23], v[92:95], a[108:111], v[20:23]
  ds_read_b128 v[92:95], v1 offset:25600
  s_waitcnt lgkmcnt(5)
  v_mfma_f32_16x16x32_bf16 v[24:27], v[96:99], a[104:107], v[24:27]
  v_mfma_f32_16x16x32_bf16 v[28:31], v[96:99], a[108:111], v[28:31]
  s_add_u32 s55, s54, 8192
  buffer_load_dwordx4 a[168:171], v4, s[4:7], s55 offen offset:0 sc1
  ds_read_b128 v[96:99], v1 offset:26624
  s_waitcnt lgkmcnt(5)
  v_mfma_f32_16x16x32_bf16 v[32:35], v[100:103], a[104:107], v[32:35]
  v_mfma_f32_16x16x32_bf16 v[36:39], v[100:103], a[108:111], v[36:39]
  ds_read_b128 v[100:103], v1 offset:27648
  s_waitcnt lgkmcnt(5)
  v_mfma_f32_16x16x32_bf16 v[40:43], v[104:107], a[104:107], v[40:43]
  v_mfma_f32_16x16x32_bf16 v[44:47], v[104:107], a[108:111], v[44:47]
  ds_read_b128 v[104:107], v1 offset:28672
  s_waitcnt lgkmcnt(5)
  v_mfma_f32_16x16x32_bf16 v[48:51], v[108:111], a[104:107], v[48:51]
  v_mfma_f32_16x16x32_bf16 v[52:55], v[108:111], a[108:111], v[52:55]
  buffer_load_dwordx4 a[172:175], v4, s[4:7], s55 offen offset:256 sc1
  ds_read_b128 v[108:111], v1 offset:29696
  s_waitcnt lgkmcnt(5)
  v_mfma_f32_16x16x32_bf16 v[56:59], v[88:91], a[104:107], v[56:59]
  v_mfma_f32_16x16x32_bf16 v[60:63], v[88:91], a[108:111], v[60:63]
  ds_read_b128 v[88:91], v1 offset:30720
  s_waitcnt lgkmcnt(5)
  v_mfma_f32_16x16x32_bf16 v[64:67], v[92:95], a[104:107], v[64:67]
  v_mfma_f32_16x16x32_bf16 v[68:71], v[92:95], a[108:111], v[68:71]
  ds_read_b128 v[92:95], v1 offset:31744
  s_waitcnt lgkmcnt(5)
  v_mfma_f32_16x16x32_bf16 v[16:19], v[96:99], a[112:115], v[16:19]
  v_mfma_f32_16x16x32_bf16 v[20:23], v[96:99], a[116:119], v[20:23]
  ds_read_b128 v[96:99], v1 offset:32768
  s_waitcnt lgkmcnt(5)
  v_mfma_f32_16x16x32_bf16 v[24:27], v[100:103], a[112:115], v[24:27]
  s_add_u32 s55, s54, 14336
  buffer_load_dwordx4 a[176:179], v4, s[4:7], s55 offen offset:0 sc1
  v_mfma_f32_16x16x32_bf16 v[28:31], v[100:103], a[116:119], v[28:31]
  ds_read_b128 v[100:103], v1 offset:33792
  s_waitcnt lgkmcnt(5)
  v_mfma_f32_16x16x32_bf16 v[32:35], v[104:107], a[112:115], v[32:35]
  v_mfma_f32_16x16x32_bf16 v[36:39], v[104:107], a[116:119], v[36:39]
  ds_read_b128 v[104:107], v1 offset:34816
  s_waitcnt lgkmcnt(5)
  v_mfma_f32_16x16x32_bf16 v[40:43], v[108:111], a[112:115], v[40:43]
  v_mfma_f32_16x16x32_bf16 v[44:47], v[108:111], a[116:119], v[44:47]
  ds_read_b128 v[108:111], v1 offset:35840
  s_waitcnt lgkmcnt(5)
  v_mfma_f32_16x16x32_bf16 v[48:51], v[88:91], a[112:115], v[48:51]
  buffer_load_dwordx4 a[180:183], v4, s[4:7], s55 offen offset:256 sc1
  v_mfma_f32_16x16x32_bf16 v[52:55], v[88:91], a[116:119], v[52:55]
  s_barrier
  ds_read_b128 v[88:91], v2 offset:8192
  s_waitcnt lgkmcnt(5)
  v_mfma_f32_16x16x32_bf16 v[56:59], v[92:95], a[112:115], v[56:59]
  v_mfma_f32_16x16x32_bf16 v[60:63], v[92:95], a[116:119], v[60:63]
  ds_read_b128 v[92:95], v2 offset:9216
  s_waitcnt lgkmcnt(5)
  v_mfma_f32_16x16x32_bf16 v[64:67], v[96:99], a[112:115], v[64:67]
  v_mfma_f32_16x16x32_bf16 v[68:71], v[96:99], a[116:119], v[68:71]
  ds_read_b128 v[96:99], v2 offset:10240
  s_waitcnt lgkmcnt(5)
  v_mfma_f32_16x16x32_bf16 v[16:19], v[100:103], a[120:123], v[16:19]
  v_mfma_f32_16x16x32_bf16 v[20:23], v[100:103], a[124:127], v[20:23]
  s_add_u32 s55, s54, 16384
  buffer_load_dwordx4 a[184:187], v4, s[4:7], s55 offen offset:0 sc1
  ds_read_b128 v[100:103], v2 offset:11264
  s_waitcnt lgkmcnt(5)
  v_mfma_f32_16x16x32_bf16 v[24:27], v[104:107], a[120:123], v[24:27]
  v_mfma_f32_16x16x32_bf16 v[28:31], v[104:107], a[124:127], v[28:31]
  ds_read_b128 v[104:107], v2 offset:12288
  s_waitcnt lgkmcnt(5)
  v_mfma_f32_16x16x32_bf16 v[32:35], v[108:111], a[120:123], v[32:35]
  v_mfma_f32_16x16x32_bf16 v[36:39], v[108:111], a[124:127], v[36:39]
  ds_read_b128 v[108:111], v2 offset:13312
  s_waitcnt lgkmcnt(5)
  v_mfma_f32_16x16x32_bf16 v[40:43], v[88:91], a[120:123], v[40:43]
  v_mfma_f32_16x16x32_bf16 v[44:47], v[88:91], a[124:127], v[44:47]
  s_add_u32 s48, s61, 184320
  s_add_u32 m0, s41, 36864
  buffer_load_dwordx4 a[188:191], v4, s[4:7], s55 offen offset:256 sc1
  ds_read_b128 v[88:91], v2 offset:14336
  s_waitcnt lgkmcnt(5)
  v_mfma_f32_16x16x32_bf16 v[48:51], v[92:95], a[120:123], v[48:51]
  v_mfma_f32_16x16x32_bf16 v[52:55], v[92:95], a[124:127], v[52:55]
  buffer_load_dwordx4 v1, s[4:7], s48 offen offset:0 sc1 lds
  ds_read_b128 v[92:95], v2 offset:15360
  s_waitcnt lgkmcnt(5)
  v_mfma_f32_16x16x32_bf16 v[56:59], v[96:99], a[120:123], v[56:59]
  v_mfma_f32_16x16x32_bf16 v[60:63], v[96:99], a[124:127], v[60:63]
  ds_read_b128 v[96:99], v2 offset:16384
  s_waitcnt lgkmcnt(5)
  v_mfma_f32_16x16x32_bf16 v[64:67], v[100:103], a[120:123], v[64:67]
  buffer_load_dwordx4 v1, s[4:7], s48 offen offset:1024 sc1 lds
  v_mfma_f32_16x16x32_bf16 v[68:71], v[100:103], a[124:127], v[68:71]
  ds_read_b128 v[100:103], v2 offset:17408
  s_waitcnt lgkmcnt(5)
  v_mfma_f32_16x16x32_bf16 v[16:19], v[104:107], a[128:131], v[16:19]
  s_add_u32 s55, s54, 24576
  buffer_load_dwordx4 a[192:195], v4, s[4:7], s55 offen offset:0 sc1
  v_mfma_f32_16x16x32_bf16 v[20:23], v[104:107], a[132:135], v[20:23]
  buffer_load_dwordx4 v1, s[4:7], s48 offen offset:2048 sc1 lds
  ds_read_b128 v[104:107], v2 offset:18432
  s_waitcnt lgkmcnt(5)
  v_mfma_f32_16x16x32_bf16 v[24:27], v[108:111], a[128:131], v[24:27]
  v_mfma_f32_16x16x32_bf16 v[28:31], v[108:111], a[132:135], v[28:31]
  ds_read_b128 v[108:111], v2 offset:19456
  s_waitcnt lgkmcnt(5)
  v_mfma_f32_16x16x32_bf16 v[32:35], v[88:91], a[128:131], v[32:35]
  buffer_load_dwordx4 v1, s[4:7], s48 offen offset:3072 sc1 lds
  s_add_u32 s48, s48, 4096
  s_add_u32 m0, m0, 4096
  v_mfma_f32_16x16x32_bf16 v[36:39], v[88:91], a[132:135], v[36:39]
  ds_read_b128 v[88:91], v2 offset:20480
  s_waitcnt lgkmcnt(5)
  v_mfma_f32_16x16x32_bf16 v[40:43], v[92:95], a[128:131], v[40:43]
  v_mfma_f32_16x16x32_bf16 v[44:47], v[92:95], a[132:135], v[44:47]
  buffer_load_dwordx4 v1, s[4:7], s48 offen offset:0 sc1 lds
  buffer_load_dwordx4 a[196:199], v4, s[4:7], s55 offen offset:256 sc1
  ds_read_b128 v[92:95], v2 offset:21504
  s_waitcnt lgkmcnt(5)
  v_mfma_f32_16x16x32_bf16 v[48:51], v[96:99], a[128:131], v[48:51]
  v_mfma_f32_16x16x32_bf16 v[52:55], v[96:99], a[132:135], v[52:55]
  ds_read_b128 v[96:99], v2 offset:22528
  s_waitcnt lgkmcnt(5)
  v_mfma_f32_16x16x32_bf16 v[56:59], v[100:103], a[128:131], v[56:59]
  buffer_load_dwordx4 v1, s[4:7], s48 offen offset:1024 sc1 lds
  v_mfma_f32_16x16x32_bf16 v[60:63], v[100:103], a[132:135], v[60:63]
  ds_read_b128 v[100:103], v2 offset:23552
  s_waitcnt lgkmcnt(5)
  v_mfma_f32_16x16x32_bf16 v[64:67], v[104:107], a[128:131], v[64:67]
  v_mfma_f32_16x16x32_bf16 v[68:71], v[104:107], a[132:135], v[68:71]
  buffer_load_dwordx4 v1, s[4:7], s48 offen offset:2048 sc1 lds
  s_add_u32 s55, s54, 26624
  buffer_load_dwordx4 a[200:203], v4, s[4:7], s55 offen offset:0 sc1
  ds_read_b128 v[104:107], v2 offset:24576
  s_waitcnt lgkmcnt(5)
  v_mfma_f32_16x16x32_bf16 v[16:19], v[108:111], a[136:139], v[16:19]
  v_mfma_f32_16x16x32_bf16 v[20:23], v[108:111], a[140:143], v[20:23]
  ds_read_b128 v[108:111], v2 offset:25600
  s_waitcnt lgkmcnt(5)
  v_mfma_f32_16x16x32_bf16 v[24:27], v[88:91], a[136:139], v[24:27]
  buffer_load_dwordx4 v1, s[4:7], s48 offen offset:3072 sc1 lds
  s_add_u32 s48, s48, 4096
  s_add_u32 m0, m0, 4096
  v_mfma_f32_16x16x32_bf16 v[28:31], v[88:91], a[140:143], v[28:31]
  ds_read_b128 v[88:91], v2 offset:26624
  s_waitcnt lgkmcnt(5)
  v_mfma_f32_16x16x32_bf16 v[32:35], v[92:95], a[136:139], v[32:35]
  v_mfma_f32_16x16x32_bf16 v[36:39], v[92:95], a[140:143], v[36:39]
  buffer_load_dwordx4 v1, s[4:7], s48 offen offset:0 sc1 lds
  ds_read_b128 v[92:95], v2 offset:27648
  s_waitcnt lgkmcnt(5)
  v_mfma_f32_16x16x32_bf16 v[40:43], v[96:99], a[136:139], v[40:43]
  buffer_load_dwordx4 a[204:207], v4, s[4:7], s55 offen offset:256 sc1
  v_mfma_f32_16x16x32_bf16 v[44:47], v[96:99], a[140:143], v[44:47]
  ds_read_b128 v[96:99], v2 offset:28672
  s_waitcnt lgkmcnt(5)
  v_mfma_f32_16x16x32_bf16 v[48:51], v[100:103], a[136:139], v[48:51]
  v_mfma_f32_16x16x32_bf16 v[52:55], v[100:103], a[140:143], v[52:55]
  ds_read_b128 v[100:103], v2 offset:29696
  s_waitcnt lgkmcnt(5)
  v_mfma_f32_16x16x32_bf16 v[56:59], v[104:107], a[136:139], v[56:59]
  v_mfma_f32_16x16x32_bf16 v[60:63], v[104:107], a[140:143], v[60:63]
  ds_read_b128 v[104:107], v2 offset:30720
  s_waitcnt lgkmcnt(5)
  v_mfma_f32_16x16x32_bf16 v[64:67], v[108:111], a[136:139], v[64:67]
  s_add_u32 s55, s54, 32768
  buffer_load_dwordx4 a[208:211], v4, s[4:7], s55 offen offset:0 sc1
  v_mfma_f32_16x16x32_bf16 v[68:71], v[108:111], a[140:143], v[68:71]
  ds_read_b128 v[108:111], v2 offset:31744
  s_waitcnt lgkmcnt(5)
  v_mfma_f32_16x16x32_bf16 v[16:19], v[88:91], a[144:147], v[16:19]
  v_mfma_f32_16x16x32_bf16 v[20:23], v[88:91], a[148:151], v[20:23]
  ds_read_b128 v[88:91], v2 offset:32768
  s_waitcnt lgkmcnt(5)
  v_mfma_f32_16x16x32_bf16 v[24:27], v[92:95], a[144:147], v[24:27]
  v_mfma_f32_16x16x32_bf16 v[28:31], v[92:95], a[148:151], v[28:31]
  ds_read_b128 v[92:95], v2 offset:33792
  s_waitcnt lgkmcnt(5)
  v_mfma_f32_16x16x32_bf16 v[32:35], v[96:99], a[144:147], v[32:35]
  v_mfma_f32_16x16x32_bf16 v[36:39], v[96:99], a[148:151], v[36:39]
  buffer_load_dwordx4 a[212:215], v4, s[4:7], s55 offen offset:256 sc1
  ds_read_b128 v[96:99], v2 offset:34816
  s_waitcnt lgkmcnt(5)
  v_mfma_f32_16x16x32_bf16 v[40:43], v[100:103], a[144:147], v[40:43]
  v_mfma_f32_16x16x32_bf16 v[44:47], v[100:103], a[148:151], v[44:47]
  ds_read_b128 v[100:103], v2 offset:35840
  s_waitcnt lgkmcnt(5)
  v_mfma_f32_16x16x32_bf16 v[48:51], v[104:107], a[144:147], v[48:51]
  v_mfma_f32_16x16x32_bf16 v[52:55], v[104:107], a[148:151], v[52:55]
  ds_read_b128 v[104:107], v2 offset:36864
  s_waitcnt lgkmcnt(5)
  v_mfma_f32_16x16x32_bf16 v[56:59], v[108:111], a[144:147], v[56:59]
  v_mfma_f32_16x16x32_bf16 v[60:63], v[108:111], a[148:151], v[60:63]
  s_add_u32 s55, s54, 34816
  buffer_load_dwordx4 a[216:219], v4, s[4:7], s55 offen offset:0 sc1
  ds_read_b128 v[108:111], v2 offset:37888
  s_waitcnt lgkmcnt(5)
  v_mfma_f32_16x16x32_bf16 v[64:67], v[88:91], a[144:147], v[64:67]
  v_mfma_f32_16x16x32_bf16 v[68:71], v[88:91], a[148:151], v[68:71]
  ds_read_b128 v[88:91], v2 offset:38912
  s_waitcnt lgkmcnt(5)
  v_mfma_f32_16x16x32_bf16 v[16:19], v[92:95], a[152:155], v[16:19]
  v_mfma_f32_16x16x32_bf16 v[20:23], v[92:95], a[156:159], v[20:23]
  ds_read_b128 v[92:95], v2 offset:39936
  s_waitcnt lgkmcnt(5)
  v_mfma_f32_16x16x32_bf16 v[24:27], v[96:99], a[152:155], v[24:27]
  v_mfma_f32_16x16x32_bf16 v[28:31], v[96:99], a[156:159], v[28:31]
  ds_read_b128 v[96:99], v2 offset:40960
  s_waitcnt lgkmcnt(5)
  v_mfma_f32_16x16x32_bf16 v[32:35], v[100:103], a[152:155], v[32:35]
  buffer_load_dwordx4 a[220:223], v4, s[4:7], s55 offen offset:256 sc1
  v_mfma_f32_16x16x32_bf16 v[36:39], v[100:103], a[156:159], v[36:39]
  ds_read_b128 v[100:103], v2 offset:41984
  s_waitcnt lgkmcnt(5)
  v_mfma_f32_16x16x32_bf16 v[40:43], v[104:107], a[152:155], v[40:43]
  v_mfma_f32_16x16x32_bf16 v[44:47], v[104:107], a[156:159], v[44:47]
  ds_read_b128 v[104:107], v2 offset:43008
  s_waitcnt lgkmcnt(5)
  v_mfma_f32_16x16x32_bf16 v[48:51], v[108:111], a[152:155], v[48:51]
  v_mfma_f32_16x16x32_bf16 v[52:55], v[108:111], a[156:159], v[52:55]
  ds_read_b128 v[108:111], v2 offset:44032
  s_waitcnt lgkmcnt(5)
  v_mfma_f32_16x16x32_bf16 v[56:59], v[88:91], a[152:155], v[56:59]
  v_mfma_f32_16x16x32_bf16 v[60:63], v[88:91], a[156:159], v[60:63]
  s_add_u32 s55, s54, 43008
  buffer_load_dwordx4 a[224:227], v4, s[4:7], s55 offen offset:0 sc1
  s_waitcnt vmcnt(26)
  s_barrier
  ds_read_b128 v[88:91], v2 offset:45056
  s_waitcnt lgkmcnt(5)
  v_mfma_f32_16x16x32_bf16 v[64:67], v[92:95], a[152:155], v[64:67]
  v_mfma_f32_16x16x32_bf16 v[68:71], v[92:95], a[156:159], v[68:71]
  ds_read_b128 v[92:95], v2 offset:46080
  s_waitcnt vmcnt(24)
  s_waitcnt lgkmcnt(5)
  v_mfma_f32_16x16x32_bf16 v[16:19], v[96:99], a[160:163], v[16:19]
  v_mfma_f32_16x16x32_bf16 v[20:23], v[96:99], a[164:167], v[20:23]
  ds_read_b128 v[96:99], v2 offset:47104
  s_waitcnt lgkmcnt(5)
  v_mfma_f32_16x16x32_bf16 v[24:27], v[100:103], a[160:163], v[24:27]
  v_mfma_f32_16x16x32_bf16 v[28:31], v[100:103], a[164:167], v[28:31]
  buffer_load_dwordx4 a[228:231], v4, s[4:7], s55 offen offset:256 sc1
  ds_read_b128 v[100:103], v2 offset:48128
  s_waitcnt lgkmcnt(5)
  v_mfma_f32_16x16x32_bf16 v[32:35], v[104:107], a[160:163], v[32:35]
  v_mfma_f32_16x16x32_bf16 v[36:39], v[104:107], a[164:167], v[36:39]
  ds_read_b128 v[104:107], v2 offset:49152
  s_waitcnt lgkmcnt(5)
  v_mfma_f32_16x16x32_bf16 v[40:43], v[108:111], a[160:163], v[40:43]
  v_mfma_f32_16x16x32_bf16 v[44:47], v[108:111], a[164:167], v[44:47]
  ds_read_b128 v[108:111], v2 offset:50176
  s_waitcnt lgkmcnt(5)
  v_mfma_f32_16x16x32_bf16 v[48:51], v[88:91], a[160:163], v[48:51]
  v_mfma_f32_16x16x32_bf16 v[52:55], v[88:91], a[164:167], v[52:55]
  s_add_u32 s48, s61, 221184
  s_add_u32 m0, s41, 0
  ds_read_b128 v[88:91], v2 offset:51200
  s_waitcnt vmcnt(23)
  s_waitcnt lgkmcnt(5)
  v_mfma_f32_16x16x32_bf16 v[16:19], v[92:95], a[168:171], v[16:19]
  s_add_u32 s55, s54, 45056
  buffer_load_dwordx4 a[232:235], v4, s[4:7], s55 offen offset:0 sc1
  v_mfma_f32_16x16x32_bf16 v[20:23], v[92:95], a[172:175], v[20:23]
  buffer_load_dwordx4 v1, s[4:7], s48 offen offset:0 sc1 lds
  ds_read_b128 v[92:95], v2 offset:52224
  s_waitcnt lgkmcnt(5)
  v_mfma_f32_16x16x32_bf16 v[24:27], v[96:99], a[168:171], v[24:27]
  v_mfma_f32_16x16x32_bf16 v[28:31], v[96:99], a[172:175], v[28:31]
  ds_read_b128 v[96:99], v2 offset:53248
  s_waitcnt lgkmcnt(5)
  v_mfma_f32_16x16x32_bf16 v[32:35], v[100:103], a[168:171], v[32:35]
  buffer_load_dwordx4 v1, s[4:7], s48 offen offset:1024 sc1 lds
  v_mfma_f32_16x16x32_bf16 v[36:39], v[100:103], a[172:175], v[36:39]
  ds_read_b128 v[100:103], v2 offset:54272
  s_waitcnt lgkmcnt(5)
  v_mfma_f32_16x16x32_bf16 v[40:43], v[104:107], a[168:171], v[40:43]
  buffer_load_dwordx4 a[236:239], v4, s[4:7], s55 offen offset:256 sc1
  v_mfma_f32_16x16x32_bf16 v[44:47], v[104:107], a[172:175], v[44:47]
  buffer_load_dwordx4 v1, s[4:7], s48 offen offset:2048 sc1 lds
  ds_read_b128 v[104:107], v2 offset:55296
  s_waitcnt lgkmcnt(5)
  v_mfma_f32_16x16x32_bf16 v[48:51], v[108:111], a[168:171], v[48:51]
  v_mfma_f32_16x16x32_bf16 v[52:55], v[108:111], a[172:175], v[52:55]
  ds_read_b128 v[108:111], v2 offset:56320
  s_waitcnt vmcnt(26)
  s_waitcnt lgkmcnt(5)
  v_mfma_f32_16x16x32_bf16 v[16:19], v[88:91], a[176:179], v[16:19]
  buffer_load_dwordx4 v1, s[4:7], s48 offen offset:3072 sc1 lds
  s_add_u32 s48, s48, 4096
  s_add_u32 m0, m0, 4096
  v_mfma_f32_16x16x32_bf16 v[20:23], v[88:91], a[180:183], v[20:23]
  ds_read_b128 v[88:91], v2 offset:57344
  s_waitcnt lgkmcnt(5)
  v_mfma_f32_16x16x32_bf16 v[24:27], v[92:95], a[176:179], v[24:27]
  v_mfma_f32_16x16x32_bf16 v[28:31], v[92:95], a[180:183], v[28:31]
  buffer_load_dwordx4 v1, s[4:7], s48 offen offset:0 sc1 lds
  s_add_u32 s55, s54, 51200
  buffer_load_dwordx4 a[240:243], v4, s[4:7], s55 offen offset:0 sc1
  ds_read_b128 v[92:95], v2 offset:58368
  s_waitcnt lgkmcnt(5)
  v_mfma_f32_16x16x32_bf16 v[32:35], v[96:99], a[176:179], v[32:35]
  v_mfma_f32_16x16x32_bf16 v[36:39], v[96:99], a[180:183], v[36:39]
  ds_read_b128 v[96:99], v2 offset:59392
  s_waitcnt lgkmcnt(5)
  v_mfma_f32_16x16x32_bf16 v[40:43], v[100:103], a[176:179], v[40:43]
  buffer_load_dwordx4 v1, s[4:7], s48 offen offset:1024 sc1 lds
  v_mfma_f32_16x16x32_bf16 v[44:47], v[100:103], a[180:183], v[44:47]
  ds_read_b128 v[100:103], v2 offset:60416
  s_waitcnt lgkmcnt(5)
  v_mfma_f32_16x16x32_bf16 v[48:51], v[104:107], a[176:179], v[48:51]
  v_mfma_f32_16x16x32_bf16 v[52:55], v[104:107], a[180:183], v[52:55]
  buffer_load_dwordx4 v1, s[4:7], s48 offen offset:2048 sc1 lds
  buffer_load_dwordx4 a[244:247], v4, s[4:7], s55 offen offset:256 sc1
  ds_read_b128 v[104:107], v2 offset:61440
  s_waitcnt vmcnt(30)
  s_waitcnt lgkmcnt(5)
  v_mfma_f32_16x16x32_bf16 v[16:19], v[108:111], a[184:187], v[16:19]
  v_mfma_f32_16x16x32_bf16 v[20:23], v[108:111], a[188:191], v[20:23]
  ds_read_b128 v[108:111], v2 offset:62464
  s_waitcnt lgkmcnt(5)
  v_mfma_f32_16x16x32_bf16 v[24:27], v[88:91], a[184:187], v[24:27]
  buffer_load_dwordx4 v1, s[4:7], s48 offen offset:3072 sc1 lds
  s_add_u32 s48, s48, 4096
  s_add_u32 m0, m0, 4096
  v_mfma_f32_16x16x32_bf16 v[28:31], v[88:91], a[188:191], v[28:31]
  ds_read_b128 v[88:91], v2 offset:63488
  s_waitcnt lgkmcnt(5)
  v_mfma_f32_16x16x32_bf16 v[32:35], v[92:95], a[184:187], v[32:35]
  v_mfma_f32_16x16x32_bf16 v[36:39], v[92:95], a[188:191], v[36:39]
  buffer_load_dwordx4 v1, s[4:7], s48 offen offset:0 sc1 lds
  ds_read_b128 v[92:95], v2 offset:64512
  s_waitcnt lgkmcnt(5)
  v_mfma_f32_16x16x32_bf16 v[40:43], v[96:99], a[184:187], v[40:43]
  s_add_u32 s55, s54, 53248
  buffer_load_dwordx4 a[248:251], v4, s[4:7], s55 offen offset:0 sc1
  v_mfma_f32_16x16x32_bf16 v[44:47], v[96:99], a[188:191], v[44:47]
  ds_read_b128 v[96:99], v3 offset:0
  s_waitcnt lgkmcnt(5)
  v_mfma_f32_16x16x32_bf16 v[48:51], v[100:103], a[184:187], v[48:51]
  v_mfma_f32_16x16x32_bf16 v[52:55], v[100:103], a[188:191], v[52:55]
  ds_read_b128 v[100:103], v3 offset:1024
  s_waitcnt vmcnt(26)
  s_waitcnt lgkmcnt(5)
  v_mfma_f32_16x16x32_bf16 v[16:19], v[104:107], a[192:195], v[16:19]
  buffer_load_dwordx4 a[252:255], v4, s[4:7], s55 offen offset:256 sc1
  v_mfma_f32_16x16x32_bf16 v[20:23], v[104:107], a[196:199], v[20:23]
  ds_read_b128 v[104:107], v3 offset:2048
  s_waitcnt lgkmcnt(5)
  v_mfma_f32_16x16x32_bf16 v[24:27], v[108:111], a[192:195], v[24:27]
  v_mfma_f32_16x16x32_bf16 v[28:31], v[108:111], a[196:199], v[28:31]
  ds_read_b128 v[108:111], v3 offset:3072
  s_waitcnt lgkmcnt(5)
  v_mfma_f32_16x16x32_bf16 v[32:35], v[88:91], a[192:195], v[32:35]
  v_mfma_f32_16x16x32_bf16 v[36:39], v[88:91], a[196:199], v[36:39]
  ds_read_b128 v[88:91], v3 offset:4096
  s_waitcnt lgkmcnt(5)
  v_mfma_f32_16x16x32_bf16 v[40:43], v[92:95], a[192:195], v[40:43]
  v_mfma_f32_16x16x32_bf16 v[44:47], v[92:95], a[196:199], v[44:47]
  ds_read_b128 v[92:95], v3 offset:5120
  s_waitcnt lgkmcnt(5)
  v_mfma_f32_16x16x32_bf16 v[48:51], v[96:99], a[192:195], v[48:51]
  v_mfma_f32_16x16x32_bf16 v[52:55], v[96:99], a[196:199], v[52:55]
  s_add_u32 s55, s54, 61440
  buffer_load_dwordx4 v[224:227], v4, s[4:7], s55 offen offset:0 sc1
  ds_read_b128 v[96:99], v3 offset:6144
  s_waitcnt vmcnt(22)
  s_waitcnt lgkmcnt(5)
  v_mfma_f32_16x16x32_bf16 v[16:19], v[100:103], a[200:203], v[16:19]
  buffer_load_dwordx4 v[228:231], v4, s[4:7], s55 offen offset:256 sc1
  v_mfma_f32_16x16x32_bf16 v[20:23], v[100:103], a[204:207], v[20:23]
  ds_read_b128 v[100:103], v3 offset:7168
  s_waitcnt lgkmcnt(5)
  v_mfma_f32_16x16x32_bf16 v[24:27], v[104:107], a[200:203], v[24:27]
  v_mfma_f32_16x16x32_bf16 v[28:31], v[104:107], a[204:207], v[28:31]
  ds_read_b128 v[104:107], v3 offset:8192
  s_waitcnt lgkmcnt(5)
  v_mfma_f32_16x16x32_bf16 v[32:35], v[108:111], a[200:203], v[32:35]
  v_mfma_f32_16x16x32_bf16 v[36:39], v[108:111], a[204:207], v[36:39]
  ds_read_b128 v[108:111], v3 offset:9216
  s_waitcnt lgkmcnt(5)
  v_mfma_f32_16x16x32_bf16 v[40:43], v[88:91], a[200:203], v[40:43]
  v_mfma_f32_16x16x32_bf16 v[44:47], v[88:91], a[204:207], v[44:47]
  ds_read_b128 v[88:91], v3 offset:10240
  s_waitcnt lgkmcnt(5)
  v_mfma_f32_16x16x32_bf16 v[48:51], v[92:95], a[200:203], v[48:51]
  v_mfma_f32_16x16x32_bf16 v[52:55], v[92:95], a[204:207], v[52:55]
  ds_read_b128 v[92:95], v3 offset:11264
  s_waitcnt vmcnt(21)
  s_waitcnt lgkmcnt(5)
  v_mfma_f32_16x16x32_bf16 v[16:19], v[96:99], a[208:211], v[16:19]
  s_add_u32 s55, s54, 63488
  buffer_load_dwordx4 v[232:235], v4, s[4:7], s55 offen offset:0 sc1
  buffer_load_dwordx4 v[236:239], v4, s[4:7], s55 offen offset:256 sc1
  v_mfma_f32_16x16x32_bf16 v[20:23], v[96:99], a[212:215], v[20:23]
  ds_read_b128 v[96:99], v3 offset:12288
  s_waitcnt lgkmcnt(5)
  v_mfma_f32_16x16x32_bf16 v[24:27], v[100:103], a[208:211], v[24:27]
  v_mfma_f32_16x16x32_bf16 v[28:31], v[100:103], a[212:215], v[28:31]
  ds_read_b128 v[100:103], v3 offset:13312
  s_waitcnt lgkmcnt(5)
  v_mfma_f32_16x16x32_bf16 v[32:35], v[104:107], a[208:211], v[32:35]
  v_mfma_f32_16x16x32_bf16 v[36:39], v[104:107], a[212:215], v[36:39]
  ds_read_b128 v[104:107], v3 offset:14336
  s_waitcnt lgkmcnt(5)
  v_mfma_f32_16x16x32_bf16 v[40:43], v[108:111], a[208:211], v[40:43]
  v_mfma_f32_16x16x32_bf16 v[44:47], v[108:111], a[212:215], v[44:47]
  ds_read_b128 v[108:111], v3 offset:15360
  s_waitcnt lgkmcnt(5)
  v_mfma_f32_16x16x32_bf16 v[48:51], v[88:91], a[208:211], v[48:51]
  v_mfma_f32_16x16x32_bf16 v[52:55], v[88:91], a[212:215], v[52:55]
  s_barrier
  ds_read_b128 v[88:91], v1 offset:36864
  s_waitcnt vmcnt(21)
  s_waitcnt lgkmcnt(5)
  v_mfma_f32_16x16x32_bf16 v[16:19], v[92:95], a[216:219], v[16:19]
  s_add_u32 s55, s54, 69632
  buffer_load_dwordx4 v[240:243], v4, s[4:7], s55 offen offset:0 sc1
  buffer_load_dwordx4 v[244:247], v4, s[4:7], s55 offen offset:256 sc1
  v_mfma_f32_16x16x32_bf16 v[20:23], v[92:95], a[220:223], v[20:23]
  ds_read_b128 v[92:95], v1 offset:37888
  s_waitcnt lgkmcnt(5)
  v_mfma_f32_16x16x32_bf16 v[24:27], v[96:99], a[216:219], v[24:27]
  v_mfma_f32_16x16x32_bf16 v[28:31], v[96:99], a[220:223], v[28:31]
  ds_read_b128 v[96:99], v1 offset:38912
  s_waitcnt lgkmcnt(5)
  v_mfma_f32_16x16x32_bf16 v[32:35], v[100:103], a[216:219], v[32:35]
  v_mfma_f32_16x16x32_bf16 v[36:39], v[100:103], a[220:223], v[36:39]
  ds_read_b128 v[100:103], v1 offset:39936
  s_waitcnt lgkmcnt(5)
  v_mfma_f32_16x16x32_bf16 v[40:43], v[104:107], a[216:219], v[40:43]
  v_mfma_f32_16x16x32_bf16 v[44:47], v[104:107], a[220:223], v[44:47]
  ds_read_b128 v[104:107], v1 offset:40960
  s_waitcnt lgkmcnt(5)
  v_mfma_f32_16x16x32_bf16 v[48:51], v[108:111], a[216:219], v[48:51]
  v_mfma_f32_16x16x32_bf16 v[52:55], v[108:111], a[220:223], v[52:55]
  ds_read_b128 v[108:111], v1 offset:41984
  s_waitcnt vmcnt(21)
  s_waitcnt lgkmcnt(5)
  v_mfma_f32_16x16x32_bf16 v[16:19], v[88:91], a[224:227], v[16:19]
  s_add_u32 s55, s54, 71680
  buffer_load_dwordx4 v[248:251], v4, s[4:7], s55 offen offset:0 sc1
  buffer_load_dwordx4 v[252:255], v4, s[4:7], s55 offen offset:256 sc1
  v_mfma_f32_16x16x32_bf16 v[20:23], v[88:91], a[228:231], v[20:23]
  s_add_u32 s48, s61, 258048
  s_add_u32 m0, s41, 73728
  ds_read_b128 v[88:91], v1 offset:43008
  s_waitcnt lgkmcnt(5)
  v_mfma_f32_16x16x32_bf16 v[24:27], v[92:95], a[224:227], v[24:27]
  v_mfma_f32_16x16x32_bf16 v[28:31], v[92:95], a[228:231], v[28:31]
  buffer_load_dwordx4 v1, s[4:7], s48 offen offset:0 sc1 lds
  ds_read_b128 v[92:95], v1 offset:44032
  s_waitcnt lgkmcnt(5)
  v_mfma_f32_16x16x32_bf16 v[32:35], v[96:99], a[224:227], v[32:35]
  v_mfma_f32_16x16x32_bf16 v[36:39], v[96:99], a[228:231], v[36:39]
  ds_read_b128 v[96:99], v1 offset:45056
  s_waitcnt lgkmcnt(5)
  v_mfma_f32_16x16x32_bf16 v[40:43], v[100:103], a[224:227], v[40:43]
  buffer_load_dwordx4 v1, s[4:7], s48 offen offset:1024 sc1 lds
  v_mfma_f32_16x16x32_bf16 v[44:47], v[100:103], a[228:231], v[44:47]
  ds_read_b128 v[100:103], v1 offset:46080
  s_waitcnt lgkmcnt(5)
  v_mfma_f32_16x16x32_bf16 v[48:51], v[104:107], a[224:227], v[48:51]
  v_mfma_f32_16x16x32_bf16 v[52:55], v[104:107], a[228:231], v[52:55]
  buffer_load_dwordx4 v1, s[4:7], s48 offen offset:2048 sc1 lds
  ds_read_b128 v[104:107], v1 offset:47104
  s_waitcnt vmcnt(22)
  s_waitcnt lgkmcnt(5)
  v_mfma_f32_16x16x32_bf16 v[16:19], v[108:111], a[232:235], v[16:19]
  v_mfma_f32_16x16x32_bf16 v[20:23], v[108:111], a[236:239], v[20:23]
  ds_read_b128 v[108:111], v1 offset:48128
  s_waitcnt lgkmcnt(5)
  v_mfma_f32_16x16x32_bf16 v[24:27], v[88:91], a[232:235], v[24:27]
  buffer_load_dwordx4 v1, s[4:7], s48 offen offset:3072 sc1 lds
  s_add_u32 s48, s48, 4096
  s_add_u32 m0, m0, 4096
  v_mfma_f32_16x16x32_bf16 v[28:31], v[88:91], a[236:239], v[28:31]
  ds_read_b128 v[88:91], v1 offset:49152
  s_waitcnt lgkmcnt(5)
  v_mfma_f32_16x16x32_bf16 v[32:35], v[92:95], a[232:235], v[32:35]
  v_mfma_f32_16x16x32_bf16 v[36:39], v[92:95], a[236:239], v[36:39]
  buffer_load_dwordx4 v1, s[4:7], s48 offen offset:0 sc1 lds
  ds_read_b128 v[92:95], v1 offset:50176
  s_waitcnt lgkmcnt(5)
  v_mfma_f32_16x16x32_bf16 v[40:43], v[96:99], a[232:235], v[40:43]
  v_mfma_f32_16x16x32_bf16 v[44:47], v[96:99], a[236:239], v[44:47]
  ds_read_b128 v[96:99], v1 offset:51200
  s_waitcnt lgkmcnt(5)
  v_mfma_f32_16x16x32_bf16 v[48:51], v[100:103], a[232:235], v[48:51]
  buffer_load_dwordx4 v1, s[4:7], s48 offen offset:1024 sc1 lds
  v_mfma_f32_16x16x32_bf16 v[52:55], v[100:103], a[236:239], v[52:55]
  ds_read_b128 v[100:103], v1 offset:52224
  s_waitcnt vmcnt(18)
  s_waitcnt lgkmcnt(5)
  v_mfma_f32_16x16x32_bf16 v[16:19], v[104:107], a[240:243], v[16:19]
  v_mfma_f32_16x16x32_bf16 v[20:23], v[104:107], a[244:247], v[20:23]
  buffer_load_dwordx4 v1, s[4:7], s48 offen offset:2048 sc1 lds
  ds_read_b128 v[104:107], v1 offset:53248
  s_waitcnt lgkmcnt(5)
  v_mfma_f32_16x16x32_bf16 v[24:27], v[108:111], a[240:243], v[24:27]
  v_mfma_f32_16x16x32_bf16 v[28:31], v[108:111], a[244:247], v[28:31]
  ds_read_b128 v[108:111], v1 offset:54272
  s_waitcnt lgkmcnt(5)
  v_mfma_f32_16x16x32_bf16 v[32:35], v[88:91], a[240:243], v[32:35]
  buffer_load_dwordx4 v1, s[4:7], s48 offen offset:3072 sc1 lds
  s_add_u32 s48, s48, 4096
  s_add_u32 m0, m0, 4096
  v_mfma_f32_16x16x32_bf16 v[36:39], v[88:91], a[244:247], v[36:39]
  ds_read_b128 v[88:91], v1 offset:55296
  s_waitcnt lgkmcnt(5)
  v_mfma_f32_16x16x32_bf16 v[40:43], v[92:95], a[240:243], v[40:43]
  v_mfma_f32_16x16x32_bf16 v[44:47], v[92:95], a[244:247], v[44:47]
  buffer_load_dwordx4 v1, s[4:7], s48 offen offset:0 sc1 lds
  ds_read_b128 v[92:95], v1 offset:56320
  s_waitcnt lgkmcnt(5)
  v_mfma_f32_16x16x32_bf16 v[48:51], v[96:99], a[240:243], v[48:51]
  v_mfma_f32_16x16x32_bf16 v[52:55], v[96:99], a[244:247], v[52:55]
  ds_read_b128 v[96:99], v1 offset:57344
  s_waitcnt vmcnt(17)
  s_waitcnt lgkmcnt(5)
  v_mfma_f32_16x16x32_bf16 v[16:19], v[100:103], a[248:251], v[16:19]
  v_mfma_f32_16x16x32_bf16 v[20:23], v[100:103], a[252:255], v[20:23]
  ds_read_b128 v[100:103], v1 offset:58368
  s_waitcnt lgkmcnt(5)
  v_mfma_f32_16x16x32_bf16 v[24:27], v[104:107], a[248:251], v[24:27]
  v_mfma_f32_16x16x32_bf16 v[28:31], v[104:107], a[252:255], v[28:31]
  ds_read_b128 v[104:107], v1 offset:59392
  s_waitcnt lgkmcnt(5)
  v_mfma_f32_16x16x32_bf16 v[32:35], v[108:111], a[248:251], v[32:35]
  v_mfma_f32_16x16x32_bf16 v[36:39], v[108:111], a[252:255], v[36:39]
  ds_read_b128 v[108:111], v1 offset:60416
  s_waitcnt lgkmcnt(5)
  v_mfma_f32_16x16x32_bf16 v[40:43], v[88:91], a[248:251], v[40:43]
  v_mfma_f32_16x16x32_bf16 v[44:47], v[88:91], a[252:255], v[44:47]
  ds_read_b128 v[88:91], v1 offset:61440
  s_waitcnt lgkmcnt(5)
  v_mfma_f32_16x16x32_bf16 v[48:51], v[92:95], a[248:251], v[48:51]
  v_mfma_f32_16x16x32_bf16 v[52:55], v[92:95], a[252:255], v[52:55]
  ds_read_b128 v[92:95], v1 offset:62464
  s_waitcnt vmcnt(15)
  s_waitcnt lgkmcnt(5)
  v_mfma_f32_16x16x32_bf16 v[16:19], v[96:99], v[224:227], v[16:19]
  s_lshr_b32 s46, s62, 2
  s_add_u32 s46, s46, s40
  buffer_load_dwordx4 v[200:203], v12, s[4:7], s46 offen offset:0 sc1
  v_mfma_f32_16x16x32_bf16 v[20:23], v[96:99], v[228:231], v[20:23]
  ds_read_b128 v[96:99], v1 offset:63488
  s_waitcnt lgkmcnt(5)
  v_mfma_f32_16x16x32_bf16 v[24:27], v[100:103], v[224:227], v[24:27]
  v_mfma_f32_16x16x32_bf16 v[28:31], v[100:103], v[228:231], v[28:31]
  ds_read_b128 v[100:103], v1 offset:64512
  s_waitcnt lgkmcnt(5)
  v_mfma_f32_16x16x32_bf16 v[32:35], v[104:107], v[224:227], v[32:35]
  v_mfma_f32_16x16x32_bf16 v[36:39], v[104:107], v[228:231], v[36:39]
  ds_read_b128 v[104:107], v2 offset:0
  s_waitcnt lgkmcnt(5)
  v_mfma_f32_16x16x32_bf16 v[40:43], v[108:111], v[224:227], v[40:43]
  v_mfma_f32_16x16x32_bf16 v[44:47], v[108:111], v[228:231], v[44:47]
  ds_read_b128 v[108:111], v2 offset:1024
  s_waitcnt lgkmcnt(5)
  v_mfma_f32_16x16x32_bf16 v[48:51], v[88:91], v[224:227], v[48:51]
  v_mfma_f32_16x16x32_bf16 v[52:55], v[88:91], v[228:231], v[52:55]
  ds_read_b128 v[88:91], v2 offset:2048
  s_waitcnt vmcnt(14)
  s_waitcnt lgkmcnt(5)
  v_mfma_f32_16x16x32_bf16 v[16:19], v[92:95], v[232:235], v[16:19]
  s_lshr_b32 s46, s62, 2
  s_add_u32 s46, s46, s40
  buffer_load_dwordx4 v[204:207], v12, s[4:7], s46 offen offset:1024 sc1
  v_mfma_f32_16x16x32_bf16 v[20:23], v[92:95], v[236:239], v[20:23]
  ds_read_b128 v[92:95], v2 offset:3072
  s_waitcnt lgkmcnt(5)
  v_mfma_f32_16x16x32_bf16 v[24:27], v[96:99], v[232:235], v[24:27]
  v_mfma_f32_16x16x32_bf16 v[28:31], v[96:99], v[236:239], v[28:31]
  ds_read_b128 v[96:99], v2 offset:4096
  s_waitcnt lgkmcnt(5)
  v_mfma_f32_16x16x32_bf16 v[32:35], v[100:103], v[232:235], v[32:35]
  v_mfma_f32_16x16x32_bf16 v[36:39], v[100:103], v[236:239], v[36:39]
  ds_read_b128 v[100:103], v2 offset:5120
  s_waitcnt lgkmcnt(5)
  v_mfma_f32_16x16x32_bf16 v[40:43], v[104:107], v[232:235], v[40:43]
  v_mfma_f32_16x16x32_bf16 v[44:47], v[104:107], v[236:239], v[44:47]
  ds_read_b128 v[104:107], v2 offset:6144
  s_waitcnt lgkmcnt(5)
  v_mfma_f32_16x16x32_bf16 v[48:51], v[108:111], v[232:235], v[48:51]
  v_mfma_f32_16x16x32_bf16 v[52:55], v[108:111], v[236:239], v[52:55]
  ds_read_b128 v[108:111], v2 offset:7168
  s_waitcnt vmcnt(13)
  s_waitcnt lgkmcnt(5)
  v_mfma_f32_16x16x32_bf16 v[16:19], v[88:91], v[240:243], v[16:19]
  s_add_u32 s46, s40, 8192
  buffer_load_dwordx4 v[208:211], v12, s[4:7], s46 offen offset:0 sc1
  v_mfma_f32_16x16x32_bf16 v[20:23], v[88:91], v[244:247], v[20:23]
  s_barrier
  ds_read_b128 v[88:91], v1 offset:0
  s_waitcnt lgkmcnt(5)
  v_mfma_f32_16x16x32_bf16 v[24:27], v[92:95], v[240:243], v[24:27]
  v_mfma_f32_16x16x32_bf16 v[28:31], v[92:95], v[244:247], v[28:31]
  ds_read_b128 v[92:95], v1 offset:1024
  s_waitcnt lgkmcnt(5)
  v_mfma_f32_16x16x32_bf16 v[32:35], v[96:99], v[240:243], v[32:35]
  v_mfma_f32_16x16x32_bf16 v[36:39], v[96:99], v[244:247], v[36:39]
  ds_read_b128 v[96:99], v1 offset:2048
  s_waitcnt lgkmcnt(5)
  v_mfma_f32_16x16x32_bf16 v[40:43], v[100:103], v[240:243], v[40:43]
  v_mfma_f32_16x16x32_bf16 v[44:47], v[100:103], v[244:247], v[44:47]
  ds_read_b128 v[100:103], v1 offset:3072
  s_waitcnt lgkmcnt(5)
  v_mfma_f32_16x16x32_bf16 v[48:51], v[104:107], v[240:243], v[48:51]
  v_mfma_f32_16x16x32_bf16 v[52:55], v[104:107], v[244:247], v[52:55]
  ds_read_b128 v[104:107], v1 offset:4096
  s_waitcnt vmcnt(12)
  s_waitcnt lgkmcnt(5)
  v_mfma_f32_16x16x32_bf16 v[16:19], v[108:111], v[248:251], v[16:19]
  v_mfma_f32_16x16x32_bf16 v[20:23], v[108:111], v[252:255], v[20:23]
  ds_read_b128 v[108:111], v1 offset:5120
  s_waitcnt lgkmcnt(5)
  v_mfma_f32_16x16x32_bf16 v[24:27], v[88:91], v[248:251], v[24:27]
  v_mfma_f32_16x16x32_bf16 v[28:31], v[88:91], v[252:255], v[28:31]
  s_add_u32 s48, s61, 294912
  s_add_u32 m0, s41, 110592
  ds_read_b128 v[88:91], v1 offset:6144
  s_waitcnt lgkmcnt(5)
  v_mfma_f32_16x16x32_bf16 v[32:35], v[92:95], v[248:251], v[32:35]
  v_mfma_f32_16x16x32_bf16 v[36:39], v[92:95], v[252:255], v[36:39]
  buffer_load_dwordx4 v1, s[4:7], s48 offen offset:0 sc1 lds
  ds_read_b128 v[92:95], v1 offset:7168
  s_waitcnt lgkmcnt(5)
  v_mfma_f32_16x16x32_bf16 v[40:43], v[96:99], v[248:251], v[40:43]
  v_mfma_f32_16x16x32_bf16 v[44:47], v[96:99], v[252:255], v[44:47]
  ds_read_b128 v[96:99], v1 offset:8192
  s_waitcnt lgkmcnt(5)
  v_mfma_f32_16x16x32_bf16 v[48:51], v[100:103], v[248:251], v[48:51]
  buffer_load_dwordx4 v1, s[4:7], s48 offen offset:1024 sc1 lds
  v_mfma_f32_16x16x32_bf16 v[52:55], v[100:103], v[252:255], v[52:55]
  ds_read_b128 v[100:103], v1 offset:9216
  s_waitcnt lgkmcnt(5)
  v_mfma_f32_16x16x32_bf16 v[56:59], v[104:107], a[160:163], v[56:59]
  v_mfma_f32_16x16x32_bf16 v[60:63], v[104:107], a[164:167], v[60:63]
  buffer_load_dwordx4 v1, s[4:7], s48 offen offset:2048 sc1 lds
  ds_read_b128 v[104:107], v1 offset:10240
  s_waitcnt lgkmcnt(5)
  v_mfma_f32_16x16x32_bf16 v[64:67], v[108:111], a[160:163], v[64:67]
  v_mfma_f32_16x16x32_bf16 v[68:71], v[108:111], a[164:167], v[68:71]
  ds_read_b128 v[108:111], v1 offset:11264
  s_waitcnt lgkmcnt(5)
  v_mfma_f32_16x16x32_bf16 v[56:59], v[88:91], a[168:171], v[56:59]
  buffer_load_dwordx4 v1, s[4:7], s48 offen offset:3072 sc1 lds
  s_add_u32 s48, s48, 4096
  s_add_u32 m0, m0, 4096
  v_cvt_pk_bf16_f32 v212, v16, v17
  v_cvt_pk_bf16_f32 v213, v18, v19
  v_mfma_f32_16x16x32_bf16 v[60:63], v[88:91], a[172:175], v[60:63]
  v_cvt_pk_bf16_f32 v214, v20, v21
  v_cvt_pk_bf16_f32 v215, v22, v23
  ds_read_b128 v[88:91], v1 offset:12288
  s_waitcnt lgkmcnt(5)
  v_mfma_f32_16x16x32_bf16 v[64:67], v[92:95], a[168:171], v[64:67]
  v_mfma_f32_16x16x32_bf16 v[68:71], v[92:95], a[172:175], v[68:71]
  buffer_load_dwordx4 v1, s[4:7], s48 offen offset:0 sc1 lds
  buffer_store_dwordx4 v[212:215], v1, s[4:7], s45 offen sc1
  ds_read_b128 v[92:95], v1 offset:13312
  s_waitcnt lgkmcnt(5)
  v_mfma_f32_16x16x32_bf16 v[56:59], v[96:99], a[176:179], v[56:59]
  v_mfma_f32_16x16x32_bf16 v[60:63], v[96:99], a[180:183], v[60:63]
  v_cvt_pk_bf16_f32 v24, v24, v25
  v_cvt_pk_bf16_f32 v25, v26, v27
  ds_read_b128 v[96:99], v1 offset:14336
  s_waitcnt lgkmcnt(5)
  v_mfma_f32_16x16x32_bf16 v[64:67], v[100:103], a[176:179], v[64:67]
  buffer_load_dwordx4 v1, s[4:7], s48 offen offset:1024 sc1 lds
  v_mfma_f32_16x16x32_bf16 v[68:71], v[100:103], a[180:183], v[68:71]
  v_cvt_pk_bf16_f32 v26, v28, v29
  v_cvt_pk_bf16_f32 v27, v30, v31
  ds_read_b128 v[100:103], v1 offset:15360
  s_waitcnt lgkmcnt(5)
  v_mfma_f32_16x16x32_bf16 v[56:59], v[104:107], a[184:187], v[56:59]
  v_mfma_f32_16x16x32_bf16 v[60:63], v[104:107], a[188:191], v[60:63]
  buffer_load_dwordx4 v1, s[4:7], s48 offen offset:2048 sc1 lds
  s_add_u32 s46, s44, s43
  s_add_u32 s43, s43, 4096
  s_and_b32 s43, s43, 0x7fff
  ds_read_b128 v[104:107], v1 offset:16384
  s_waitcnt lgkmcnt(5)
  v_mfma_f32_16x16x32_bf16 v[64:67], v[108:111], a[184:187], v[64:67]
  v_mfma_f32_16x16x32_bf16 v[68:71], v[108:111], a[188:191], v[68:71]
  buffer_store_dwordx4 v[24:27], v1, s[4:7], s46 offen sc1
  ds_read_b128 v[108:111], v1 offset:17408
  s_waitcnt lgkmcnt(5)
  v_mfma_f32_16x16x32_bf16 v[56:59], v[88:91], a[192:195], v[56:59]
  buffer_load_dwordx4 v1, s[4:7], s48 offen offset:3072 sc1 lds
  s_add_u32 s48, s48, 4096
  s_add_u32 m0, m0, 4096
  v_mfma_f32_16x16x32_bf16 v[60:63], v[88:91], a[196:199], v[60:63]
  v_cvt_pk_bf16_f32 v32, v32, v33
  v_cvt_pk_bf16_f32 v33, v34, v35
  ds_read_b128 v[88:91], v1 offset:18432
  s_waitcnt lgkmcnt(5)
  v_mfma_f32_16x16x32_bf16 v[64:67], v[92:95], a[192:195], v[64:67]
  v_mfma_f32_16x16x32_bf16 v[68:71], v[92:95], a[196:199], v[68:71]
  buffer_load_dwordx4 v1, s[4:7], s48 offen offset:0 sc1 lds
  v_cvt_pk_bf16_f32 v34, v36, v37
  v_cvt_pk_bf16_f32 v35, v38, v39
  ds_read_b128 v[92:95], v1 offset:19456
  s_waitcnt lgkmcnt(5)
  v_mfma_f32_16x16x32_bf16 v[56:59], v[96:99], a[200:203], v[56:59]
  v_mfma_f32_16x16x32_bf16 v[60:63], v[96:99], a[204:207], v[60:63]
  s_add_u32 s46, s44, s43
  s_add_u32 s43, s43, 4096
  s_and_b32 s43, s43, 0x7fff
  ds_read_b128 v[96:99], v1 offset:20480
  s_waitcnt lgkmcnt(5)
  v_mfma_f32_16x16x32_bf16 v[64:67], v[100:103], a[200:203], v[64:67]
  buffer_store_dwordx4 v[32:35], v1, s[4:7], s46 offen sc1
  v_mfma_f32_16x16x32_bf16 v[68:71], v[100:103], a[204:207], v[68:71]
  ds_read_b128 v[100:103], v1 offset:21504
  s_waitcnt lgkmcnt(5)
  v_mfma_f32_16x16x32_bf16 v[56:59], v[104:107], a[208:211], v[56:59]
  v_cvt_pk_bf16_f32 v40, v40, v41
  v_cvt_pk_bf16_f32 v41, v42, v43
  v_mfma_f32_16x16x32_bf16 v[60:63], v[104:107], a[212:215], v[60:63]
  ds_read_b128 v[104:107], v1 offset:22528
  s_waitcnt lgkmcnt(5)
  v_mfma_f32_16x16x32_bf16 v[64:67], v[108:111], a[208:211], v[64:67]
  v_cvt_pk_bf16_f32 v42, v44, v45
  v_cvt_pk_bf16_f32 v43, v46, v47
  v_mfma_f32_16x16x32_bf16 v[68:71], v[108:111], a[212:215], v[68:71]
  ds_read_b128 v[108:111], v1 offset:23552
  s_waitcnt lgkmcnt(5)
  v_mfma_f32_16x16x32_bf16 v[56:59], v[88:91], a[216:219], v[56:59]
  s_add_u32 s46, s44, s43
  s_add_u32 s43, s43, 4096
  s_and_b32 s43, s43, 0x7fff
  v_mfma_f32_16x16x32_bf16 v[60:63], v[88:91], a[220:223], v[60:63]
  ds_read_b128 v[88:91], v1 offset:24576
  s_waitcnt lgkmcnt(5)
  v_mfma_f32_16x16x32_bf16 v[64:67], v[92:95], a[216:219], v[64:67]
  buffer_store_dwordx4 v[40:43], v1, s[4:7], s46 offen sc1
  v_mfma_f32_16x16x32_bf16 v[68:71], v[92:95], a[220:223], v[68:71]
  ds_read_b128 v[92:95], v1 offset:25600
  s_waitcnt lgkmcnt(5)
  v_mfma_f32_16x16x32_bf16 v[56:59], v[96:99], a[224:227], v[56:59]
  v_cvt_pk_bf16_f32 v48, v48, v49
  v_cvt_pk_bf16_f32 v49, v50, v51
  v_mfma_f32_16x16x32_bf16 v[60:63], v[96:99], a[228:231], v[60:63]
  ds_read_b128 v[96:99], v1 offset:26624
  s_waitcnt lgkmcnt(5)
  v_mfma_f32_16x16x32_bf16 v[64:67], v[100:103], a[224:227], v[64:67]
  v_cvt_pk_bf16_f32 v50, v52, v53
  v_cvt_pk_bf16_f32 v51, v54, v55
  v_mfma_f32_16x16x32_bf16 v[68:71], v[100:103], a[228:231], v[68:71]
  ds_read_b128 v[100:103], v1 offset:27648
  s_waitcnt lgkmcnt(5)
  v_mfma_f32_16x16x32_bf16 v[56:59], v[104:107], a[232:235], v[56:59]
  s_add_u32 s46, s44, s43
  s_add_u32 s43, s43, 4096
  s_and_b32 s43, s43, 0x7fff
  v_mfma_f32_16x16x32_bf16 v[60:63], v[104:107], a[236:239], v[60:63]
  ds_read_b128 v[104:107], v1 offset:28672
  s_waitcnt lgkmcnt(5)
  v_mfma_f32_16x16x32_bf16 v[64:67], v[108:111], a[232:235], v[64:67]
  buffer_store_dwordx4 v[48:51], v1, s[4:7], s46 offen sc1
  v_mfma_f32_16x16x32_bf16 v[68:71], v[108:111], a[236:239], v[68:71]
  ds_read_b128 v[108:111], v1 offset:29696
  s_waitcnt lgkmcnt(5)
  v_mfma_f32_16x16x32_bf16 v[56:59], v[88:91], a[240:243], v[56:59]
  v_mfma_f32_16x16x32_bf16 v[60:63], v[88:91], a[244:247], v[60:63]
  ds_read_b128 v[88:91], v1 offset:30720
  s_waitcnt lgkmcnt(5)
  v_mfma_f32_16x16x32_bf16 v[64:67], v[92:95], a[240:243], v[64:67]
  v_mfma_f32_16x16x32_bf16 v[68:71], v[92:95], a[244:247], v[68:71]
  ds_read_b128 v[92:95], v1 offset:31744
  s_waitcnt lgkmcnt(5)
  v_mfma_f32_16x16x32_bf16 v[56:59], v[96:99], a[248:251], v[56:59]
  v_mfma_f32_16x16x32_bf16 v[60:63], v[96:99], a[252:255], v[60:63]
  ds_read_b128 v[96:99], v1 offset:32768
  s_waitcnt lgkmcnt(5)
  v_mfma_f32_16x16x32_bf16 v[64:67], v[100:103], a[248:251], v[64:67]
  v_mfma_f32_16x16x32_bf16 v[68:71], v[100:103], a[252:255], v[68:71]
  ds_read_b128 v[100:103], v1 offset:33792
  s_waitcnt lgkmcnt(5)
  v_mfma_f32_16x16x32_bf16 v[56:59], v[104:107], v[224:227], v[56:59]
  v_mfma_f32_16x16x32_bf16 v[60:63], v[104:107], v[228:231], v[60:63]
  ds_read_b128 v[104:107], v1 offset:34816
  s_waitcnt lgkmcnt(5)
  v_mfma_f32_16x16x32_bf16 v[64:67], v[108:111], v[224:227], v[64:67]
  v_mfma_f32_16x16x32_bf16 v[68:71], v[108:111], v[228:231], v[68:71]
  ds_read_b128 v[108:111], v1 offset:35840
  s_waitcnt lgkmcnt(5)
  v_mfma_f32_16x16x32_bf16 v[56:59], v[88:91], v[232:235], v[56:59]
  v_mfma_f32_16x16x32_bf16 v[60:63], v[88:91], v[236:239], v[60:63]
  s_waitcnt vmcnt(17)
  s_barrier
  ds_read_b128 v[88:91], v2 offset:8192
  s_waitcnt lgkmcnt(5)
  v_mfma_f32_16x16x32_bf16 v[64:67], v[92:95], v[232:235], v[64:67]
  v_mfma_f32_16x16x32_bf16 v[68:71], v[92:95], v[236:239], v[68:71]
  ds_read_b128 v[92:95], v2 offset:9216
  s_waitcnt lgkmcnt(5)
  v_mfma_f32_16x16x32_bf16 v[56:59], v[96:99], v[240:243], v[56:59]
  v_mfma_f32_16x16x32_bf16 v[60:63], v[96:99], v[244:247], v[60:63]
  ds_read_b128 v[96:99], v2 offset:10240
  s_waitcnt lgkmcnt(5)
  v_mfma_f32_16x16x32_bf16 v[64:67], v[100:103], v[240:243], v[64:67]
  v_mfma_f32_16x16x32_bf16 v[68:71], v[100:103], v[244:247], v[68:71]
  ds_read_b128 v[100:103], v2 offset:11264
  s_waitcnt lgkmcnt(5)
  v_mfma_f32_16x16x32_bf16 v[56:59], v[104:107], v[248:251], v[56:59]
  v_mfma_f32_16x16x32_bf16 v[60:63], v[104:107], v[252:255], v[60:63]
  ds_read_b128 v[104:107], v2 offset:12288
  s_waitcnt lgkmcnt(5)
  v_mfma_f32_16x16x32_bf16 v[64:67], v[108:111], v[248:251], v[64:67]
  v_mfma_f32_16x16x32_bf16 v[68:71], v[108:111], v[252:255], v[68:71]
  ds_read_b128 v[108:111], v2 offset:13312
  s_waitcnt lgkmcnt(5)
  v_mfma_f32_16x16x32_bf16 v[72:75], v[88:91], a[0:3], 0
  v_mfma_f32_16x16x32_bf16 v[76:79], v[88:91], a[4:7], 0
  ds_read_b128 v[88:91], v2 offset:14336
  s_waitcnt lgkmcnt(5)
  v_mfma_f32_16x16x32_bf16 v[72:75], v[92:95], a[8:11], v[72:75]
  v_mfma_f32_16x16x32_bf16 v[76:79], v[92:95], a[12:15], v[76:79]
  ds_read_b128 v[92:95], v2 offset:15360
  s_waitcnt lgkmcnt(5)
  v_mfma_f32_16x16x32_bf16 v[72:75], v[96:99], a[16:19], v[72:75]
  v_cvt_pk_bf16_f32 v56, v56, v57
  v_cvt_pk_bf16_f32 v57, v58, v59
  v_mfma_f32_16x16x32_bf16 v[76:79], v[96:99], a[20:23], v[76:79]
  v_cvt_pk_bf16_f32 v58, v60, v61
  v_cvt_pk_bf16_f32 v59, v62, v63
  ds_read_b128 v[96:99], v2 offset:16384
  s_waitcnt lgkmcnt(5)
  v_mfma_f32_16x16x32_bf16 v[72:75], v[100:103], a[24:27], v[72:75]
  v_mfma_f32_16x16x32_bf16 v[76:79], v[100:103], a[28:31], v[76:79]
  s_add_u32 s46, s44, s43
  s_add_u32 s43, s43, 4096
  s_and_b32 s43, s43, 0x7fff
  ds_read_b128 v[100:103], v2 offset:17408
  s_waitcnt lgkmcnt(5)
  v_mfma_f32_16x16x32_bf16 v[72:75], v[104:107], a[32:35], v[72:75]
  v_mfma_f32_16x16x32_bf16 v[76:79], v[104:107], a[36:39], v[76:79]
  buffer_store_dwordx4 v[56:59], v1, s[4:7], s46 offen sc1
  ds_read_b128 v[104:107], v2 offset:18432
  s_waitcnt lgkmcnt(5)
  v_mfma_f32_16x16x32_bf16 v[72:75], v[108:111], a[40:43], v[72:75]
  v_mfma_f32_16x16x32_bf16 v[76:79], v[108:111], a[44:47], v[76:79]
  v_cvt_pk_bf16_f32 v64, v64, v65
  v_cvt_pk_bf16_f32 v65, v66, v67
  ds_read_b128 v[108:111], v2 offset:19456
  s_waitcnt lgkmcnt(5)
  v_mfma_f32_16x16x32_bf16 v[72:75], v[88:91], a[48:51], v[72:75]
  v_cvt_pk_bf16_f32 v66, v68, v69
  v_cvt_pk_bf16_f32 v67, v70, v71
  v_mfma_f32_16x16x32_bf16 v[76:79], v[88:91], a[52:55], v[76:79]
  ds_read_b128 v[88:91], v2 offset:20480
  s_waitcnt lgkmcnt(5)
  v_mfma_f32_16x16x32_bf16 v[72:75], v[92:95], a[56:59], v[72:75]
  s_add_u32 s46, s44, s43
  s_add_u32 s43, s43, 4096
  s_and_b32 s43, s43, 0x7fff
  v_mfma_f32_16x16x32_bf16 v[76:79], v[92:95], a[60:63], v[76:79]
  ds_read_b128 v[92:95], v2 offset:21504
  s_waitcnt lgkmcnt(5)
  v_mfma_f32_16x16x32_bf16 v[72:75], v[96:99], a[64:67], v[72:75]
  buffer_store_dwordx4 v[64:67], v1, s[4:7], s46 offen sc1
  v_mfma_f32_16x16x32_bf16 v[76:79], v[96:99], a[68:71], v[76:79]
  ds_read_b128 v[96:99], v2 offset:22528
  s_waitcnt lgkmcnt(5)
  v_mfma_f32_16x16x32_bf16 v[72:75], v[100:103], a[72:75], v[72:75]
  v_mfma_f32_16x16x32_bf16 v[76:79], v[100:103], a[76:79], v[76:79]
  ds_read_b128 v[100:103], v2 offset:23552
  s_waitcnt lgkmcnt(5)
  v_mfma_f32_16x16x32_bf16 v[72:75], v[104:107], a[80:83], v[72:75]
  s_waitcnt vmcnt(2)
  buffer_store_dword v7, v6, s[4:7], s53 offen sc1
  v_mfma_f32_16x16x32_bf16 v[76:79], v[104:107], a[84:87], v[76:79]
  ds_read_b128 v[104:107], v2 offset:24576
  s_waitcnt lgkmcnt(5)
  v_mfma_f32_16x16x32_bf16 v[72:75], v[108:111], a[88:91], v[72:75]
  s_lshr_b32 s15, s36, 2
  s_lshl_b32 s15, s15, 3
  s_lshr_b32 s13, s37, 2
  s_add_u32 s15, s15, s13
  s_mul_i32 s15, s15, 136192
  s_add_u32 s15, s15, 16220160
  s_cmp_eq_u32 s51, 0
  s_cselect_b32 s15, s15, s49
  s_mul_i32 s13, s3, 9216
  s_add_u32 s12, s15, s13
  s_add_u32 s12, s12, 36864
  s_add_u32 m0, s13, 36864
  v_mfma_f32_16x16x32_bf16 v[76:79], v[108:111], a[92:95], v[76:79]
  ds_read_b128 v[108:111], v2 offset:25600
  s_waitcnt lgkmcnt(5)
  v_mfma_f32_16x16x32_bf16 v[72:75], v[88:91], a[96:99], v[72:75]
  v_mfma_f32_16x16x32_bf16 v[76:79], v[88:91], a[100:103], v[76:79]
  ds_read_b128 v[88:91], v2 offset:26624
  s_waitcnt lgkmcnt(5)
  v_mfma_f32_16x16x32_bf16 v[72:75], v[92:95], a[104:107], v[72:75]
  buffer_load_dwordx4 v1, s[4:7], s12 offen offset:0 sc1 lds
  v_mfma_f32_16x16x32_bf16 v[76:79], v[92:95], a[108:111], v[76:79]
  ds_read_b128 v[92:95], v2 offset:27648
  s_waitcnt lgkmcnt(5)
  v_mfma_f32_16x16x32_bf16 v[72:75], v[96:99], a[112:115], v[72:75]
  v_mfma_f32_16x16x32_bf16 v[76:79], v[96:99], a[116:119], v[76:79]
  ds_read_b128 v[96:99], v2 offset:28672
  s_waitcnt lgkmcnt(5)
  v_mfma_f32_16x16x32_bf16 v[72:75], v[100:103], a[120:123], v[72:75]
  buffer_load_dwordx4 v1, s[4:7], s12 offen offset:1024 sc1 lds
  v_mfma_f32_16x16x32_bf16 v[76:79], v[100:103], a[124:127], v[76:79]
  ds_read_b128 v[100:103], v2 offset:29696
  s_waitcnt lgkmcnt(5)
  v_mfma_f32_16x16x32_bf16 v[72:75], v[104:107], a[128:131], v[72:75]
  v_mfma_f32_16x16x32_bf16 v[76:79], v[104:107], a[132:135], v[76:79]
  ds_read_b128 v[104:107], v2 offset:30720
  s_waitcnt lgkmcnt(5)
  v_mfma_f32_16x16x32_bf16 v[72:75], v[108:111], a[136:139], v[72:75]
  buffer_load_dwordx4 v1, s[4:7], s12 offen offset:2048 sc1 lds
  v_mfma_f32_16x16x32_bf16 v[76:79], v[108:111], a[140:143], v[76:79]
  ds_read_b128 v[108:111], v2 offset:31744
  s_waitcnt lgkmcnt(5)
  v_mfma_f32_16x16x32_bf16 v[72:75], v[88:91], a[144:147], v[72:75]
  v_mfma_f32_16x16x32_bf16 v[76:79], v[88:91], a[148:151], v[76:79]
  ds_read_b128 v[88:91], v2 offset:32768
  s_waitcnt lgkmcnt(5)
  v_mfma_f32_16x16x32_bf16 v[72:75], v[92:95], a[152:155], v[72:75]
  buffer_load_dwordx4 v1, s[4:7], s12 offen offset:3072 sc1 lds
  s_add_u32 s12, s12, 4096
  s_add_u32 m0, m0, 4096
  v_mfma_f32_16x16x32_bf16 v[76:79], v[92:95], a[156:159], v[76:79]
  ds_read_b128 v[92:95], v2 offset:33792
  s_waitcnt lgkmcnt(5)
  v_mfma_f32_16x16x32_bf16 v[72:75], v[96:99], a[160:163], v[72:75]
  v_mfma_f32_16x16x32_bf16 v[76:79], v[96:99], a[164:167], v[76:79]
  ds_read_b128 v[96:99], v2 offset:34816
  s_waitcnt lgkmcnt(5)
  v_mfma_f32_16x16x32_bf16 v[72:75], v[100:103], a[168:171], v[72:75]
  v_mfma_f32_16x16x32_bf16 v[76:79], v[100:103], a[172:175], v[76:79]
  buffer_load_dwordx4 v1, s[4:7], s12 offen offset:0 sc1 lds
  ds_read_b128 v[100:103], v2 offset:35840
  s_waitcnt lgkmcnt(5)
  v_mfma_f32_16x16x32_bf16 v[72:75], v[104:107], a[176:179], v[72:75]
  v_mfma_f32_16x16x32_bf16 v[76:79], v[104:107], a[180:183], v[76:79]
  ds_read_b128 v[104:107], v2 offset:36864
  s_waitcnt lgkmcnt(5)
  v_mfma_f32_16x16x32_bf16 v[72:75], v[108:111], a[184:187], v[72:75]
  v_mfma_f32_16x16x32_bf16 v[76:79], v[108:111], a[188:191], v[76:79]
  buffer_load_dwordx4 v1, s[4:7], s12 offen offset:1024 sc1 lds
  ds_read_b128 v[108:111], v2 offset:37888
  s_waitcnt lgkmcnt(5)
  v_mfma_f32_16x16x32_bf16 v[72:75], v[88:91], a[192:195], v[72:75]
  v_mfma_f32_16x16x32_bf16 v[76:79], v[88:91], a[196:199], v[76:79]
  ds_read_b128 v[88:91], v2 offset:38912
  s_waitcnt lgkmcnt(5)
  v_mfma_f32_16x16x32_bf16 v[72:75], v[92:95], a[200:203], v[72:75]
  v_mfma_f32_16x16x32_bf16 v[76:79], v[92:95], a[204:207], v[76:79]
  buffer_load_dwordx4 v1, s[4:7], s12 offen offset:2048 sc1 lds
  ds_read_b128 v[92:95], v2 offset:39936
  s_waitcnt lgkmcnt(5)
  v_mfma_f32_16x16x32_bf16 v[72:75], v[96:99], a[208:211], v[72:75]
  v_mfma_f32_16x16x32_bf16 v[76:79], v[96:99], a[212:215], v[76:79]
  ds_read_b128 v[96:99], v2 offset:40960
  s_waitcnt lgkmcnt(5)
  v_mfma_f32_16x16x32_bf16 v[72:75], v[100:103], a[216:219], v[72:75]
  v_mfma_f32_16x16x32_bf16 v[76:79], v[100:103], a[220:223], v[76:79]
  buffer_load_dwordx4 v1, s[4:7], s12 offen offset:3072 sc1 lds
  s_add_u32 s12, s12, 4096
  s_add_u32 m0, m0, 4096
  ds_read_b128 v[100:103], v2 offset:41984
  s_waitcnt lgkmcnt(5)
  v_mfma_f32_16x16x32_bf16 v[72:75], v[104:107], a[224:227], v[72:75]
  v_mfma_f32_16x16x32_bf16 v[76:79], v[104:107], a[228:231], v[76:79]
  ds_read_b128 v[104:107], v2 offset:43008
  s_waitcnt lgkmcnt(5)
  v_mfma_f32_16x16x32_bf16 v[72:75], v[108:111], a[232:235], v[72:75]
  v_mfma_f32_16x16x32_bf16 v[76:79], v[108:111], a[236:239], v[76:79]
  buffer_load_dwordx4 v1, s[4:7], s12 offen offset:0 sc1 lds
  ds_read_b128 v[108:111], v2 offset:44032
  s_waitcnt lgkmcnt(5)
  v_mfma_f32_16x16x32_bf16 v[72:75], v[88:91], a[240:243], v[72:75]
  v_mfma_f32_16x16x32_bf16 v[76:79], v[88:91], a[244:247], v[76:79]
  s_barrier
  ds_read_b128 v[88:91], v2 offset:45056
  s_waitcnt lgkmcnt(5)
  v_mfma_f32_16x16x32_bf16 v[72:75], v[92:95], a[248:251], v[72:75]
  v_mfma_f32_16x16x32_bf16 v[76:79], v[92:95], a[252:255], v[76:79]
  ds_read_b128 v[92:95], v2 offset:46080
  s_waitcnt lgkmcnt(5)
  v_mfma_f32_16x16x32_bf16 v[72:75], v[96:99], v[224:227], v[72:75]
  v_mfma_f32_16x16x32_bf16 v[76:79], v[96:99], v[228:231], v[76:79]
  ds_read_b128 v[96:99], v2 offset:47104
  s_waitcnt lgkmcnt(5)
  v_mfma_f32_16x16x32_bf16 v[72:75], v[100:103], v[232:235], v[72:75]
  v_mov_b32 v219, 2
  s_waitcnt vmcnt(10)
  buffer_store_dword v219, v6, s[4:7], s53 offen sc1
  v_mfma_f32_16x16x32_bf16 v[76:79], v[100:103], v[236:239], v[76:79]
  ds_read_b128 v[100:103], v2 offset:48128
  s_waitcnt lgkmcnt(5)
  v_mfma_f32_16x16x32_bf16 v[72:75], v[104:107], v[240:243], v[72:75]
  v_mfma_f32_16x16x32_bf16 v[76:79], v[104:107], v[244:247], v[76:79]
  ds_read_b128 v[104:107], v2 offset:49152
  s_waitcnt lgkmcnt(5)
  v_mfma_f32_16x16x32_bf16 v[72:75], v[108:111], v[248:251], v[72:75]
  v_mfma_f32_16x16x32_bf16 v[76:79], v[108:111], v[252:255], v[76:79]
  ds_read_b128 v[108:111], v2 offset:50176
  s_waitcnt lgkmcnt(5)
  v_mfma_f32_16x16x32_bf16 v[80:83], v[88:91], a[0:3], 0
  buffer_load_dword v220, v10, s[4:7], s53 offen sc1
  v_mfma_f32_16x16x32_bf16 v[84:87], v[88:91], a[4:7], 0
  ds_read_b128 v[88:91], v2 offset:51200
  s_waitcnt lgkmcnt(5)
  v_mfma_f32_16x16x32_bf16 v[80:83], v[92:95], a[8:11], v[80:83]
  s_lshr_b32 s15, s36, 2
  s_lshl_b32 s15, s15, 3
  s_lshr_b32 s13, s37, 2
  s_add_u32 s15, s15, s13
  s_mul_i32 s15, s15, 136192
  s_add_u32 s15, s15, 16220160
  s_cmp_eq_u32 s51, 0
  s_cselect_b32 s15, s15, s49
  s_mul_i32 s13, s3, 9216
  s_add_u32 s12, s15, s13
  s_add_u32 s12, s12, 0
  s_add_u32 m0, s13, 0
  v_mfma_f32_16x16x32_bf16 v[84:87], v[92:95], a[12:15], v[84:87]
  ds_read_b128 v[92:95], v2 offset:52224
  s_waitcnt lgkmcnt(5)
  v_mfma_f32_16x16x32_bf16 v[80:83], v[96:99], a[16:19], v[80:83]
  buffer_load_dwordx4 v1, s[4:7], s12 offen offset:0 sc1 lds
  v_mfma_f32_16x16x32_bf16 v[84:87], v[96:99], a[20:23], v[84:87]
  ds_read_b128 v[96:99], v2 offset:53248
  s_waitcnt lgkmcnt(5)
  v_mfma_f32_16x16x32_bf16 v[80:83], v[100:103], a[24:27], v[80:83]
  buffer_load_dwordx4 v1, s[4:7], s12 offen offset:1024 sc1 lds
  v_mfma_f32_16x16x32_bf16 v[84:87], v[100:103], a[28:31], v[84:87]
  ds_read_b128 v[100:103], v2 offset:54272
  s_waitcnt lgkmcnt(5)
  v_mfma_f32_16x16x32_bf16 v[80:83], v[104:107], a[32:35], v[80:83]
  buffer_load_dwordx4 v1, s[4:7], s12 offen offset:2048 sc1 lds
  v_mfma_f32_16x16x32_bf16 v[84:87], v[104:107], a[36:39], v[84:87]
  ds_read_b128 v[104:107], v2 offset:55296
  s_waitcnt lgkmcnt(5)
  v_mfma_f32_16x16x32_bf16 v[80:83], v[108:111], a[40:43], v[80:83]
  buffer_load_dwordx4 v1, s[4:7], s12 offen offset:3072 sc1 lds
  s_add_u32 s12, s12, 4096
  s_add_u32 m0, m0, 4096
  v_mfma_f32_16x16x32_bf16 v[84:87], v[108:111], a[44:47], v[84:87]
  ds_read_b128 v[108:111], v2 offset:56320
  s_waitcnt lgkmcnt(5)
  v_mfma_f32_16x16x32_bf16 v[80:83], v[88:91], a[48:51], v[80:83]
  v_mfma_f32_16x16x32_bf16 v[84:87], v[88:91], a[52:55], v[84:87]
  buffer_load_dwordx4 v1, s[4:7], s12 offen offset:0 sc1 lds
  ds_read_b128 v[88:91], v2 offset:57344
  s_waitcnt lgkmcnt(5)
  v_mfma_f32_16x16x32_bf16 v[80:83], v[92:95], a[56:59], v[80:83]
  v_mfma_f32_16x16x32_bf16 v[84:87], v[92:95], a[60:63], v[84:87]
  buffer_load_dwordx4 v1, s[4:7], s12 offen offset:1024 sc1 lds
  ds_read_b128 v[92:95], v2 offset:58368
  s_waitcnt lgkmcnt(5)
  v_mfma_f32_16x16x32_bf16 v[80:83], v[96:99], a[64:67], v[80:83]
  v_mfma_f32_16x16x32_bf16 v[84:87], v[96:99], a[68:71], v[84:87]
  buffer_load_dwordx4 v1, s[4:7], s12 offen offset:2048 sc1 lds
  ds_read_b128 v[96:99], v2 offset:59392
  s_waitcnt lgkmcnt(5)
  v_mfma_f32_16x16x32_bf16 v[80:83], v[100:103], a[72:75], v[80:83]
  v_mfma_f32_16x16x32_bf16 v[84:87], v[100:103], a[76:79], v[84:87]
  buffer_load_dwordx4 v1, s[4:7], s12 offen offset:3072 sc1 lds
  s_add_u32 s12, s12, 4096
  s_add_u32 m0, m0, 4096
  ds_read_b128 v[100:103], v2 offset:60416
  s_waitcnt lgkmcnt(5)
  v_mfma_f32_16x16x32_bf16 v[80:83], v[104:107], a[80:83], v[80:83]
  v_mfma_f32_16x16x32_bf16 v[84:87], v[104:107], a[84:87], v[84:87]
  buffer_load_dwordx4 v1, s[4:7], s12 offen offset:0 sc1 lds
  ds_read_b128 v[104:107], v2 offset:61440
  s_waitcnt lgkmcnt(5)
  v_mfma_f32_16x16x32_bf16 v[80:83], v[108:111], a[88:91], v[80:83]
  v_mfma_f32_16x16x32_bf16 v[84:87], v[108:111], a[92:95], v[84:87]
  ds_read_b128 v[108:111], v2 offset:62464
  s_waitcnt lgkmcnt(5)
  v_mfma_f32_16x16x32_bf16 v[80:83], v[88:91], a[96:99], v[80:83]
  v_mfma_f32_16x16x32_bf16 v[84:87], v[88:91], a[100:103], v[84:87]
  ds_read_b128 v[88:91], v2 offset:63488
  s_waitcnt lgkmcnt(5)
  v_mfma_f32_16x16x32_bf16 v[80:83], v[92:95], a[104:107], v[80:83]
  v_mfma_f32_16x16x32_bf16 v[84:87], v[92:95], a[108:111], v[84:87]
  ds_read_b128 v[92:95], v2 offset:64512
  s_waitcnt lgkmcnt(5)
  v_mfma_f32_16x16x32_bf16 v[80:83], v[96:99], a[112:115], v[80:83]
  s_waitcnt vmcnt(9)
  s_mov_b32 s47, 0
B2_spin0:
  v_cmp_eq_u32 vcc, 0, v220
  s_nop 0
  s_cmp_eq_u64 vcc, 0
  s_cbranch_scc1 B2_ok0
  s_add_u32 s47, s47, 1
  s_cmp_gt_u32 s47, 0x40000
  s_cbranch_scc1 B2_ok0
  buffer_load_dword v220, v10, s[4:7], s53 offen sc1
  s_waitcnt vmcnt(0)
  s_branch B2_spin0
B2_ok0:
  v_mfma_f32_16x16x32_bf16 v[84:87], v[96:99], a[116:119], v[84:87]
  ds_read_b128 v[96:99], v3 offset:0
  s_waitcnt lgkmcnt(5)
  v_mfma_f32_16x16x32_bf16 v[80:83], v[100:103], a[120:123], v[80:83]
  s_add_u32 s46, s98, s62
  buffer_load_dwordx4 v[136:139], v1, s[4:7], s46 offen sc1
  v_mfma_f32_16x16x32_bf16 v[84:87], v[100:103], a[124:127], v[84:87]
  ds_read_b128 v[100:103], v3 offset:1024
  s_waitcnt lgkmcnt(5)
  v_mfma_f32_16x16x32_bf16 v[80:83], v[104:107], a[128:131], v[80:83]
  v_mfma_f32_16x16x32_bf16 v[84:87], v[104:107], a[132:135], v[84:87]
  s_add_u32 s46, s98, s62
  s_add_u32 s46, s46, 4096
  buffer_load_dwordx4 v[140:143], v1, s[4:7], s46 offen sc1
  ds_read_b128 v[104:107], v3 offset:2048
  s_waitcnt lgkmcnt(5)
  v_mfma_f32_16x16x32_bf16 v[80:83], v[108:111], a[136:139], v[80:83]
  v_mfma_f32_16x16x32_bf16 v[84:87], v[108:111], a[140:143], v[84:87]
  ds_read_b128 v[108:111], v3 offset:3072
  s_waitcnt lgkmcnt(5)
  v_mfma_f32_16x16x32_bf16 v[80:83], v[88:91], a[144:147], v[80:83]
  s_add_u32 s46, s98, 32768
  buffer_load_dwordx4 v[144:147], v11, s[4:7], s46 offen sc1
  v_mfma_f32_16x16x32_bf16 v[84:87], v[88:91], a[148:151], v[84:87]
  ds_read_b128 v[88:91], v3 offset:4096
  s_waitcnt lgkmcnt(5)
  v_mfma_f32_16x16x32_bf16 v[80:83], v[92:95], a[152:155], v[80:83]
  v_mfma_f32_16x16x32_bf16 v[84:87], v[92:95], a[156:159], v[84:87]
  s_add_u32 s46, s97, s62
  buffer_load_dwordx4 v[124:127], v1, s[4:7], s46 offen sc1
  ds_read_b128 v[92:95], v3 offset:5120
  s_waitcnt lgkmcnt(5)
  v_mfma_f32_16x16x32_bf16 v[80:83], v[96:99], a[160:163], v[80:83]
  v_mfma_f32_16x16x32_bf16 v[84:87], v[96:99], a[164:167], v[84:87]
  s_add_u32 s46, s97, s62
  s_add_u32 s46, s46, 4096
  buffer_load_dwordx4 v[128:131], v1, s[4:7], s46 offen sc1
  ds_read_b128 v[96:99], v3 offset:6144
  s_waitcnt lgkmcnt(5)
  v_mfma_f32_16x16x32_bf16 v[80:83], v[100:103], a[168:171], v[80:83]
  v_mfma_f32_16x16x32_bf16 v[84:87], v[100:103], a[172:175], v[84:87]
  ds_read_b128 v[100:103], v3 offset:7168
  s_waitcnt lgkmcnt(5)
  v_mfma_f32_16x16x32_bf16 v[80:83], v[104:107], a[176:179], v[80:83]
  s_add_u32 s46, s97, 32768
  buffer_load_dwordx4 v[132:135], v11, s[4:7], s46 offen sc1
  v_mfma_f32_16x16x32_bf16 v[84:87], v[104:107], a[180:183], v[84:87]
  ds_read_b128 v[104:107], v3 offset:8192
  s_waitcnt lgkmcnt(5)
  v_mfma_f32_16x16x32_bf16 v[80:83], v[108:111], a[184:187], v[80:83]
  v_mfma_f32_16x16x32_bf16 v[84:87], v[108:111], a[188:191], v[84:87]
  s_add_u32 s46, s96, 32768
  buffer_load_dwordx4 v[120:123], v11, s[4:7], s46 offen sc1
  ds_read_b128 v[108:111], v3 offset:9216
  s_waitcnt lgkmcnt(5)
  v_mfma_f32_16x16x32_bf16 v[80:83], v[88:91], a[192:195], v[80:83]
  v_mfma_f32_16x16x32_bf16 v[84:87], v[88:91], a[196:199], v[84:87]
  ds_read_b128 v[88:91], v3 offset:10240
  s_waitcnt lgkmcnt(5)
  v_mfma_f32_16x16x32_bf16 v[80:83], v[92:95], a[200:203], v[80:83]
  v_mfma_f32_16x16x32_bf16 v[84:87], v[92:95], a[204:207], v[84:87]
  ds_read_b128 v[92:95], v3 offset:11264
  s_waitcnt lgkmcnt(5)
  v_mfma_f32_16x16x32_bf16 v[80:83], v[96:99], a[208:211], v[80:83]
  v_mfma_f32_16x16x32_bf16 v[84:87], v[96:99], a[212:215], v[84:87]
  ds_read_b128 v[96:99], v3 offset:12288
  s_waitcnt lgkmcnt(5)
  v_mfma_f32_16x16x32_bf16 v[80:83], v[100:103], a[216:219], v[80:83]
  buffer_load_dword v220, v14, s[4:7], s53 offen sc1
  v_mfma_f32_16x16x32_bf16 v[84:87], v[100:103], a[220:223], v[84:87]
  ds_read_b128 v[100:103], v3 offset:13312
  s_waitcnt lgkmcnt(5)
  v_mfma_f32_16x16x32_bf16 v[80:83], v[104:107], a[224:227], v[80:83]
  v_mfma_f32_16x16x32_bf16 v[84:87], v[104:107], a[228:231], v[84:87]
  ds_read_b128 v[104:107], v3 offset:14336
  s_waitcnt lgkmcnt(5)
  v_mfma_f32_16x16x32_bf16 v[80:83], v[108:111], a[232:235], v[80:83]
  v_mfma_f32_16x16x32_bf16 v[84:87], v[108:111], a[236:239], v[84:87]
  ds_read_b128 v[108:111], v3 offset:15360
  s_waitcnt lgkmcnt(5)
  v_mfma_f32_16x16x32_bf16 v[80:83], v[88:91], a[240:243], v[80:83]
  v_mfma_f32_16x16x32_bf16 v[84:87], v[88:91], a[244:247], v[84:87]
  s_waitcnt lgkmcnt(4)
  v_mfma_f32_16x16x32_bf16 v[80:83], v[92:95], a[248:251], v[80:83]
  v_mfma_f32_16x16x32_bf16 v[84:87], v[92:95], a[252:255], v[84:87]
  s_waitcnt lgkmcnt(3)
  v_mfma_f32_16x16x32_bf16 v[80:83], v[96:99], v[224:227], v[80:83]
  v_mfma_f32_16x16x32_bf16 v[84:87], v[96:99], v[228:231], v[84:87]
  s_waitcnt lgkmcnt(2)
  v_mfma_f32_16x16x32_bf16 v[80:83], v[100:103], v[232:235], v[80:83]
  v_mfma_f32_16x16x32_bf16 v[84:87], v[100:103], v[236:239], v[84:87]
  s_waitcnt lgkmcnt(1)
  v_mfma_f32_16x16x32_bf16 v[80:83], v[104:107], v[240:243], v[80:83]
  v_mfma_f32_16x16x32_bf16 v[84:87], v[104:107], v[244:247], v[84:87]
  s_waitcnt lgkmcnt(0)
  v_mfma_f32_16x16x32_bf16 v[80:83], v[108:111], v[248:251], v[80:83]
  v_mfma_f32_16x16x32_bf16 v[84:87], v[108:111], v[252:255], v[84:87]
  s_waitcnt vmcnt(0)
  s_mov_b32 s47, 0
B2_spin1:
  v_cmp_ne_u32 vcc, 2, v220
  s_nop 0
  s_cmp_eq_u64 vcc, 0
  s_cbranch_scc1 B2_ok1
  s_add_u32 s47, s47, 1
  s_cmp_gt_u32 s47, 0x40000
  s_cbranch_scc1 B2_ok1
  buffer_load_dword v220, v14, s[4:7], s53 offen sc1
  s_waitcnt vmcnt(0)
  s_branch B2_spin1
B2_ok1:
  s_add_u32 s46, s96, s62
  buffer_load_dwordx4 v[112:115], v1, s[4:7], s46 offen sc1
  s_add_u32 s46, s96, s62
  s_add_u32 s46, s46, 4096
  buffer_load_dwordx4 v[116:119], v1, s[4:7], s46 offen sc1
  s_barrier
  v_mov_b32 v96, 0
  v_mov_b32 v97, 0
  v_mov_b32 v98, 0
  v_mov_b32 v99, 0
  v_mov_b32 v108, 0
  v_mov_b32 v109, 0
  v_mov_b32 v110, 0
  v_mov_b32 v111, 0
  v_and_b32 v164, 1, v9
  v_mul_lo_u32 v165, v164, s63
  v_mul_lo_u32 v164, v164, s56
  v_add_u32 v164, v164, v13
  v_add_u32 v165, v165, v13
  v_permlane16_swap_b32 v200, v202
  v_permlane16_swap_b32 v201, v203
  v_permlane16_swap_b32 v204, v206
  v_permlane16_swap_b32 v205, v207
  v_permlane16_swap_b32 v208, v210
  v_permlane16_swap_b32 v209, v211
  v_lshlrev_b32 v148, 16, v200
  v_and_b32 v149, 0xffff0000, v200
  v_lshlrev_b32 v150, 16, v201
  v_and_b32 v151, 0xffff0000, v201
  v_pk_add_f32 v[72:73], v[72:73], v[148:149]
  v_pk_add_f32 v[74:75], v[74:75], v[150:151]
  v_lshlrev_b32 v148, 16, v202
  v_and_b32 v149, 0xffff0000, v202
  v_lshlrev_b32 v150, 16, v203
  v_and_b32 v151, 0xffff0000, v203
  v_pk_add_f32 v[76:77], v[76:77], v[148:149]
  v_pk_add_f32 v[78:79], v[78:79], v[150:151]
  v_lshlrev_b32 v148, 16, v204
  v_and_b32 v149, 0xffff0000, v204
  v_lshlrev_b32 v150, 16, v205
  v_and_b32 v151, 0xffff0000, v205
  v_pk_add_f32 v[80:81], v[80:81], v[148:149]
  v_pk_add_f32 v[82:83], v[82:83], v[150:151]
  v_lshlrev_b32 v148, 16, v206
  v_and_b32 v149, 0xffff0000, v206
  v_lshlrev_b32 v150, 16, v207
  v_and_b32 v151, 0xffff0000, v207
  v_pk_add_f32 v[84:85], v[84:85], v[148:149]
  v_pk_add_f32 v[86:87], v[86:87], v[150:151]
  v_lshlrev_b32 v148, 16, v136
  v_and_b32 v149, 0xffff0000, v136
  v_lshlrev_b32 v150, 16, v137
  v_and_b32 v151, 0xffff0000, v137
  v_pk_add_f32 v[72:73], v[72:73], v[148:149]
  v_pk_add_f32 v[74:75], v[74:75], v[150:151]
  v_lshlrev_b32 v148, 16, v138
  v_and_b32 v149, 0xffff0000, v138
  v_lshlrev_b32 v150, 16, v139
  v_and_b32 v151, 0xffff0000, v139
  v_pk_add_f32 v[76:77], v[76:77], v[148:149]
  v_pk_add_f32 v[78:79], v[78:79], v[150:151]
  v_lshlrev_b32 v148, 16, v140
  v_and_b32 v149, 0xffff0000, v140
  v_lshlrev_b32 v150, 16, v141
  v_and_b32 v151, 0xffff0000, v141
  v_pk_add_f32 v[80:81], v[80:81], v[148:149]
  v_pk_add_f32 v[82:83], v[82:83], v[150:151]
  v_lshlrev_b32 v148, 16, v142
  v_and_b32 v149, 0xffff0000, v142
  v_lshlrev_b32 v150, 16, v143
  v_and_b32 v151, 0xffff0000, v143
  v_pk_add_f32 v[84:85], v[84:85], v[148:149]
  v_pk_add_f32 v[86:87], v[86:87], v[150:151]
  v_lshlrev_b32 v148, 16, v124
  v_and_b32 v149, 0xffff0000, v124
  v_lshlrev_b32 v150, 16, v125
  v_and_b32 v151, 0xffff0000, v125
  v_pk_add_f32 v[72:73], v[72:73], v[148:149]
  v_pk_add_f32 v[74:75], v[74:75], v[150:151]
  v_lshlrev_b32 v148, 16, v126
  v_and_b32 v149, 0xffff0000, v126
  v_lshlrev_b32 v150, 16, v127
  v_and_b32 v151, 0xffff0000, v127
  v_pk_add_f32 v[76:77], v[76:77], v[148:149]
  v_pk_add_f32 v[78:79], v[78:79], v[150:151]
  v_lshlrev_b32 v148, 16, v128
  v_and_b32 v149, 0xffff0000, v128
  v_lshlrev_b32 v150, 16, v129
  v_and_b32 v151, 0xffff0000, v129
  v_pk_add_f32 v[80:81], v[80:81], v[148:149]
  v_pk_add_f32 v[82:83], v[82:83], v[150:151]
  v_lshlrev_b32 v148, 16, v130
  v_and_b32 v149, 0xffff0000, v130
  v_lshlrev_b32 v150, 16, v131
  v_and_b32 v151, 0xffff0000, v131
  v_pk_add_f32 v[84:85], v[84:85], v[148:149]
  v_pk_add_f32 v[86:87], v[86:87], v[150:151]
  s_cmp_lg_u32 s3, s57
  s_cbranch_scc1 B2_no8
  v_lshlrev_b32 v148, 16, v208
  v_and_b32 v149, 0xffff0000, v208
  v_lshlrev_b32 v150, 16, v209
  v_and_b32 v151, 0xffff0000, v209
  v_pk_add_f32 v[16:17], v[16:17], v[148:149]
  v_pk_add_f32 v[18:19], v[18:19], v[150:151]
  v_lshlrev_b32 v148, 16, v144
  v_and_b32 v149, 0xffff0000, v144
  v_lshlrev_b32 v150, 16, v145
  v_and_b32 v151, 0xffff0000, v145
  v_pk_add_f32 v[16:17], v[16:17], v[148:149]
  v_pk_add_f32 v[18:19], v[18:19], v[150:151]
  v_lshlrev_b32 v148, 16, v132
  v_and_b32 v149, 0xffff0000, v132
  v_lshlrev_b32 v150, 16, v133
  v_and_b32 v151, 0xffff0000, v133
  v_pk_add_f32 v[16:17], v[16:17], v[148:149]
  v_pk_add_f32 v[18:19], v[18:19], v[150:151]
  v_lshlrev_b32 v148, 16, v210
  v_and_b32 v149, 0xffff0000, v210
  v_lshlrev_b32 v150, 16, v211
  v_and_b32 v151, 0xffff0000, v211
  v_pk_add_f32 v[20:21], v[20:21], v[148:149]
  v_pk_add_f32 v[22:23], v[22:23], v[150:151]
  v_lshlrev_b32 v148, 16, v146
  v_and_b32 v149, 0xffff0000, v146
  v_lshlrev_b32 v150, 16, v147
  v_and_b32 v151, 0xffff0000, v147
  v_pk_add_f32 v[20:21], v[20:21], v[148:149]
  v_pk_add_f32 v[22:23], v[22:23], v[150:151]
  v_lshlrev_b32 v148, 16, v134
  v_and_b32 v149, 0xffff0000, v134
  v_lshlrev_b32 v150, 16, v135
  v_and_b32 v151, 0xffff0000, v135
  v_pk_add_f32 v[20:21], v[20:21], v[148:149]
  v_pk_add_f32 v[22:23], v[22:23], v[150:151]
  v_lshlrev_b32 v148, 16, v120
  v_and_b32 v149, 0xffff0000, v120
  v_lshlrev_b32 v150, 16, v121
  v_and_b32 v151, 0xffff0000, v121
  v_pk_add_f32 v[16:17], v[16:17], v[148:149]
  v_pk_add_f32 v[18:19], v[18:19], v[150:151]
  v_cvt_pk_bf16_f32 v160, v16, v17
  v_cvt_pk_bf16_f32 v161, v18, v19
  v_lshlrev_b32 v96, 16, v160
  v_and_b32 v97, 0xffff0000, v160
  v_lshlrev_b32 v98, 16, v161
  v_and_b32 v99, 0xffff0000, v161
  v_lshlrev_b32 v148, 16, v122
  v_and_b32 v149, 0xffff0000, v122
  v_lshlrev_b32 v150, 16, v123
  v_and_b32 v151, 0xffff0000, v123
  v_pk_add_f32 v[20:21], v[20:21], v[148:149]
  v_pk_add_f32 v[22:23], v[22:23], v[150:151]
  v_cvt_pk_bf16_f32 v162, v20, v21
  v_cvt_pk_bf16_f32 v163, v22, v23
  v_lshlrev_b32 v108, 16, v162
  v_and_b32 v109, 0xffff0000, v162
  v_lshlrev_b32 v110, 16, v163
  v_and_b32 v111, 0xffff0000, v163
  s_lshl_b32 s46, s56, 3
  s_add_u32 s46, s46, s42
  v_permlane16_swap_b32 v160, v162
  v_permlane16_swap_b32 v161, v163
  buffer_store_dwordx4 v[160:163], v165, s[8:11], s46 offen sc1
  s_waitcnt vmcnt(1)
  s_branch B2_go
B2_no8:
  s_waitcnt vmcnt(0)
B2_go:
  v_lshlrev_b32 v148, 16, v112
  v_and_b32 v149, 0xffff0000, v112
  v_lshlrev_b32 v150, 16, v113
  v_and_b32 v151, 0xffff0000, v113
  v_pk_add_f32 v[72:73], v[72:73], v[148:149]
  v_pk_add_f32 v[74:75], v[74:75], v[150:151]
  v_cvt_pk_bf16_f32 v152, v72, v73
  v_cvt_pk_bf16_f32 v153, v74, v75
  v_lshlrev_b32 v88, 16, v152
  v_and_b32 v89, 0xffff0000, v152
  v_lshlrev_b32 v90, 16, v153
  v_and_b32 v91, 0xffff0000, v153
  v_lshlrev_b32 v148, 16, v116
  v_and_b32 v149, 0xffff0000, v116
  v_lshlrev_b32 v150, 16, v117
  v_and_b32 v151, 0xffff0000, v117
  v_pk_add_f32 v[80:81], v[80:81], v[148:149]
  v_pk_add_f32 v[82:83], v[82:83], v[150:151]
  v_cvt_pk_bf16_f32 v154, v80, v81
  v_cvt_pk_bf16_f32 v155, v82, v83
  v_lshlrev_b32 v92, 16, v154
  v_and_b32 v93, 0xffff0000, v154
  v_lshlrev_b32 v94, 16, v155
  v_and_b32 v95, 0xffff0000, v155
  s_lshl_b32 s46, s57, 1
  s_mul_i32 s46, s46, s56
  s_add_u32 s46, s46, s42
  v_permlane16_swap_b32 v152, v154
  v_permlane16_swap_b32 v153, v155
  buffer_store_dwordx4 v[152:155], v164, s[8:11], s46 offen sc1
  v_lshlrev_b32 v148, 16, v114
  v_and_b32 v149, 0xffff0000, v114
  v_lshlrev_b32 v150, 16, v115
  v_and_b32 v151, 0xffff0000, v115
  v_pk_add_f32 v[76:77], v[76:77], v[148:149]
  v_pk_add_f32 v[78:79], v[78:79], v[150:151]
  v_cvt_pk_bf16_f32 v156, v76, v77
  v_cvt_pk_bf16_f32 v157, v78, v79
  v_lshlrev_b32 v100, 16, v156
  v_and_b32 v101, 0xffff0000, v156
  v_lshlrev_b32 v102, 16, v157
  v_and_b32 v103, 0xffff0000, v157
  v_lshlrev_b32 v148, 16, v118
  v_and_b32 v149, 0xffff0000, v118
  v_lshlrev_b32 v150, 16, v119
  v_and_b32 v151, 0xffff0000, v119
  v_pk_add_f32 v[84:85], v[84:85], v[148:149]
  v_pk_add_f32 v[86:87], v[86:87], v[150:151]
  v_cvt_pk_bf16_f32 v158, v84, v85
  v_cvt_pk_bf16_f32 v159, v86, v87
  v_lshlrev_b32 v104, 16, v158
  v_and_b32 v105, 0xffff0000, v158
  v_lshlrev_b32 v106, 16, v159
  v_and_b32 v107, 0xffff0000, v159
  s_lshl_b32 s46, s57, 1
  s_mul_i32 s46, s46, s56
  s_add_u32 s46, s46, s42
  s_add_u32 s46, s46, s63
  v_permlane16_swap_b32 v156, v158
  v_permlane16_swap_b32 v157, v159
  buffer_store_dwordx4 v[156:159], v164, s[8:11], s46 offen sc1
  s_cmp_lg_u32 s51, 0
  s_cbranch_scc1 B2_fin
  s_mov_b32 s47, 0x3e000000
  s_mov_b32 s48, 0x40800000
  s_mov_b32 s45, 0x41000000
  s_mov_b32 s46, 0
  s_cmp_eq_u32 s3, s57
  s_cselect_b32 s47, 0x3daaaaab, s47
  s_cselect_b32 s48, 0x40c00000, s48
  s_cselect_b32 s45, 0x41400000, s45
  s_cselect_b32 s46, 1.0, s46
  v_pk_add_f32 v[24:25], v[88:89], v[90:91]
  v_pk_add_f32 v[26:27], v[92:93], v[94:95]
  v_pk_add_f32 v[28:29], v[96:97], v[98:99]
  v_pk_add_f32 v[24:25], v[24:25], v[26:27]
  v_pk_add_f32 v[24:25], v[24:25], v[28:29]
  v_add_f32 v24, v24, v25
  v_mul_f32 v24, s47, v24
  v_mov_b32 v25, v24
  v_pk_add_f32 v[88:89], v[88:89], v[24:25] neg_lo:[0,1] neg_hi:[0,1]
  v_pk_add_f32 v[90:91], v[90:91], v[24:25] neg_lo:[0,1] neg_hi:[0,1]
  v_pk_add_f32 v[92:93], v[92:93], v[24:25] neg_lo:[0,1] neg_hi:[0,1]
  v_pk_add_f32 v[94:95], v[94:95], v[24:25] neg_lo:[0,1] neg_hi:[0,1]
  v_pk_add_f32 v[96:97], v[96:97], v[24:25] neg_lo:[0,1] neg_hi:[0,1]
  v_pk_add_f32 v[98:99], v[98:99], v[24:25] neg_lo:[0,1] neg_hi:[0,1]
  v_pk_mul_f32 v[26:27], v[88:89], v[88:89]
  v_pk_mul_f32 v[28:29], v[96:97], v[96:97]
  v_pk_fma_f32 v[26:27], v[90:91], v[90:91], v[26:27]
  v_pk_fma_f32 v[26:27], v[92:93], v[92:93], v[26:27]
  v_pk_fma_f32 v[26:27], v[94:95], v[94:95], v[26:27]
  v_pk_fma_f32 v[28:29], v[98:99], v[98:99], v[28:29]
  v_add_f32 v17, v26, v27
  v_add_f32 v28, v28, v29
  v_fmac_f32 v17, s46, v28
  v_mov_b32 v16, v24
  v_mov_b32 v2, v16
  v_mov_b32 v3, v17
  s_nop 0
  v_permlane16_swap_b32 v16, v2
  v_permlane16_swap_b32 v17, v3
  v_add_f32 v17, v17, v3
  v_sub_f32 v3, v16, v2
  v_add_f32 v16, v16, v2
  v_mul_f32 v16, 0.5, v16
  v_mul_f32 v3, v3, v3
  v_fma_f32 v17, v3, s48, v17
  v_mov_b32 v2, v16
  v_mov_b32 v3, v17
  s_nop 0
  v_permlane32_swap_b32 v16, v2
  v_permlane32_swap_b32 v17, v3
  v_add_f32 v17, v17, v3
  v_sub_f32 v3, v16, v2
  v_add_f32 v16, v16, v2
  v_mul_f32 v16, 0.5, v16
  v_mul_f32 v3, v3, v3
  v_fma_f32 v17, v3, s45, v17
  v_pk_add_f32 v[24:25], v[100:101], v[102:103]
  v_pk_add_f32 v[26:27], v[104:105], v[106:107]
  v_pk_add_f32 v[28:29], v[108:109], v[110:111]
  v_pk_add_f32 v[24:25], v[24:25], v[26:27]
  v_pk_add_f32 v[24:25], v[24:25], v[28:29]
  v_add_f32 v24, v24, v25
  v_mul_f32 v24, s47, v24
  v_mov_b32 v25, v24
  v_pk_add_f32 v[100:101], v[100:101], v[24:25] neg_lo:[0,1] neg_hi:[0,1]
  v_pk_add_f32 v[102:103], v[102:103], v[24:25] neg_lo:[0,1] neg_hi:[0,1]
  v_pk_add_f32 v[104:105], v[104:105], v[24:25] neg_lo:[0,1] neg_hi:[0,1]
  v_pk_add_f32 v[106:107], v[106:107], v[24:25] neg_lo:[0,1] neg_hi:[0,1]
  v_pk_add_f32 v[108:109], v[108:109], v[24:25] neg_lo:[0,1] neg_hi:[0,1]
  v_pk_add_f32 v[110:111], v[110:111], v[24:25] neg_lo:[0,1] neg_hi:[0,1]
  v_pk_mul_f32 v[26:27], v[100:101], v[100:101]
  v_pk_mul_f32 v[28:29], v[108:109], v[108:109]
  v_pk_fma_f32 v[26:27], v[102:103], v[102:103], v[26:27]
  v_pk_fma_f32 v[26:27], v[104:105], v[104:105], v[26:27]
  v_pk_fma_f32 v[26:27], v[106:107], v[106:107], v[26:27]
  v_pk_fma_f32 v[28:29], v[110:111], v[110:111], v[28:29]
  v_add_f32 v19, v26, v27
  v_add_f32 v28, v28, v29
  v_fmac_f32 v19, s46, v28
  v_mov_b32 v18, v24
  v_mov_b32 v2, v18
  v_mov_b32 v3, v19
  s_nop 0
  v_permlane16_swap_b32 v18, v2
  v_permlane16_swap_b32 v19, v3
  v_add_f32 v19, v19, v3
  v_sub_f32 v3, v18, v2
  v_add_f32 v18, v18, v2
  v_mul_f32 v18, 0.5, v18
  v_mul_f32 v3, v3, v3
  v_fma_f32 v19, v3, s48, v19
  v_mov_b32 v2, v18
  v_mov_b32 v3, v19
  s_nop 0
  v_permlane32_swap_b32 v18, v2
  v_permlane32_swap_b32 v19, v3
  v_add_f32 v19, v19, v3
  v_sub_f32 v3, v18, v2
  v_add_f32 v18, v18, v2
  v_mul_f32 v18, 0.5, v18
  v_mul_f32 v3, v3, v3
  v_fma_f32 v19, v3, s45, v19
  s_lshl_b32 s46, s52, 12
  s_lshl_b32 s47, s39, 8
  s_add_u32 s46, s46, s47
  s_lshr_b32 s47, s57, 1
  s_lshl_b32 s47, s47, 10
  s_add_u32 s46, s46, s47
  s_and_b32 s47, s57, 1
  s_lshl_b32 s47, s47, 3
  s_add_u32 s46, s46, s47
  s_add_u32 s46, s46, 70451200
  v_lshlrev_b32 v8, 4, v0
  s_mov_b32 exec_lo, 0xffff
  s_mov_b32 exec_hi, 0x0
  buffer_store_dwordx2 v[16:17], v8, s[4:7], s46 offen sc1
  buffer_store_dwordx2 v[18:19], v8, s[4:7], s46 offen offset:2048 sc1
  s_mov_b64 exec, -1
  s_lshl_b32 s46, s38, 2
  s_add_u32 s46, s46, s39
  s_lshl_b32 s46, s46, 2
  s_add_u32 s46, s46, s57
  s_lshl_b32 s46, s46, 7
  s_add_u32 s46, s46, 24412160
  s_cmp_eq_u32 s3, 0
  s_cselect_b32 s46, s46, s49
  v_mov_b32 v2, s49
  v_writelane_b32 v2, s46, 0
  v_mov_b32 v3, 1
  s_waitcnt vmcnt(0)
  s_barrier
  buffer_store_dword v3, v2, s[4:7], 0 offen sc1
  s_lshr_b32 s15, s36, 2
  s_lshl_b32 s15, s15, 3
  s_lshr_b32 s13, s37, 2
  s_add_u32 s15, s15, s13
  s_mul_i32 s15, s15, 136192
  s_add_u32 s15, s15, 16220160
  s_mul_i32 s13, s3, 8192
  s_add_u32 s12, s15, s13
  s_add_u32 s12, s12, 73728
  s_add_u32 m0, s13, 73728
  s_nop 0
  buffer_load_dwordx4 v1, s[4:7], s12 offen offset:0 sc1 lds
  buffer_load_dwordx4 v1, s[4:7], s12 offen offset:1024 sc1 lds
  buffer_load_dwordx4 v1, s[4:7], s12 offen offset:2048 sc1 lds
  buffer_load_dwordx4 v1, s[4:7], s12 offen offset:3072 sc1 lds
  s_add_u32 s12, s12, 4096
  s_add_u32 m0, m0, 4096
  s_nop 0
  buffer_load_dwordx4 v1, s[4:7], s12 offen offset:0 sc1 lds
  buffer_load_dwordx4 v1, s[4:7], s12 offen offset:1024 sc1 lds
  buffer_load_dwordx4 v1, s[4:7], s12 offen offset:2048 sc1 lds
  buffer_load_dwordx4 v1, s[4:7], s12 offen offset:3072 sc1 lds
  s_add_u32 s50, s50, 45842432
  s_mov_b32 s51, 1
  s_branch M_layer
B2_fin:
M_end:
  s_endpgm
M_after:

.section .rodata,"a"
.p2align 6
.amdhsa_kernel interleave_layers__linear_attn_block__geglu_ffn__prompt_kernel
  .amdhsa_next_free_vgpr 512
  .amdhsa_next_free_sgpr 102
  .amdhsa_accum_offset 256
  .amdhsa_group_segment_fixed_size 0
  .amdhsa_kernarg_size 80
  .amdhsa_user_sgpr_count 2
  .amdhsa_user_sgpr_kernarg_segment_ptr 1
  .amdhsa_system_sgpr_workgroup_id_x 1
  .amdhsa_float_denorm_mode_32 3
.end_amdhsa_kernel
```
